```python
import torch

def _softmax(x, axis=-1):
    return torch.softmax(x, dim=axis)
def _gelu(x):
    return torch.nn.functional.gelu(x, approximate="tanh")
def _silu(x):
    return torch.nn.functional.silu(x)
def _sigmoid(x):
    return torch.sigmoid(x)
def _layernorm(x, axis=-1, eps=1e-5):
    m = x.mean(dim=axis, keepdim=True)
    v = x.var(dim=axis, keepdim=True, unbiased=False)
    return (x - m) / torch.sqrt(v + eps)
def _scatter_add(tgt, idx, src, axis=0):
    return tgt.clone().index_add_(axis, idx, src)
def _segment_sum(src, seg, n):
    out = torch.zeros((n,) + src.shape[1:], dtype=src.dtype)
    return out.index_add_(0, seg, src)
def _pad(x, pw):
    flat = tuple(v for pair in reversed(pw) for v in pair)
    return torch.nn.functional.pad(x, flat)

kernel_name = 'concat_heads__ssm_conv_s4d__ssm_conv_h3__prompt'

def setup_inputs():

    _w = (lambda a: (lambda t: t.to(torch.bfloat16) if t.is_floating_point() else t)(torch.as_tensor(a)))
    def _A_setup():
        Bsz, L, D, N = 1, 2048, 640, 128
        return {
            "u": _w((lambda *s: torch.randn(*s, dtype=torch.bfloat16) * 0.05)(Bsz, L, D)),
            "log_A_real": _w((lambda *s: torch.randn(*s, dtype=torch.bfloat16) * 3.2)(D, N) * 0.5),
            "A_imag": _w((lambda *s: torch.randn(*s, dtype=torch.bfloat16) * 0.05)(D, N) * 3.14),
            "C_real": _w((lambda *s: torch.randn(*s, dtype=torch.bfloat16) * 0.1)(D, N) / N ** 0.5),
            "C_imag": _w((lambda *s: torch.randn(*s, dtype=torch.bfloat16) * 0.1)(D, N) / N ** 0.5),
            "log_dt": _w((lambda *s: torch.randn(*s, dtype=torch.bfloat16) * 0.05)(D) * 0.5 - 4.0),
            "D_skip": _w((lambda *s: torch.randn(*s, dtype=torch.bfloat16) * 0.05)(D)),
        }
    _A_in = _A_setup()

    def _B_setup():
        B, S, D = 1, 2048, 640
        ks = 4
        return {
            "q": _w((lambda *s: torch.randn(*s, dtype=torch.bfloat16) * 0.05)(B, S, D)),
            "k": _w((lambda *s: torch.randn(*s, dtype=torch.bfloat16) * 0.4)(B, S, D)),
            "v": _w((lambda *s: torch.randn(*s, dtype=torch.bfloat16) * 0.2)(B, S, D)),
            "shift_k": _w((lambda *s: torch.randn(*s, dtype=torch.bfloat16) * 0.4)(D, ks) * 0.5),
            "ssm_k": _w((lambda *s: torch.randn(*s, dtype=torch.bfloat16) * 0.4)(D, S) * (1.0 / S ** 0.5)),
            "ssm_D": _w((lambda *s: torch.randn(*s, dtype=torch.bfloat16) * 0.2)(D)),
        }
    _B_in = _B_setup()

    return {
        "A_u": _A_in["u"],
        "A_log_A_real": _A_in["log_A_real"],
        "A_A_imag": _A_in["A_imag"],
        "A_C_real": _A_in["C_real"],
        "A_C_imag": _A_in["C_imag"],
        "A_log_dt": _A_in["log_dt"],
        "A_D_skip": _A_in["D_skip"],
        "B_q": _B_in["q"],
        "B_k": _B_in["k"],
        "B_v": _B_in["v"],
        "B_shift_k": _B_in["shift_k"],
        "B_ssm_k": _B_in["ssm_k"],
        "B_ssm_D": _B_in["ssm_D"],
    }

def reference(A_u, A_log_A_real, A_A_imag, A_C_real, A_C_imag, A_log_dt, A_D_skip, B_q, B_k, B_v, B_shift_k, B_ssm_k, B_ssm_D):
    def _A_ref(u, log_A_real, A_imag, C_real, C_imag, log_dt, D_skip):
        L = u.shape[1]
        dt = torch.exp(log_dt)
        A = -torch.exp(log_A_real) + 1j * A_imag
        C = (C_real + 1j * C_imag) * dt[:, None]
        pos = (lambda x, dt: x.to(dt))(torch.arange(L), log_dt.dtype)
        P = torch.exp((A * dt[:, None])[:, :, None] * pos[None, None, :])
        K = 2.0 * torch.einsum("dn,dnl->dl", C, P).real
        L2 = 2 * L
        u_t = (lambda x, *d: x.permute(*d))(u, 0, 2, 1)
        Kf = (lambda x, *a, **k: torch.fft.rfft(x.float(), *a, **k))(K, L2)
        Uf = (lambda x, *a, **k: torch.fft.rfft(x.float(), *a, **k))(u_t, L2)
        y = (lambda x, *a, **k: torch.fft.irfft(x, *a, **k).to(torch.bfloat16))(Uf * Kf[None, :, :], L2)[:, :, :L]
        y = (lambda x, *d: x.permute(*d))(y, 0, 2, 1)
        return y + u * D_skip[None, None, :]

    def _B_ref(q, k, v, shift_k, ssm_k, ssm_D):
        B, S, D = q.shape
        ks = shift_k.shape[-1]
        k_pad = _pad(k, ((0, 0), (ks - 1, 0), (0, 0)))
        k_shift = torch.zeros_like(k)
        for t in range(ks):
            k_shift = k_shift + k_pad[:, t:t + S, :] * shift_k[:, ks - 1 - t][None, None, :]
        kv = k_shift * v
        L = 2 * S
        kv_pad = _pad(kv, ((0, 0), (0, S), (0, 0)))
        kf_pad = _pad(ssm_k, ((0, 0), (0, S)))
        kv_f = (lambda x, axes=(-2,-1): torch.fft.rfft2(x.float(), dim=axes))(kv_pad[:, None, :, :], axes=(1, 2))
        kf_f = (lambda x, axes=(-2,-1): torch.fft.rfft2(x.float(), dim=axes))(kf_pad[:, None, :], axes=(1, 2))
        kf_f = (lambda x, *d: x.permute(*d))(kf_f, 1, 2, 0)
        y_f = kv_f * kf_f[None, :, :, :]
        y = (lambda x, s, axes=(-2,-1): torch.fft.irfft2(x, s=s, dim=axes).to(torch.bfloat16))(y_f, (1, L), axes=(1, 2))[:, 0, :S, :]
        y = y + kv * ssm_D[None, None, :]
        return q * y

    a = _A_ref(A_u, A_log_A_real, A_A_imag, A_C_real, A_C_imag, A_log_dt, A_D_skip)
    b = _B_ref(B_q, B_k, B_v, B_shift_k, B_ssm_k, B_ssm_D)
    return torch.concatenate([a, b], axis=-1)
```

```asm
; @launch grid=(256,1,1) block=(768,1,1) lds=150464
.amdgcn_target "amdgcn-amd-amdhsa--gfx950"
.text
.globl concat_heads__ssm_conv_s4d__ssm_conv_h3__prompt_kernel
.p2align 8
.type concat_heads__ssm_conv_s4d__ssm_conv_h3__prompt_kernel,@function
concat_heads__ssm_conv_s4d__ssm_conv_h3__prompt_kernel:
  s_cmp_ge_u32 s2, 256
  s_cbranch_scc1 L_exit
  s_load_dwordx16 s[64:79], s[0:1], 0
  s_load_dwordx16 s[80:95], s[0:1], 64
  v_and_b32 v1, 63, v0
  v_lshrrev_b32 v2, 6, v0
  s_and_b32 s5, s2, 7
  s_lshr_b32 s6, s2, 3
  v_readfirstlane_b32 s4, v2
  s_cmp_lt_u32 s5, 4
  s_cselect_b32 s7, 8, 12
  s_cmp_lt_u32 s6, s7
  s_cbranch_scc1 L_H
  s_sub_u32 s6, s6, s7
  s_lshr_b32 s7, s6, 3
  s_mov_b32 s32, 0x86848280
  s_mov_b32 s33, 0xc8c68988
  s_cmp_eq_u32 s7, 1
  s_cselect_b32 s32, 0x87858381, s32
  s_cselect_b32 s33, 0xc9c7c5c4, s33
  s_cmp_eq_u32 s7, 2
  s_cselect_b32 s32, 0xc3c2c1c0, s32
  s_cselect_b32 s33, 0x0, s33
  s_lshl_b32 s5, s5, 3
  s_lshr_b64 s[32:33], s[32:33], s5
  s_and_b32 s34, s32, 0x80
  s_cmp_eq_u32 s34, 0
  s_cbranch_scc1 L_exit
  s_and_b32 s28, s32, 15
  s_bfe_u32 s31, s32, 0x10006
  s_mul_i32 s30, s31, 80
  s_and_b32 s6, s6, 7
  s_lshl_b32 s3, s28, 3
  s_add_u32 s3, s3, s6
  s_cmp_eq_u32 s31, 1
  s_cbranch_scc1 L_B
  s_cmp_ge_u32 s4, 8
  s_cbranch_scc1 L_AI
  s_cmp_ge_u32 s4, 4
  s_cbranch_scc1 L_AG
  s_lshl_b32 s5, s3, 3
  s_add_u32 s5, s5, s4
  s_lshl_b32 s6, s5, 8
  v_lshl_add_u32 v94, v1, 2, s6
  s_waitcnt lgkmcnt(0)
  global_load_dword v10, v94, s[66:67]
  global_load_dword v11, v94, s[68:69]
  global_load_dword v12, v94, s[70:71]
  global_load_dword v13, v94, s[72:73]
  s_lshl_b32 s6, s5, 1
  v_mov_b32 v95, s6
  global_load_short_d16_hi v14, v95, s[74:75]
  global_load_short_d16_hi v21, v95, s[76:77]
  v_and_b32 v160, 15, v1
  v_lshrrev_b32 v161, 4, v1
  v_lshrrev_b32 v162, 2, v160
  v_and_b32 v163, 3, v160
  v_add_u32 v162, v162, v163
  v_lshlrev_b32 v162, 3, v162
  v_lshl_add_u32 v162, v161, 6, v162
  s_mul_i32 s61, s4, 4128
  s_add_u32 s61, s61, 37024
  s_sub_u32 s5, s61, 24
  v_add_u32 v2, s5, v162
  v_lshlrev_b32 v162, 4, v161
  v_lshlrev_b32 v163, 3, v160
  v_sub_u32 v162, v162, v163
  s_mul_i32 s5, s4, 4624
  s_add_u32 s5, s5, 120
  v_add_u32 v3, s5, v162
  v_lshlrev_b32 v162, 5, v160
  v_lshl_add_u32 v162, v161, 3, v162
  v_lshrrev_b32 v163, 2, v160
  v_lshl_add_u32 v162, v163, 4, v162
  s_mul_i32 s5, s4, 4672
  s_add_u32 s5, s5, 70016
  v_add_u32 v4, s5, v162
  v_add_u32 v162, 47, v1
  v_subrev_u32 v163, 16, v1
  v_cmp_gt_u32 vcc, 16, v1
  v_cndmask_b32 v162, v163, v162, vcc
  v_mov_b32 v163, 63
  v_cmp_eq_u32 vcc, 0, v1
  v_cndmask_b32 v162, v162, v163, vcc
  v_lshlrev_b32 v5, 2, v162
  s_mov_b64 s[40:41], 1
  s_mov_b32 s44, 0xffff0000
  v_lshrrev_b32 v160, 4, v1
  v_mul_u32_u24 v160, 1152, v160
  v_and_b32 v161, 15, v1
  v_lshl_add_u32 v160, v161, 3, v160
  s_mul_i32 s5, s4, 4624
  s_add_u32 s5, s5, 1024
  v_add_u32 v160, s5, v160
  v_mov_b32 v162, 0
  v_mov_b32 v163, 0
  ds_write_b64 v160, v[162:163]
  v_and_b32 v161, 3, v1
  v_lshlrev_b32 v161, 3, v161
  s_sub_u32 s5, s61, 32
  v_add_u32 v161, s5, v161
  ds_write_b64 v161, v[162:163]
  s_mul_i32 s7, s4, 8704
  s_add_u32 s5, s7, 70016
  s_add_u32 s6, s7, 72576
  s_cmp_lt_u32 s4, 4
  s_cselect_b32 s60, s5, s6
  s_lshl_b32 s62, s4, 10
  s_add_u32 s62, s62, 142208
  v_lshl_add_u32 v16, v1, 3, s60
  v_add_u32 v7, 2176, v16
  v_add_u32 v8, 4352, v16
  v_add_u32 v9, 6528, v16
  v_and_b32 v94, 15, v1
  v_lshrrev_b32 v95, 4, v1
  v_mul_u32_u24 v17, 544, v94
  v_lshl_add_u32 v17, v95, 4, v17
  v_add_u32 v17, s60, v17
  v_lshlrev_b32 v96, 3, v94
  v_lshlrev_b32 v97, 2, v94
  v_cmp_gt_u32 vcc, 32, v1
  v_cndmask_b32 v96, v97, v96, vcc
  v_lshl_add_u32 v96, v95, 7, v96
  v_add_u32 v18, s62, v96
  v_mov_b32 v97, 64
  v_mov_b32 v98, 4
  v_cndmask_b32 v97, v97, v98, vcc
  v_add_u32 v19, v18, v97
  v_lshlrev_b32 v6, 5, v94
  v_lshl_add_u32 v6, v95, 3, v6
  v_add_u32 v6, s62, v6
  v_lshrrev_b32 v95, 5, v1
  v_bfe_u32 v96, v1, 4, 1
  v_lshlrev_b32 v94, 4, v94
  v_lshl_add_u32 v94, v95, 8, v94
  v_lshl_add_u32 v94, v96, 3, v94
  v_add_u32 v20, s61, v94
  s_mov_b32 s48, 0x01000100
  s_mov_b32 s49, 0x03020302
  s_mov_b32 s50, 0x05040302
  s_waitcnt vmcnt(1)
  v_mul_f32 v22, 1069066811, v14
  v_lshlrev_b32 v24, 16, v10
  v_lshlrev_b32 v26, 16, v11
  v_lshlrev_b32 v34, 16, v12
  v_lshlrev_b32 v35, 16, v13
  v_and_b32 v25, s44, v10
  v_and_b32 v27, s44, v11
  v_and_b32 v52, s44, v12
  v_and_b32 v53, s44, v13
  v_exp_f32 v22, v22
  v_mul_f32 v24, 1069066811, v24
  v_mul_f32 v25, 1069066811, v25
  v_exp_f32 v24, v24
  v_exp_f32 v25, v25
  v_cvt_pk_bf16_f32 v22, v22, v22
  s_waitcnt vmcnt(0)
  v_cndmask_b32 v21, 0, v21, s[40:41]
  v_and_b32 v22, s44, v22
  v_cvt_pk_bf16_f32 v28, v24, v25
  v_add_f32 v23, v22, v22
  v_and_b32 v25, s44, v28
  v_lshlrev_b32 v24, 16, v28
  v_mul_f32 v26, v26, v22
  v_mul_f32 v24, -v24, v22
  v_mul_f32 v27, v27, v22
  v_mul_f32 v25, -v25, v22
  v_mul_f32 v26, 1042479491, v26
  v_mul_f32 v24, 1069066811, v24
  v_mul_f32 v27, 1042479491, v27
  v_mul_f32 v25, 1069066811, v25
  v_mul_f32 v34, v34, v23
  v_mul_f32 v35, v35, v23
  v_mul_f32 v52, v52, v23
  v_mul_f32 v53, v53, v23
  v_exp_f32 v28, v24
  v_fract_f32 v30, v26
  v_mul_f32 v32, 0x43000000, v24
  v_mul_f32 v71, 0x43000000, v26
  v_exp_f32 v29, v25
  v_fract_f32 v31, v27
  v_mul_f32 v33, 0x43000000, v25
  v_mul_f32 v73, 0x43000000, v27
  v_exp_f32 v70, v32
  v_fract_f32 v71, v71
  v_cos_f32 v36, v30
  v_sin_f32 v37, v30
  v_exp_f32 v72, v33
  v_fract_f32 v73, v73
  v_cos_f32 v54, v31
  v_sin_f32 v55, v31
  v_cos_f32 v44, v71
  v_sin_f32 v45, v71
  v_cos_f32 v62, v73
  v_sin_f32 v63, v73
  v_mul_f32 v36, v36, v28
  v_mul_f32 v37, v37, v28
  v_mul_f32 v54, v54, v29
  v_mul_f32 v55, v55, v29
  v_mul_f32 v44, v44, v70
  v_mul_f32 v45, v45, v70
  v_mul_f32 v62, v62, v72
  v_mul_f32 v63, v63, v72
  v_pk_mul_f32 v[70:71], v[36:37], v[36:37] op_sel:[0,0] op_sel_hi:[1,0]
  v_pk_mul_f32 v[72:73], v[54:55], v[54:55] op_sel:[0,0] op_sel_hi:[1,0]
  v_pk_mul_f32 v[74:75], v[44:45], v[44:45] op_sel:[0,0] op_sel_hi:[1,0]
  v_pk_mul_f32 v[76:77], v[62:63], v[62:63] op_sel:[0,0] op_sel_hi:[1,0]
  v_pk_fma_f32 v[38:39], v[36:37], v[36:37], v[70:71] op_sel:[1,1,0] op_sel_hi:[0,1,1] neg_lo:[1,0,0]
  v_pk_fma_f32 v[56:57], v[54:55], v[54:55], v[72:73] op_sel:[1,1,0] op_sel_hi:[0,1,1] neg_lo:[1,0,0]
  v_pk_fma_f32 v[46:47], v[44:45], v[44:45], v[74:75] op_sel:[1,1,0] op_sel_hi:[0,1,1] neg_lo:[1,0,0]
  v_pk_fma_f32 v[64:65], v[62:63], v[62:63], v[76:77] op_sel:[1,1,0] op_sel_hi:[0,1,1] neg_lo:[1,0,0]
  v_pk_mul_f32 v[70:71], v[38:39], v[38:39] op_sel:[0,0] op_sel_hi:[1,0]
  v_pk_mul_f32 v[72:73], v[56:57], v[56:57] op_sel:[0,0] op_sel_hi:[1,0]
  v_pk_mul_f32 v[74:75], v[46:47], v[46:47] op_sel:[0,0] op_sel_hi:[1,0]
  v_pk_mul_f32 v[76:77], v[64:65], v[64:65] op_sel:[0,0] op_sel_hi:[1,0]
  v_pk_fma_f32 v[40:41], v[38:39], v[38:39], v[70:71] op_sel:[1,1,0] op_sel_hi:[0,1,1] neg_lo:[1,0,0]
  v_pk_fma_f32 v[58:59], v[56:57], v[56:57], v[72:73] op_sel:[1,1,0] op_sel_hi:[0,1,1] neg_lo:[1,0,0]
  v_pk_fma_f32 v[48:49], v[46:47], v[46:47], v[74:75] op_sel:[1,1,0] op_sel_hi:[0,1,1] neg_lo:[1,0,0]
  v_pk_fma_f32 v[66:67], v[64:65], v[64:65], v[76:77] op_sel:[1,1,0] op_sel_hi:[0,1,1] neg_lo:[1,0,0]
  v_pk_mul_f32 v[70:71], v[40:41], v[40:41] op_sel:[0,0] op_sel_hi:[1,0]
  v_pk_mul_f32 v[72:73], v[58:59], v[58:59] op_sel:[0,0] op_sel_hi:[1,0]
  v_pk_mul_f32 v[74:75], v[48:49], v[48:49] op_sel:[0,0] op_sel_hi:[1,0]
  v_pk_mul_f32 v[76:77], v[66:67], v[66:67] op_sel:[0,0] op_sel_hi:[1,0]
  v_pk_fma_f32 v[42:43], v[40:41], v[40:41], v[70:71] op_sel:[1,1,0] op_sel_hi:[0,1,1] neg_lo:[1,0,0]
  v_pk_fma_f32 v[60:61], v[58:59], v[58:59], v[72:73] op_sel:[1,1,0] op_sel_hi:[0,1,1] neg_lo:[1,0,0]
  v_pk_fma_f32 v[50:51], v[48:49], v[48:49], v[74:75] op_sel:[1,1,0] op_sel_hi:[0,1,1] neg_lo:[1,0,0]
  v_pk_fma_f32 v[68:69], v[66:67], v[66:67], v[76:77] op_sel:[1,1,0] op_sel_hi:[0,1,1] neg_lo:[1,0,0]
  v_mov_b32 v94, 0x3f80
  v_mov_b32 v95, 0x3f80
  v_pk_mul_f32 v[70:71], v[42:43], v[42:43] op_sel:[0,0] op_sel_hi:[1,0]
  v_pk_mul_f32 v[72:73], v[60:61], v[60:61] op_sel:[0,0] op_sel_hi:[1,0]
  v_pk_fma_f32 v[84:85], v[42:43], v[42:43], v[70:71] op_sel:[1,1,0] op_sel_hi:[0,1,1] neg_lo:[1,0,0]
  v_pk_fma_f32 v[92:93], v[60:61], v[60:61], v[72:73] op_sel:[1,1,0] op_sel_hi:[0,1,1] neg_lo:[1,0,0]
  v_cvt_pk_bf16_f32 v96, v42, -v43
  v_cvt_pk_bf16_f32 v97, v60, -v61
  ds_write2_b64 v16, v[94:95], v[96:97] offset0:0 offset1:68
  v_pk_mul_f32 v[74:75], v[42:43], v[84:85] op_sel:[0,0] op_sel_hi:[1,0]
  v_pk_mul_f32 v[76:77], v[60:61], v[92:93] op_sel:[0,0] op_sel_hi:[1,0]
  v_pk_mul_f32 v[70:71], v[84:85], v[84:85] op_sel:[0,0] op_sel_hi:[1,0]
  v_pk_mul_f32 v[72:73], v[92:93], v[92:93] op_sel:[0,0] op_sel_hi:[1,0]
  v_pk_fma_f32 v[78:79], v[42:43], v[84:85], v[74:75] op_sel:[1,1,0] op_sel_hi:[0,1,1] neg_lo:[1,0,0]
  v_pk_fma_f32 v[86:87], v[60:61], v[92:93], v[76:77] op_sel:[1,1,0] op_sel_hi:[0,1,1] neg_lo:[1,0,0]
  v_pk_fma_f32 v[80:81], v[84:85], v[84:85], v[70:71] op_sel:[1,1,0] op_sel_hi:[0,1,1] neg_lo:[1,0,0]
  v_pk_fma_f32 v[88:89], v[92:93], v[92:93], v[72:73] op_sel:[1,1,0] op_sel_hi:[0,1,1] neg_lo:[1,0,0]
  v_cvt_pk_bf16_f32 v98, v84, -v85
  v_cvt_pk_bf16_f32 v99, v92, -v93
  v_cvt_pk_bf16_f32 v100, v78, -v79
  v_cvt_pk_bf16_f32 v101, v86, -v87
  ds_write2_b64 v16, v[98:99], v[100:101] offset0:136 offset1:204
  v_pk_mul_f32 v[74:75], v[78:79], v[84:85] op_sel:[0,0] op_sel_hi:[1,0]
  v_pk_mul_f32 v[76:77], v[86:87], v[92:93] op_sel:[0,0] op_sel_hi:[1,0]
  v_pk_fma_f32 v[78:79], v[78:79], v[84:85], v[74:75] op_sel:[1,1,0] op_sel_hi:[0,1,1] neg_lo:[1,0,0]
  v_pk_fma_f32 v[86:87], v[86:87], v[92:93], v[76:77] op_sel:[1,1,0] op_sel_hi:[0,1,1] neg_lo:[1,0,0]
  v_cvt_pk_bf16_f32 v94, v80, -v81
  v_cvt_pk_bf16_f32 v95, v88, -v89
  v_cvt_pk_bf16_f32 v96, v78, -v79
  v_cvt_pk_bf16_f32 v97, v86, -v87
  ds_write2_b64 v7, v[94:95], v[96:97] offset0:0 offset1:68
  v_pk_mul_f32 v[70:71], v[78:79], v[84:85] op_sel:[0,0] op_sel_hi:[1,0]
  v_pk_mul_f32 v[72:73], v[86:87], v[92:93] op_sel:[0,0] op_sel_hi:[1,0]
  v_pk_mul_f32 v[74:75], v[80:81], v[84:85] op_sel:[0,0] op_sel_hi:[1,0]
  v_pk_mul_f32 v[76:77], v[88:89], v[92:93] op_sel:[0,0] op_sel_hi:[1,0]
  v_pk_fma_f32 v[78:79], v[78:79], v[84:85], v[70:71] op_sel:[1,1,0] op_sel_hi:[0,1,1] neg_lo:[1,0,0]
  v_pk_fma_f32 v[86:87], v[86:87], v[92:93], v[72:73] op_sel:[1,1,0] op_sel_hi:[0,1,1] neg_lo:[1,0,0]
  v_pk_fma_f32 v[80:81], v[80:81], v[84:85], v[74:75] op_sel:[1,1,0] op_sel_hi:[0,1,1] neg_lo:[1,0,0]
  v_pk_fma_f32 v[88:89], v[88:89], v[92:93], v[76:77] op_sel:[1,1,0] op_sel_hi:[0,1,1] neg_lo:[1,0,0]
  v_cvt_pk_bf16_f32 v98, v80, -v81
  v_cvt_pk_bf16_f32 v99, v88, -v89
  v_cvt_pk_bf16_f32 v100, v78, -v79
  v_cvt_pk_bf16_f32 v101, v86, -v87
  ds_write2_b64 v7, v[98:99], v[100:101] offset0:136 offset1:204
  v_pk_mul_f32 v[70:71], v[78:79], v[84:85] op_sel:[0,0] op_sel_hi:[1,0]
  v_pk_mul_f32 v[72:73], v[86:87], v[92:93] op_sel:[0,0] op_sel_hi:[1,0]
  v_pk_mul_f32 v[74:75], v[80:81], v[84:85] op_sel:[0,0] op_sel_hi:[1,0]
  v_pk_mul_f32 v[76:77], v[88:89], v[92:93] op_sel:[0,0] op_sel_hi:[1,0]
  v_pk_fma_f32 v[78:79], v[78:79], v[84:85], v[70:71] op_sel:[1,1,0] op_sel_hi:[0,1,1] neg_lo:[1,0,0]
  v_pk_fma_f32 v[86:87], v[86:87], v[92:93], v[72:73] op_sel:[1,1,0] op_sel_hi:[0,1,1] neg_lo:[1,0,0]
  v_pk_fma_f32 v[80:81], v[80:81], v[84:85], v[74:75] op_sel:[1,1,0] op_sel_hi:[0,1,1] neg_lo:[1,0,0]
  v_pk_fma_f32 v[88:89], v[88:89], v[92:93], v[76:77] op_sel:[1,1,0] op_sel_hi:[0,1,1] neg_lo:[1,0,0]
  v_cvt_pk_bf16_f32 v94, v80, -v81
  v_cvt_pk_bf16_f32 v95, v88, -v89
  v_cvt_pk_bf16_f32 v96, v78, -v79
  v_cvt_pk_bf16_f32 v97, v86, -v87
  ds_write2_b64 v8, v[94:95], v[96:97] offset0:0 offset1:68
  v_pk_mul_f32 v[70:71], v[78:79], v[84:85] op_sel:[0,0] op_sel_hi:[1,0]
  v_pk_mul_f32 v[72:73], v[86:87], v[92:93] op_sel:[0,0] op_sel_hi:[1,0]
  v_pk_mul_f32 v[74:75], v[80:81], v[84:85] op_sel:[0,0] op_sel_hi:[1,0]
  v_pk_mul_f32 v[76:77], v[88:89], v[92:93] op_sel:[0,0] op_sel_hi:[1,0]
  v_pk_fma_f32 v[78:79], v[78:79], v[84:85], v[70:71] op_sel:[1,1,0] op_sel_hi:[0,1,1] neg_lo:[1,0,0]
  v_pk_fma_f32 v[86:87], v[86:87], v[92:93], v[72:73] op_sel:[1,1,0] op_sel_hi:[0,1,1] neg_lo:[1,0,0]
  v_pk_fma_f32 v[80:81], v[80:81], v[84:85], v[74:75] op_sel:[1,1,0] op_sel_hi:[0,1,1] neg_lo:[1,0,0]
  v_pk_fma_f32 v[88:89], v[88:89], v[92:93], v[76:77] op_sel:[1,1,0] op_sel_hi:[0,1,1] neg_lo:[1,0,0]
  v_cvt_pk_bf16_f32 v98, v80, -v81
  v_cvt_pk_bf16_f32 v99, v88, -v89
  v_cvt_pk_bf16_f32 v100, v78, -v79
  v_cvt_pk_bf16_f32 v101, v86, -v87
  ds_write2_b64 v8, v[98:99], v[100:101] offset0:136 offset1:204
  v_pk_mul_f32 v[70:71], v[78:79], v[84:85] op_sel:[0,0] op_sel_hi:[1,0]
  v_pk_mul_f32 v[72:73], v[86:87], v[92:93] op_sel:[0,0] op_sel_hi:[1,0]
  v_pk_mul_f32 v[74:75], v[80:81], v[84:85] op_sel:[0,0] op_sel_hi:[1,0]
  v_pk_mul_f32 v[76:77], v[88:89], v[92:93] op_sel:[0,0] op_sel_hi:[1,0]
  v_pk_fma_f32 v[78:79], v[78:79], v[84:85], v[70:71] op_sel:[1,1,0] op_sel_hi:[0,1,1] neg_lo:[1,0,0]
  v_pk_fma_f32 v[86:87], v[86:87], v[92:93], v[72:73] op_sel:[1,1,0] op_sel_hi:[0,1,1] neg_lo:[1,0,0]
  v_pk_fma_f32 v[80:81], v[80:81], v[84:85], v[74:75] op_sel:[1,1,0] op_sel_hi:[0,1,1] neg_lo:[1,0,0]
  v_pk_fma_f32 v[88:89], v[88:89], v[92:93], v[76:77] op_sel:[1,1,0] op_sel_hi:[0,1,1] neg_lo:[1,0,0]
  v_cvt_pk_bf16_f32 v94, v80, -v81
  v_cvt_pk_bf16_f32 v95, v88, -v89
  v_cvt_pk_bf16_f32 v96, v78, -v79
  v_cvt_pk_bf16_f32 v97, v86, -v87
  ds_write2_b64 v9, v[94:95], v[96:97] offset0:0 offset1:68
  v_pk_mul_f32 v[70:71], v[78:79], v[84:85] op_sel:[0,0] op_sel_hi:[1,0]
  v_pk_mul_f32 v[72:73], v[86:87], v[92:93] op_sel:[0,0] op_sel_hi:[1,0]
  v_pk_mul_f32 v[74:75], v[80:81], v[84:85] op_sel:[0,0] op_sel_hi:[1,0]
  v_pk_mul_f32 v[76:77], v[88:89], v[92:93] op_sel:[0,0] op_sel_hi:[1,0]
  v_pk_fma_f32 v[78:79], v[78:79], v[84:85], v[70:71] op_sel:[1,1,0] op_sel_hi:[0,1,1] neg_lo:[1,0,0]
  v_pk_fma_f32 v[86:87], v[86:87], v[92:93], v[72:73] op_sel:[1,1,0] op_sel_hi:[0,1,1] neg_lo:[1,0,0]
  v_pk_fma_f32 v[80:81], v[80:81], v[84:85], v[74:75] op_sel:[1,1,0] op_sel_hi:[0,1,1] neg_lo:[1,0,0]
  v_pk_fma_f32 v[88:89], v[88:89], v[92:93], v[76:77] op_sel:[1,1,0] op_sel_hi:[0,1,1] neg_lo:[1,0,0]
  v_cvt_pk_bf16_f32 v98, v80, -v81
  v_cvt_pk_bf16_f32 v99, v88, -v89
  v_cvt_pk_bf16_f32 v100, v78, -v79
  v_cvt_pk_bf16_f32 v101, v86, -v87
  ds_write2_b64 v9, v[98:99], v[100:101] offset0:136 offset1:204
  ds_read_b128 v[102:105], v17 offset:0
  ds_read_b128 v[106:109], v17 offset:64
  ds_read_b128 v[110:113], v17 offset:128
  ds_read_b128 v[114:117], v17 offset:192
  ds_read_b128 v[118:121], v17 offset:256
  ds_read_b128 v[122:125], v17 offset:320
  ds_read_b128 v[126:129], v17 offset:384
  ds_read_b128 v[130:133], v17 offset:448
  v_pk_mul_f32 v[70:71], v[34:35], v[44:45] op_sel:[0,0] op_sel_hi:[1,0]
  v_pk_mul_f32 v[72:73], v[52:53], v[62:63] op_sel:[0,0] op_sel_hi:[1,0]
  v_pk_mul_f32 v[74:75], v[34:35], v[36:37] op_sel:[0,0] op_sel_hi:[1,0]
  v_pk_mul_f32 v[76:77], v[52:53], v[54:55] op_sel:[0,0] op_sel_hi:[1,0]
  v_pk_fma_f32 v[80:81], v[34:35], v[44:45], v[70:71] op_sel:[1,1,0] op_sel_hi:[0,1,1] neg_lo:[1,0,0]
  v_pk_fma_f32 v[88:89], v[52:53], v[62:63], v[72:73] op_sel:[1,1,0] op_sel_hi:[0,1,1] neg_lo:[1,0,0]
  v_pk_fma_f32 v[78:79], v[34:35], v[36:37], v[74:75] op_sel:[1,1,0] op_sel_hi:[0,1,1] neg_lo:[1,0,0]
  v_pk_fma_f32 v[86:87], v[52:53], v[54:55], v[76:77] op_sel:[1,1,0] op_sel_hi:[0,1,1] neg_lo:[1,0,0]
  v_cvt_pk_bf16_f32 v94, v34, v35
  v_cvt_pk_bf16_f32 v95, v52, v53
  v_cvt_pk_bf16_f32 v96, v78, v79
  v_cvt_pk_bf16_f32 v97, v86, v87
  ds_write2_b64 v16, v[94:95], v[96:97] offset0:0 offset1:68
  v_cvt_pk_bf16_f32 v98, v80, v81
  v_cvt_pk_bf16_f32 v99, v88, v89
  v_pk_mul_f32 v[70:71], v[80:81], v[36:37] op_sel:[0,0] op_sel_hi:[1,0]
  v_pk_mul_f32 v[72:73], v[88:89], v[54:55] op_sel:[0,0] op_sel_hi:[1,0]
  v_pk_mul_f32 v[74:75], v[78:79], v[36:37] op_sel:[0,0] op_sel_hi:[1,0]
  v_pk_mul_f32 v[76:77], v[86:87], v[54:55] op_sel:[0,0] op_sel_hi:[1,0]
  v_pk_fma_f32 v[80:81], v[80:81], v[36:37], v[70:71] op_sel:[1,1,0] op_sel_hi:[0,1,1] neg_lo:[1,0,0]
  v_pk_fma_f32 v[88:89], v[88:89], v[54:55], v[72:73] op_sel:[1,1,0] op_sel_hi:[0,1,1] neg_lo:[1,0,0]
  v_pk_fma_f32 v[78:79], v[78:79], v[36:37], v[74:75] op_sel:[1,1,0] op_sel_hi:[0,1,1] neg_lo:[1,0,0]
  v_pk_fma_f32 v[86:87], v[86:87], v[54:55], v[76:77] op_sel:[1,1,0] op_sel_hi:[0,1,1] neg_lo:[1,0,0]
  v_cvt_pk_bf16_f32 v100, v80, v81
  v_cvt_pk_bf16_f32 v101, v88, v89
  ds_write2_b64 v8, v[98:99], v[100:101] offset0:0 offset1:68
  v_cvt_pk_bf16_f32 v94, v78, v79
  v_cvt_pk_bf16_f32 v95, v86, v87
  v_pk_mul_f32 v[70:71], v[78:79], v[36:37] op_sel:[0,0] op_sel_hi:[1,0]
  v_pk_mul_f32 v[72:73], v[86:87], v[54:55] op_sel:[0,0] op_sel_hi:[1,0]
  v_pk_mul_f32 v[74:75], v[80:81], v[36:37] op_sel:[0,0] op_sel_hi:[1,0]
  v_pk_mul_f32 v[76:77], v[88:89], v[54:55] op_sel:[0,0] op_sel_hi:[1,0]
  v_pk_fma_f32 v[78:79], v[78:79], v[36:37], v[70:71] op_sel:[1,1,0] op_sel_hi:[0,1,1] neg_lo:[1,0,0]
  v_pk_fma_f32 v[86:87], v[86:87], v[54:55], v[72:73] op_sel:[1,1,0] op_sel_hi:[0,1,1] neg_lo:[1,0,0]
  v_pk_fma_f32 v[80:81], v[80:81], v[36:37], v[74:75] op_sel:[1,1,0] op_sel_hi:[0,1,1] neg_lo:[1,0,0]
  v_pk_fma_f32 v[88:89], v[88:89], v[54:55], v[76:77] op_sel:[1,1,0] op_sel_hi:[0,1,1] neg_lo:[1,0,0]
  v_cvt_pk_bf16_f32 v96, v78, v79
  v_cvt_pk_bf16_f32 v97, v86, v87
  ds_write2_b64 v16, v[94:95], v[96:97] offset0:136 offset1:204
  v_cvt_pk_bf16_f32 v98, v80, v81
  v_cvt_pk_bf16_f32 v99, v88, v89
  v_pk_mul_f32 v[70:71], v[80:81], v[36:37] op_sel:[0,0] op_sel_hi:[1,0]
  v_pk_mul_f32 v[72:73], v[88:89], v[54:55] op_sel:[0,0] op_sel_hi:[1,0]
  v_pk_mul_f32 v[74:75], v[78:79], v[36:37] op_sel:[0,0] op_sel_hi:[1,0]
  v_pk_mul_f32 v[76:77], v[86:87], v[54:55] op_sel:[0,0] op_sel_hi:[1,0]
  v_pk_fma_f32 v[80:81], v[80:81], v[36:37], v[70:71] op_sel:[1,1,0] op_sel_hi:[0,1,1] neg_lo:[1,0,0]
  v_pk_fma_f32 v[88:89], v[88:89], v[54:55], v[72:73] op_sel:[1,1,0] op_sel_hi:[0,1,1] neg_lo:[1,0,0]
  v_pk_fma_f32 v[78:79], v[78:79], v[36:37], v[74:75] op_sel:[1,1,0] op_sel_hi:[0,1,1] neg_lo:[1,0,0]
  v_pk_fma_f32 v[86:87], v[86:87], v[54:55], v[76:77] op_sel:[1,1,0] op_sel_hi:[0,1,1] neg_lo:[1,0,0]
  v_cvt_pk_bf16_f32 v100, v80, v81
  v_cvt_pk_bf16_f32 v101, v88, v89
  ds_write2_b64 v8, v[98:99], v[100:101] offset0:136 offset1:204
  v_cvt_pk_bf16_f32 v94, v78, v79
  v_cvt_pk_bf16_f32 v95, v86, v87
  v_pk_mul_f32 v[70:71], v[78:79], v[36:37] op_sel:[0,0] op_sel_hi:[1,0]
  v_pk_mul_f32 v[72:73], v[86:87], v[54:55] op_sel:[0,0] op_sel_hi:[1,0]
  v_pk_mul_f32 v[74:75], v[80:81], v[36:37] op_sel:[0,0] op_sel_hi:[1,0]
  v_pk_mul_f32 v[76:77], v[88:89], v[54:55] op_sel:[0,0] op_sel_hi:[1,0]
  v_pk_fma_f32 v[78:79], v[78:79], v[36:37], v[70:71] op_sel:[1,1,0] op_sel_hi:[0,1,1] neg_lo:[1,0,0]
  v_pk_fma_f32 v[86:87], v[86:87], v[54:55], v[72:73] op_sel:[1,1,0] op_sel_hi:[0,1,1] neg_lo:[1,0,0]
  v_pk_fma_f32 v[80:81], v[80:81], v[36:37], v[74:75] op_sel:[1,1,0] op_sel_hi:[0,1,1] neg_lo:[1,0,0]
  v_pk_fma_f32 v[88:89], v[88:89], v[54:55], v[76:77] op_sel:[1,1,0] op_sel_hi:[0,1,1] neg_lo:[1,0,0]
  v_cvt_pk_bf16_f32 v96, v78, v79
  v_cvt_pk_bf16_f32 v97, v86, v87
  ds_write2_b64 v7, v[94:95], v[96:97] offset0:0 offset1:68
  v_cvt_pk_bf16_f32 v98, v80, v81
  v_cvt_pk_bf16_f32 v99, v88, v89
  v_pk_mul_f32 v[70:71], v[80:81], v[36:37] op_sel:[0,0] op_sel_hi:[1,0]
  v_pk_mul_f32 v[72:73], v[88:89], v[54:55] op_sel:[0,0] op_sel_hi:[1,0]
  v_pk_mul_f32 v[74:75], v[78:79], v[36:37] op_sel:[0,0] op_sel_hi:[1,0]
  v_pk_mul_f32 v[76:77], v[86:87], v[54:55] op_sel:[0,0] op_sel_hi:[1,0]
  v_pk_fma_f32 v[80:81], v[80:81], v[36:37], v[70:71] op_sel:[1,1,0] op_sel_hi:[0,1,1] neg_lo:[1,0,0]
  v_pk_fma_f32 v[88:89], v[88:89], v[54:55], v[72:73] op_sel:[1,1,0] op_sel_hi:[0,1,1] neg_lo:[1,0,0]
  v_pk_fma_f32 v[78:79], v[78:79], v[36:37], v[74:75] op_sel:[1,1,0] op_sel_hi:[0,1,1] neg_lo:[1,0,0]
  v_pk_fma_f32 v[86:87], v[86:87], v[54:55], v[76:77] op_sel:[1,1,0] op_sel_hi:[0,1,1] neg_lo:[1,0,0]
  v_cvt_pk_bf16_f32 v100, v80, v81
  v_cvt_pk_bf16_f32 v101, v88, v89
  ds_write2_b64 v9, v[98:99], v[100:101] offset0:0 offset1:68
  v_cvt_pk_bf16_f32 v94, v78, v79
  v_cvt_pk_bf16_f32 v95, v86, v87
  v_pk_mul_f32 v[70:71], v[78:79], v[36:37] op_sel:[0,0] op_sel_hi:[1,0]
  v_pk_mul_f32 v[72:73], v[86:87], v[54:55] op_sel:[0,0] op_sel_hi:[1,0]
  v_pk_mul_f32 v[74:75], v[80:81], v[36:37] op_sel:[0,0] op_sel_hi:[1,0]
  v_pk_mul_f32 v[76:77], v[88:89], v[54:55] op_sel:[0,0] op_sel_hi:[1,0]
  v_pk_fma_f32 v[78:79], v[78:79], v[36:37], v[70:71] op_sel:[1,1,0] op_sel_hi:[0,1,1] neg_lo:[1,0,0]
  v_pk_fma_f32 v[86:87], v[86:87], v[54:55], v[72:73] op_sel:[1,1,0] op_sel_hi:[0,1,1] neg_lo:[1,0,0]
  v_pk_fma_f32 v[80:81], v[80:81], v[36:37], v[74:75] op_sel:[1,1,0] op_sel_hi:[0,1,1] neg_lo:[1,0,0]
  v_pk_fma_f32 v[88:89], v[88:89], v[54:55], v[76:77] op_sel:[1,1,0] op_sel_hi:[0,1,1] neg_lo:[1,0,0]
  v_cvt_pk_bf16_f32 v96, v78, v79
  v_cvt_pk_bf16_f32 v97, v86, v87
  ds_write2_b64 v7, v[94:95], v[96:97] offset0:136 offset1:204
  v_cvt_pk_bf16_f32 v98, v80, v81
  v_cvt_pk_bf16_f32 v99, v88, v89
  v_pk_mul_f32 v[70:71], v[80:81], v[36:37] op_sel:[0,0] op_sel_hi:[1,0]
  v_pk_mul_f32 v[72:73], v[88:89], v[54:55] op_sel:[0,0] op_sel_hi:[1,0]
  v_pk_fma_f32 v[80:81], v[80:81], v[36:37], v[70:71] op_sel:[1,1,0] op_sel_hi:[0,1,1] neg_lo:[1,0,0]
  v_pk_fma_f32 v[88:89], v[88:89], v[54:55], v[72:73] op_sel:[1,1,0] op_sel_hi:[0,1,1] neg_lo:[1,0,0]
  v_cvt_pk_bf16_f32 v100, v80, v81
  v_cvt_pk_bf16_f32 v101, v88, v89
  ds_write2_b64 v9, v[98:99], v[100:101] offset0:136 offset1:204
  ds_read_b128 v[134:137], v17 offset:0
  ds_read_b128 v[138:141], v17 offset:64
  ds_read_b128 v[142:145], v17 offset:128
  ds_read_b128 v[146:149], v17 offset:192
  ds_read_b128 v[150:153], v17 offset:256
  ds_read_b128 v[154:157], v17 offset:320
  ds_read_b128 v[158:161], v17 offset:384
  ds_read_b128 v[162:165], v17 offset:448
  v_pk_mul_f32 v[74:75], v[34:35], v[50:51] op_sel:[0,0] op_sel_hi:[1,0]
  v_pk_mul_f32 v[76:77], v[52:53], v[68:69] op_sel:[0,0] op_sel_hi:[1,0]
  v_pk_fma_f32 v[78:79], v[34:35], v[50:51], v[74:75] op_sel:[1,1,0] op_sel_hi:[0,1,1] neg_lo:[1,0,0]
  v_pk_fma_f32 v[86:87], v[52:53], v[68:69], v[76:77] op_sel:[1,1,0] op_sel_hi:[0,1,1] neg_lo:[1,0,0]
  v_pk_mul_f32 v[70:71], v[78:79], v[44:45] op_sel:[0,0] op_sel_hi:[1,0]
  v_pk_mul_f32 v[72:73], v[86:87], v[62:63] op_sel:[0,0] op_sel_hi:[1,0]
  v_pk_fma_f32 v[80:81], v[78:79], v[44:45], v[70:71] op_sel:[1,1,0] op_sel_hi:[0,1,1] neg_lo:[1,0,0]
  v_pk_fma_f32 v[88:89], v[86:87], v[62:63], v[72:73] op_sel:[1,1,0] op_sel_hi:[0,1,1] neg_lo:[1,0,0]
  v_cvt_pk_bf16_f32 v94, v78, v79
  s_waitcnt lgkmcnt(7)
  v_mfma_f32_16x16x32_bf16 v[24:27], v[134:137], v[102:105], 0
  v_cvt_pk_bf16_f32 v95, v86, v87
  v_cvt_pk_bf16_f32 v96, v80, v81
  v_cvt_pk_bf16_f32 v97, v88, v89
  s_waitcnt lgkmcnt(6)
  v_mfma_f32_16x16x32_bf16 v[24:27], v[138:141], v[106:109], v[24:27]
  ds_write2_b64 v16, v[94:95], v[96:97] offset0:0 offset1:68
  v_pk_mul_f32 v[74:75], v[78:79], v[46:47] op_sel:[0,0] op_sel_hi:[1,0]
  v_pk_mul_f32 v[76:77], v[86:87], v[64:65] op_sel:[0,0] op_sel_hi:[1,0]
  s_waitcnt lgkmcnt(6)
  v_mfma_f32_16x16x32_bf16 v[24:27], v[142:145], v[110:113], v[24:27]
  v_pk_mul_f32 v[70:71], v[80:81], v[46:47] op_sel:[0,0] op_sel_hi:[1,0]
  v_pk_mul_f32 v[72:73], v[88:89], v[64:65] op_sel:[0,0] op_sel_hi:[1,0]
  v_pk_fma_f32 v[78:79], v[78:79], v[46:47], v[74:75] op_sel:[1,1,0] op_sel_hi:[0,1,1] neg_lo:[1,0,0]
  s_waitcnt lgkmcnt(5)
  v_mfma_f32_16x16x32_bf16 v[24:27], v[146:149], v[114:117], v[24:27]
  v_pk_fma_f32 v[86:87], v[86:87], v[64:65], v[76:77] op_sel:[1,1,0] op_sel_hi:[0,1,1] neg_lo:[1,0,0]
  v_pk_fma_f32 v[80:81], v[80:81], v[46:47], v[70:71] op_sel:[1,1,0] op_sel_hi:[0,1,1] neg_lo:[1,0,0]
  v_pk_fma_f32 v[88:89], v[88:89], v[64:65], v[72:73] op_sel:[1,1,0] op_sel_hi:[0,1,1] neg_lo:[1,0,0]
  s_waitcnt lgkmcnt(4)
  v_mfma_f32_16x16x32_bf16 v[24:27], v[150:153], v[118:121], v[24:27]
  v_cvt_pk_bf16_f32 v98, v78, v79
  v_cvt_pk_bf16_f32 v99, v86, v87
  v_cvt_pk_bf16_f32 v100, v80, v81
  s_waitcnt lgkmcnt(3)
  v_mfma_f32_16x16x32_bf16 v[24:27], v[154:157], v[122:125], v[24:27]
  v_cvt_pk_bf16_f32 v101, v88, v89
  ds_write2_b64 v16, v[98:99], v[100:101] offset0:136 offset1:204
  v_pk_mul_f32 v[74:75], v[78:79], v[46:47] op_sel:[0,0] op_sel_hi:[1,0]
  s_waitcnt lgkmcnt(3)
  v_mfma_f32_16x16x32_bf16 v[24:27], v[158:161], v[126:129], v[24:27]
  v_pk_mul_f32 v[76:77], v[86:87], v[64:65] op_sel:[0,0] op_sel_hi:[1,0]
  v_pk_mul_f32 v[70:71], v[80:81], v[46:47] op_sel:[0,0] op_sel_hi:[1,0]
  v_pk_mul_f32 v[72:73], v[88:89], v[64:65] op_sel:[0,0] op_sel_hi:[1,0]
  s_waitcnt lgkmcnt(2)
  v_mfma_f32_16x16x32_bf16 v[24:27], v[162:165], v[130:133], v[24:27]
  v_pk_fma_f32 v[78:79], v[78:79], v[46:47], v[74:75] op_sel:[1,1,0] op_sel_hi:[0,1,1] neg_lo:[1,0,0]
  v_pk_fma_f32 v[86:87], v[86:87], v[64:65], v[76:77] op_sel:[1,1,0] op_sel_hi:[0,1,1] neg_lo:[1,0,0]
  v_pk_fma_f32 v[80:81], v[80:81], v[46:47], v[70:71] op_sel:[1,1,0] op_sel_hi:[0,1,1] neg_lo:[1,0,0]
  v_pk_fma_f32 v[88:89], v[88:89], v[64:65], v[72:73] op_sel:[1,1,0] op_sel_hi:[0,1,1] neg_lo:[1,0,0]
  v_cvt_pk_bf16_f32 v94, v78, v79
  v_cvt_pk_bf16_f32 v95, v86, v87
  v_cvt_pk_bf16_f32 v96, v80, v81
  v_cvt_pk_bf16_f32 v97, v88, v89
  ds_write2_b64 v7, v[94:95], v[96:97] offset0:0 offset1:68
  v_pk_mul_f32 v[74:75], v[78:79], v[46:47] op_sel:[0,0] op_sel_hi:[1,0]
  v_pk_mul_f32 v[76:77], v[86:87], v[64:65] op_sel:[0,0] op_sel_hi:[1,0]
  v_pk_mul_f32 v[70:71], v[80:81], v[46:47] op_sel:[0,0] op_sel_hi:[1,0]
  v_pk_mul_f32 v[72:73], v[88:89], v[64:65] op_sel:[0,0] op_sel_hi:[1,0]
  v_pk_fma_f32 v[78:79], v[78:79], v[46:47], v[74:75] op_sel:[1,1,0] op_sel_hi:[0,1,1] neg_lo:[1,0,0]
  v_pk_fma_f32 v[86:87], v[86:87], v[64:65], v[76:77] op_sel:[1,1,0] op_sel_hi:[0,1,1] neg_lo:[1,0,0]
  v_pk_fma_f32 v[80:81], v[80:81], v[46:47], v[70:71] op_sel:[1,1,0] op_sel_hi:[0,1,1] neg_lo:[1,0,0]
  v_pk_fma_f32 v[88:89], v[88:89], v[64:65], v[72:73] op_sel:[1,1,0] op_sel_hi:[0,1,1] neg_lo:[1,0,0]
  v_cvt_pk_bf16_f32 v98, v78, v79
  v_cvt_pk_bf16_f32 v99, v86, v87
  v_cvt_pk_bf16_f32 v100, v80, v81
  v_cvt_pk_bf16_f32 v101, v88, v89
  ds_write2_b64 v7, v[98:99], v[100:101] offset0:136 offset1:204
  v_pk_mul_f32 v[74:75], v[78:79], v[46:47] op_sel:[0,0] op_sel_hi:[1,0]
  v_pk_mul_f32 v[76:77], v[86:87], v[64:65] op_sel:[0,0] op_sel_hi:[1,0]
  v_pk_fma_f32 v[78:79], v[78:79], v[46:47], v[74:75] op_sel:[1,1,0] op_sel_hi:[0,1,1] neg_lo:[1,0,0]
  v_pk_fma_f32 v[86:87], v[86:87], v[64:65], v[76:77] op_sel:[1,1,0] op_sel_hi:[0,1,1] neg_lo:[1,0,0]
  v_cvt_pk_bf16_f32 v94, v78, v79
  v_cvt_pk_bf16_f32 v95, v86, v87
  ds_write_b64 v8, v[94:95] offset:0
  ds_read_b128 v[134:137], v17 offset:0
  ds_read_b128 v[138:141], v17 offset:64
  ds_read_b128 v[142:145], v17 offset:128
  ds_read_b128 v[146:149], v17 offset:192
  ds_read_b128 v[150:153], v17 offset:256
  ds_read_b128 v[154:157], v17 offset:320
  ds_read_b128 v[158:161], v17 offset:384
  ds_read_b128 v[162:165], v17 offset:448
  v_add_f32 v24, v24, v21
  v_cvt_pk_bf16_f32 v10, v24, v25
  v_cvt_pk_bf16_f32 v11, v26, v27
  ds_write_b64 v20, v[10:11]
  v_pk_mul_f32 v[70:71], v[34:35], v[46:47] op_sel:[0,0] op_sel_hi:[1,0]
  v_pk_mul_f32 v[72:73], v[52:53], v[64:65] op_sel:[0,0] op_sel_hi:[1,0]
  v_pk_mul_f32 v[74:75], v[34:35], v[48:49] op_sel:[0,0] op_sel_hi:[1,0]
  v_pk_mul_f32 v[76:77], v[52:53], v[66:67] op_sel:[0,0] op_sel_hi:[1,0]
  v_pk_fma_f32 v[78:79], v[34:35], v[46:47], v[70:71] op_sel:[1,1,0] op_sel_hi:[0,1,1] neg_lo:[1,0,0]
  v_pk_fma_f32 v[86:87], v[52:53], v[64:65], v[72:73] op_sel:[1,1,0] op_sel_hi:[0,1,1] neg_lo:[1,0,0]
  v_pk_fma_f32 v[82:83], v[34:35], v[48:49], v[74:75] op_sel:[1,1,0] op_sel_hi:[0,1,1] neg_lo:[1,0,0]
  s_waitcnt lgkmcnt(8)
  v_mfma_f32_16x16x32_bf16 v[24:27], v[102:105], v[134:137], 0
  v_pk_fma_f32 v[90:91], v[52:53], v[66:67], v[76:77] op_sel:[1,1,0] op_sel_hi:[0,1,1] neg_lo:[1,0,0]
  v_pk_mul_f32 v[70:71], v[78:79], v[44:45] op_sel:[0,0] op_sel_hi:[1,0]
  v_pk_mul_f32 v[72:73], v[86:87], v[62:63] op_sel:[0,0] op_sel_hi:[1,0]
  s_waitcnt lgkmcnt(7)
  v_mfma_f32_16x16x32_bf16 v[24:27], v[106:109], v[138:141], v[24:27]
  v_pk_mul_f32 v[74:75], v[82:83], v[40:41] op_sel:[0,0] op_sel_hi:[1,0]
  v_pk_mul_f32 v[76:77], v[90:91], v[58:59] op_sel:[0,0] op_sel_hi:[1,0]
  v_pk_fma_f32 v[80:81], v[78:79], v[44:45], v[70:71] op_sel:[1,1,0] op_sel_hi:[0,1,1] neg_lo:[1,0,0]
  s_waitcnt lgkmcnt(6)
  v_mfma_f32_16x16x32_bf16 v[24:27], v[110:113], v[142:145], v[24:27]
  v_pk_fma_f32 v[88:89], v[86:87], v[62:63], v[72:73] op_sel:[1,1,0] op_sel_hi:[0,1,1] neg_lo:[1,0,0]
  v_pk_fma_f32 v[84:85], v[82:83], v[40:41], v[74:75] op_sel:[1,1,0] op_sel_hi:[0,1,1] neg_lo:[1,0,0]
  v_pk_fma_f32 v[92:93], v[90:91], v[58:59], v[76:77] op_sel:[1,1,0] op_sel_hi:[0,1,1] neg_lo:[1,0,0]
  s_waitcnt lgkmcnt(5)
  v_mfma_f32_16x16x32_bf16 v[24:27], v[114:117], v[146:149], v[24:27]
  v_cvt_pk_bf16_f32 v98, v82, v83
  v_cvt_pk_bf16_f32 v99, v90, v91
  v_cvt_pk_bf16_f32 v100, v84, v85
  s_waitcnt lgkmcnt(4)
  v_mfma_f32_16x16x32_bf16 v[24:27], v[118:121], v[150:153], v[24:27]
  v_cvt_pk_bf16_f32 v101, v92, v93
  ds_write2_b64 v8, v[98:99], v[100:101] offset0:0 offset1:68
  v_cvt_pk_bf16_f32 v94, v78, v79
  s_waitcnt lgkmcnt(4)
  v_mfma_f32_16x16x32_bf16 v[24:27], v[122:125], v[154:157], v[24:27]
  v_cvt_pk_bf16_f32 v95, v86, v87
  v_cvt_pk_bf16_f32 v96, v80, v81
  v_cvt_pk_bf16_f32 v97, v88, v89
  s_waitcnt lgkmcnt(3)
  v_mfma_f32_16x16x32_bf16 v[24:27], v[126:129], v[158:161], v[24:27]
  v_pk_mul_f32 v[70:71], v[78:79], v[38:39] op_sel:[0,0] op_sel_hi:[1,0]
  v_pk_mul_f32 v[72:73], v[86:87], v[56:57] op_sel:[0,0] op_sel_hi:[1,0]
  v_pk_mul_f32 v[74:75], v[80:81], v[38:39] op_sel:[0,0] op_sel_hi:[1,0]
  s_waitcnt lgkmcnt(2)
  v_mfma_f32_16x16x32_bf16 v[24:27], v[130:133], v[162:165], v[24:27]
  v_pk_mul_f32 v[76:77], v[88:89], v[56:57] op_sel:[0,0] op_sel_hi:[1,0]
  v_pk_fma_f32 v[78:79], v[78:79], v[38:39], v[70:71] op_sel:[1,1,0] op_sel_hi:[0,1,1] neg_lo:[1,0,0]
  v_pk_fma_f32 v[86:87], v[86:87], v[56:57], v[72:73] op_sel:[1,1,0] op_sel_hi:[0,1,1] neg_lo:[1,0,0]
  v_pk_fma_f32 v[80:81], v[80:81], v[38:39], v[74:75] op_sel:[1,1,0] op_sel_hi:[0,1,1] neg_lo:[1,0,0]
  v_pk_fma_f32 v[88:89], v[88:89], v[56:57], v[76:77] op_sel:[1,1,0] op_sel_hi:[0,1,1] neg_lo:[1,0,0]
  v_cvt_pk_bf16_f32 v98, v78, v79
  v_cvt_pk_bf16_f32 v99, v86, v87
  v_cvt_pk_bf16_f32 v100, v80, v81
  v_cvt_pk_bf16_f32 v101, v88, v89
  ds_write2_b64 v16, v[94:95], v[98:99] offset0:0 offset1:68
  ds_write2_b64 v7, v[96:97], v[100:101] offset0:0 offset1:68
  v_pk_mul_f32 v[70:71], v[82:83], v[44:45] op_sel:[0,0] op_sel_hi:[1,0]
  v_pk_mul_f32 v[72:73], v[90:91], v[62:63] op_sel:[0,0] op_sel_hi:[1,0]
  v_pk_fma_f32 v[82:83], v[82:83], v[44:45], v[70:71] op_sel:[1,1,0] op_sel_hi:[0,1,1] neg_lo:[1,0,0]
  v_pk_fma_f32 v[90:91], v[90:91], v[62:63], v[72:73] op_sel:[1,1,0] op_sel_hi:[0,1,1] neg_lo:[1,0,0]
  v_cvt_pk_bf16_f32 v12, v24, v25
  v_pk_mul_f32 v[74:75], v[82:83], v[40:41] op_sel:[0,0] op_sel_hi:[1,0]
  v_pk_mul_f32 v[76:77], v[90:91], v[58:59] op_sel:[0,0] op_sel_hi:[1,0]
  v_cvt_pk_bf16_f32 v13, v26, v27
  v_pk_fma_f32 v[84:85], v[82:83], v[40:41], v[74:75] op_sel:[1,1,0] op_sel_hi:[0,1,1] neg_lo:[1,0,0]
  v_pk_fma_f32 v[92:93], v[90:91], v[58:59], v[76:77] op_sel:[1,1,0] op_sel_hi:[0,1,1] neg_lo:[1,0,0]
  ds_write_b64 v6, v[12:13] offset:512
  v_cvt_pk_bf16_f32 v98, v82, v83
  v_cvt_pk_bf16_f32 v99, v90, v91
  v_lshl_add_u32 v14, v1, 1, s62
  v_cvt_pk_bf16_f32 v100, v84, v85
  v_cvt_pk_bf16_f32 v101, v92, v93
  ds_read_u16 v10, v14 offset:512
  ds_write2_b64 v8, v[98:99], v[100:101] offset0:136 offset1:204
  v_pk_mul_f32 v[70:71], v[78:79], v[38:39] op_sel:[0,0] op_sel_hi:[1,0]
  ds_read_u16 v11, v14 offset:514
  v_pk_mul_f32 v[72:73], v[86:87], v[56:57] op_sel:[0,0] op_sel_hi:[1,0]
  v_pk_mul_f32 v[74:75], v[80:81], v[38:39] op_sel:[0,0] op_sel_hi:[1,0]
  ds_read_u16 v12, v14 offset:640
  v_pk_mul_f32 v[76:77], v[88:89], v[56:57] op_sel:[0,0] op_sel_hi:[1,0]
  v_pk_fma_f32 v[78:79], v[78:79], v[38:39], v[70:71] op_sel:[1,1,0] op_sel_hi:[0,1,1] neg_lo:[1,0,0]
  ds_read_u16 v13, v14 offset:642
  v_pk_fma_f32 v[86:87], v[86:87], v[56:57], v[72:73] op_sel:[1,1,0] op_sel_hi:[0,1,1] neg_lo:[1,0,0]
  v_pk_fma_f32 v[80:81], v[80:81], v[38:39], v[74:75] op_sel:[1,1,0] op_sel_hi:[0,1,1] neg_lo:[1,0,0]
  v_and_b32 v22, 1, v1
  v_pk_fma_f32 v[88:89], v[88:89], v[56:57], v[76:77] op_sel:[1,1,0] op_sel_hi:[0,1,1] neg_lo:[1,0,0]
  v_cvt_pk_bf16_f32 v94, v78, v79
  v_mov_b32 v23, 0x05040100
  v_cvt_pk_bf16_f32 v95, v86, v87
  v_cvt_pk_bf16_f32 v96, v80, v81
  v_mov_b32 v32, 0x05040504
  v_cvt_pk_bf16_f32 v97, v88, v89
  v_pk_mul_f32 v[70:71], v[82:83], v[44:45] op_sel:[0,0] op_sel_hi:[1,0]
  v_cmp_eq_u32 vcc, 1, v22
  v_pk_mul_f32 v[72:73], v[90:91], v[62:63] op_sel:[0,0] op_sel_hi:[1,0]
  v_pk_fma_f32 v[82:83], v[82:83], v[44:45], v[70:71] op_sel:[1,1,0] op_sel_hi:[0,1,1] neg_lo:[1,0,0]
  v_lshl_add_u32 v15, v1, 4, s61
  v_pk_fma_f32 v[90:91], v[90:91], v[62:63], v[72:73] op_sel:[1,1,0] op_sel_hi:[0,1,1] neg_lo:[1,0,0]
  v_pk_mul_f32 v[74:75], v[82:83], v[40:41] op_sel:[0,0] op_sel_hi:[1,0]
  v_cndmask_b32 v23, v23, v32, vcc
  v_pk_mul_f32 v[76:77], v[90:91], v[58:59] op_sel:[0,0] op_sel_hi:[1,0]
  v_pk_fma_f32 v[84:85], v[82:83], v[40:41], v[74:75] op_sel:[1,1,0] op_sel_hi:[0,1,1] neg_lo:[1,0,0]
  s_waitcnt lgkmcnt(4)
  v_perm_b32 v28, v10, v10, s48
  v_pk_fma_f32 v[92:93], v[90:91], v[58:59], v[76:77] op_sel:[1,1,0] op_sel_hi:[0,1,1] neg_lo:[1,0,0]
  v_cvt_pk_bf16_f32 v98, v82, v83
  s_waitcnt lgkmcnt(2)
  v_perm_b32 v30, v11, v10, v23
  v_cvt_pk_bf16_f32 v99, v90, v91
  v_cvt_pk_bf16_f32 v100, v84, v85
  v_mov_b32 v29, v28
  v_cvt_pk_bf16_f32 v101, v92, v93
  ds_write2_b64 v9, v[98:99], v[100:101] offset0:0 offset1:68
  v_perm_b32 v31, v11, v11, s48
  v_pk_mul_f32 v[70:71], v[78:79], v[38:39] op_sel:[0,0] op_sel_hi:[1,0]
  v_pk_mul_f32 v[72:73], v[86:87], v[56:57] op_sel:[0,0] op_sel_hi:[1,0]
  ds_write_b128 v15, v[28:31] offset:2048
  v_pk_mul_f32 v[74:75], v[80:81], v[38:39] op_sel:[0,0] op_sel_hi:[1,0]
  v_pk_mul_f32 v[76:77], v[88:89], v[56:57] op_sel:[0,0] op_sel_hi:[1,0]
  s_waitcnt lgkmcnt(3)
  v_perm_b32 v28, v12, v12, s48
  v_pk_fma_f32 v[78:79], v[78:79], v[38:39], v[70:71] op_sel:[1,1,0] op_sel_hi:[0,1,1] neg_lo:[1,0,0]
  v_pk_fma_f32 v[86:87], v[86:87], v[56:57], v[72:73] op_sel:[1,1,0] op_sel_hi:[0,1,1] neg_lo:[1,0,0]
  s_waitcnt lgkmcnt(2)
  v_perm_b32 v30, v13, v12, v23
  v_pk_fma_f32 v[80:81], v[80:81], v[38:39], v[74:75] op_sel:[1,1,0] op_sel_hi:[0,1,1] neg_lo:[1,0,0]
  v_pk_fma_f32 v[88:89], v[88:89], v[56:57], v[76:77] op_sel:[1,1,0] op_sel_hi:[0,1,1] neg_lo:[1,0,0]
  v_mov_b32 v29, v28
  v_cvt_pk_bf16_f32 v98, v78, v79
  v_cvt_pk_bf16_f32 v99, v86, v87
  v_perm_b32 v31, v13, v13, s48
  v_cvt_pk_bf16_f32 v100, v80, v81
  v_cvt_pk_bf16_f32 v101, v88, v89
  ds_write_b128 v15, v[28:31] offset:3072
  ds_write2_b64 v16, v[94:95], v[98:99] offset0:136 offset1:204
  ds_write2_b64 v7, v[96:97], v[100:101] offset0:136 offset1:204
  v_pk_mul_f32 v[70:71], v[82:83], v[44:45] op_sel:[0,0] op_sel_hi:[1,0]
  v_pk_mul_f32 v[72:73], v[90:91], v[62:63] op_sel:[0,0] op_sel_hi:[1,0]
  v_pk_fma_f32 v[82:83], v[82:83], v[44:45], v[70:71] op_sel:[1,1,0] op_sel_hi:[0,1,1] neg_lo:[1,0,0]
  v_pk_fma_f32 v[90:91], v[90:91], v[62:63], v[72:73] op_sel:[1,1,0] op_sel_hi:[0,1,1] neg_lo:[1,0,0]
  v_pk_mul_f32 v[74:75], v[82:83], v[40:41] op_sel:[0,0] op_sel_hi:[1,0]
  v_pk_mul_f32 v[76:77], v[90:91], v[58:59] op_sel:[0,0] op_sel_hi:[1,0]
  v_pk_fma_f32 v[84:85], v[82:83], v[40:41], v[74:75] op_sel:[1,1,0] op_sel_hi:[0,1,1] neg_lo:[1,0,0]
  v_pk_fma_f32 v[92:93], v[90:91], v[58:59], v[76:77] op_sel:[1,1,0] op_sel_hi:[0,1,1] neg_lo:[1,0,0]
  v_cvt_pk_bf16_f32 v98, v82, v83
  v_cvt_pk_bf16_f32 v99, v90, v91
  v_cvt_pk_bf16_f32 v100, v84, v85
  v_cvt_pk_bf16_f32 v101, v92, v93
  ds_write2_b64 v9, v[98:99], v[100:101] offset0:136 offset1:204
  ds_read_b128 v[134:137], v17 offset:0
  ds_read_b128 v[138:141], v17 offset:64
  ds_read_b128 v[142:145], v17 offset:128
  ds_read_b128 v[146:149], v17 offset:192
  ds_read_b128 v[150:153], v17 offset:256
  ds_read_b128 v[154:157], v17 offset:320
  ds_read_b128 v[158:161], v17 offset:384
  ds_read_b128 v[162:165], v17 offset:448
  v_and_b32 v34, 31, v1
  v_lshl_add_u32 v35, v34, 3, s62
  v_lshl_add_u32 v36, v34, 4, s61
  v_lshl_add_u32 v37, v1, 2, s62
  v_lshl_add_u32 v38, v1, 4, s61
  s_waitcnt lgkmcnt(7)
  v_mfma_f32_16x16x32_bf16 v[28:31], v[134:137], v[102:105], 0
  s_waitcnt lgkmcnt(6)
  v_mfma_f32_16x16x32_bf16 v[28:31], v[138:141], v[106:109], v[28:31]
  s_waitcnt lgkmcnt(5)
  v_mfma_f32_16x16x32_bf16 v[28:31], v[142:145], v[110:113], v[28:31]
  s_waitcnt lgkmcnt(4)
  v_mfma_f32_16x16x32_bf16 v[28:31], v[146:149], v[114:117], v[28:31]
  s_waitcnt lgkmcnt(3)
  v_mfma_f32_16x16x32_bf16 v[28:31], v[150:153], v[118:121], v[28:31]
  s_waitcnt lgkmcnt(2)
  v_mfma_f32_16x16x32_bf16 v[28:31], v[154:157], v[122:125], v[28:31]
  s_waitcnt lgkmcnt(1)
  v_mfma_f32_16x16x32_bf16 v[28:31], v[158:161], v[126:129], v[28:31]
  s_waitcnt lgkmcnt(0)
  v_mfma_f32_16x16x32_bf16 v[28:31], v[162:165], v[130:133], v[28:31]
  s_nop 7
  v_cvt_pk_bf16_f32 v40, v28, v29
  v_cvt_pk_bf16_f32 v41, v30, v31
  ds_write_b32 v18, v40
  ds_write_b32 v19, v41
  ds_read_b64 v[78:79], v35
  ds_read_b32 v80, v35 offset:8
  ds_read2_b32 v[82:83], v37 offset0:64 offset1:65
  ds_read_b64_tr_b16 v[16:17], v2 offset:0
  ds_read_b64_tr_b16 v[18:19], v2 offset:32
  ds_read_b64_tr_b16 v[20:21], v2 offset:256
  ds_read_b64_tr_b16 v[22:23], v2 offset:288
  s_waitcnt lgkmcnt(6)
  v_perm_b32 v88, v78, v78, s48
  v_perm_b32 v89, v79, v78, s50
  v_perm_b32 v90, v79, v79, s48
  s_waitcnt lgkmcnt(5)
  v_perm_b32 v91, v80, v79, s50
  ds_write_b128 v36, v[88:91] offset:512
  s_waitcnt lgkmcnt(5)
  v_perm_b32 v92, v82, v82, s48
  v_mov_b32 v93, v82
  v_perm_b32 v94, v82, v82, s49
  v_perm_b32 v95, v83, v83, s48
  ds_write_b128 v38, v[92:95] offset:1024
  ds_read_b64_tr_b16 v[24:25], v2 offset:512
  ds_read_b64_tr_b16 v[26:27], v2 offset:544
  ds_read_b64_tr_b16 v[28:29], v2 offset:768
  ds_read_b64_tr_b16 v[30:31], v2 offset:800
  ds_read_b64_tr_b16 v[32:33], v2 offset:1024
  ds_read_b64_tr_b16 v[34:35], v2 offset:1056
  ds_read_b64_tr_b16 v[36:37], v2 offset:1280
  ds_read_b64_tr_b16 v[38:39], v2 offset:1312
  ds_read_b64_tr_b16 v[40:41], v2 offset:1536
  ds_read_b64_tr_b16 v[42:43], v2 offset:1568
  ds_read_b64_tr_b16 v[44:45], v2 offset:1792
  ds_read_b64_tr_b16 v[46:47], v2 offset:1824
  v_mov_b32 v10, 0
  v_mov_b32 v11, 0
  v_mov_b32 v12, 0
  v_mov_b32 v13, 0
  v_mov_b32 v14, 0
  v_mov_b32 v15, 0
  s_waitcnt lgkmcnt(0)
  s_barrier
  s_setprio 0
  ds_read_b64 v[144:145], v3 offset:960
  ds_read_b64 v[146:147], v3 offset:968
  ds_read_b64 v[148:149], v3 offset:2112
  ds_read_b64 v[150:151], v3 offset:2120
  ds_read_b64 v[152:153], v3 offset:3264
  ds_read_b64 v[154:155], v3 offset:3272
  ds_read_b64 v[156:157], v3 offset:4416
  ds_read_b64 v[158:159], v3 offset:4424
  ds_read_b64 v[160:161], v3 offset:896
  ds_read_b64 v[162:163], v3 offset:904
  s_waitcnt lgkmcnt(8)
  v_mfma_f32_16x16x32_bf16 v[80:83], v[20:23], v[144:147], 0
  v_mfma_f32_16x16x32_bf16 v[96:99], v[28:31], v[144:147], 0
  v_mfma_f32_16x16x32_bf16 v[112:115], v[36:39], v[144:147], 0
  v_mfma_f32_16x16x32_bf16 v[128:131], v[44:47], v[144:147], 0
  ds_read_b64 v[144:145], v3 offset:2048
  ds_read_b64 v[146:147], v3 offset:2056
  s_waitcnt lgkmcnt(8)
  v_mfma_f32_16x16x32_bf16 v[84:87], v[20:23], v[148:151], 0
  v_mfma_f32_16x16x32_bf16 v[100:103], v[28:31], v[148:151], 0
  v_mfma_f32_16x16x32_bf16 v[116:119], v[36:39], v[148:151], 0
  v_mfma_f32_16x16x32_bf16 v[132:135], v[44:47], v[148:151], 0
  ds_read_b64 v[148:149], v3 offset:3200
  ds_read_b64 v[150:151], v3 offset:3208
  s_waitcnt lgkmcnt(8)
  v_mfma_f32_16x16x32_bf16 v[88:91], v[20:23], v[152:155], 0
  v_mfma_f32_16x16x32_bf16 v[104:107], v[28:31], v[152:155], 0
  v_mfma_f32_16x16x32_bf16 v[120:123], v[36:39], v[152:155], 0
  v_mfma_f32_16x16x32_bf16 v[136:139], v[44:47], v[152:155], 0
  ds_read_b64 v[152:153], v3 offset:4352
  ds_read_b64 v[154:155], v3 offset:4360
  s_waitcnt lgkmcnt(8)
  v_mfma_f32_16x16x32_bf16 v[92:95], v[20:23], v[156:159], 0
  v_mfma_f32_16x16x32_bf16 v[108:111], v[28:31], v[156:159], 0
  v_mfma_f32_16x16x32_bf16 v[124:127], v[36:39], v[156:159], 0
  v_mfma_f32_16x16x32_bf16 v[140:143], v[44:47], v[156:159], 0
  ds_read_b64 v[156:157], v3 offset:832
  ds_read_b64 v[158:159], v3 offset:840
  s_waitcnt lgkmcnt(8)
  v_mfma_f32_16x16x32_bf16 v[80:83], v[16:19], v[160:163], v[80:83]
  v_mfma_f32_16x16x32_bf16 v[96:99], v[24:27], v[160:163], v[96:99]
  v_mfma_f32_16x16x32_bf16 v[112:115], v[32:35], v[160:163], v[112:115]
  v_mfma_f32_16x16x32_bf16 v[128:131], v[40:43], v[160:163], v[128:131]
  ds_read_b64 v[160:161], v3 offset:1984
  ds_read_b64 v[162:163], v3 offset:1992
  s_waitcnt lgkmcnt(8)
  v_mfma_f32_16x16x32_bf16 v[84:87], v[16:19], v[144:147], v[84:87]
  v_mfma_f32_16x16x32_bf16 v[100:103], v[24:27], v[144:147], v[100:103]
  v_mfma_f32_16x16x32_bf16 v[116:119], v[32:35], v[144:147], v[116:119]
  v_mfma_f32_16x16x32_bf16 v[132:135], v[40:43], v[144:147], v[132:135]
  ds_read_b64 v[144:145], v3 offset:3136
  ds_read_b64 v[146:147], v3 offset:3144
  s_waitcnt lgkmcnt(8)
  v_mfma_f32_16x16x32_bf16 v[88:91], v[16:19], v[148:151], v[88:91]
  v_mfma_f32_16x16x32_bf16 v[104:107], v[24:27], v[148:151], v[104:107]
  v_mfma_f32_16x16x32_bf16 v[120:123], v[32:35], v[148:151], v[120:123]
  v_mfma_f32_16x16x32_bf16 v[136:139], v[40:43], v[148:151], v[136:139]
  ds_read_b64 v[148:149], v3 offset:4288
  ds_read_b64 v[150:151], v3 offset:4296
  s_waitcnt lgkmcnt(8)
  v_mfma_f32_16x16x32_bf16 v[92:95], v[16:19], v[152:155], v[92:95]
  v_mfma_f32_16x16x32_bf16 v[108:111], v[24:27], v[152:155], v[108:111]
  ds_read_b64_tr_b16 v[48:49], v2 offset:2048
  v_mfma_f32_16x16x32_bf16 v[124:127], v[32:35], v[152:155], v[124:127]
  ds_read_b64_tr_b16 v[50:51], v2 offset:2080
  v_mfma_f32_16x16x32_bf16 v[140:143], v[40:43], v[152:155], v[140:143]
  ds_read_b64_tr_b16 v[52:53], v2 offset:2304
  ds_read_b64 v[152:153], v3 offset:768
  ds_read_b64 v[154:155], v3 offset:776
  s_waitcnt lgkmcnt(11)
  v_mfma_f32_16x16x32_bf16 v[96:99], v[20:23], v[156:159], v[96:99]
  ds_read_b64_tr_b16 v[54:55], v2 offset:2336
  v_mfma_f32_16x16x32_bf16 v[112:115], v[28:31], v[156:159], v[112:115]
  ds_read_b64_tr_b16 v[56:57], v2 offset:2560
  v_mfma_f32_16x16x32_bf16 v[128:131], v[36:39], v[156:159], v[128:131]
  ds_read_b64_tr_b16 v[58:59], v2 offset:2592
  ds_read_b64 v[156:157], v3 offset:1920
  ds_read_b64 v[158:159], v3 offset:1928
  s_waitcnt lgkmcnt(14)
  v_mfma_f32_16x16x32_bf16 v[100:103], v[20:23], v[160:163], v[100:103]
  ds_read_b64_tr_b16 v[60:61], v2 offset:2816
  v_mfma_f32_16x16x32_bf16 v[116:119], v[28:31], v[160:163], v[116:119]
  ds_read_b64_tr_b16 v[62:63], v2 offset:2848
  v_mfma_f32_16x16x32_bf16 v[132:135], v[36:39], v[160:163], v[132:135]
  ds_read_b64_tr_b16 v[64:65], v2 offset:3072
  ds_read_b64 v[160:161], v3 offset:3072
  ds_read_b64 v[162:163], v3 offset:3080
  s_waitcnt lgkmcnt(15)
  v_mfma_f32_16x16x32_bf16 v[104:107], v[20:23], v[144:147], v[104:107]
  ds_read_b64_tr_b16 v[66:67], v2 offset:3104
  v_mfma_f32_16x16x32_bf16 v[120:123], v[28:31], v[144:147], v[120:123]
  ds_read_b64_tr_b16 v[68:69], v2 offset:3328
  v_mfma_f32_16x16x32_bf16 v[136:139], v[36:39], v[144:147], v[136:139]
  ds_read_b64_tr_b16 v[70:71], v2 offset:3360
  ds_read_b64 v[144:145], v3 offset:4224
  ds_read_b64 v[146:147], v3 offset:4232
  v_mfma_f32_16x16x32_bf16 v[108:111], v[20:23], v[148:151], v[108:111]
  ds_read_b64_tr_b16 v[72:73], v2 offset:3584
  v_mfma_f32_16x16x32_bf16 v[124:127], v[28:31], v[148:151], v[124:127]
  ds_read_b64_tr_b16 v[74:75], v2 offset:3616
  v_mfma_f32_16x16x32_bf16 v[140:143], v[36:39], v[148:151], v[140:143]
  ds_read_b64_tr_b16 v[76:77], v2 offset:3840
  ds_read_b64 v[148:149], v3 offset:704
  ds_read_b64 v[150:151], v3 offset:712
  s_waitcnt lgkmcnt(15)
  v_mfma_f32_16x16x32_bf16 v[96:99], v[16:19], v[152:155], v[96:99]
  ds_read_b64_tr_b16 v[78:79], v2 offset:3872
  v_mfma_f32_16x16x32_bf16 v[112:115], v[24:27], v[152:155], v[112:115]
  v_add_f32 v8, v87, v90
  v_mfma_f32_16x16x32_bf16 v[128:131], v[32:35], v[152:155], v[128:131]
  v_add_f32 v81, v81, v84
  ds_read_b64 v[152:153], v3 offset:1856
  ds_read_b64 v[154:155], v3 offset:1864
  v_mfma_f32_16x16x32_bf16 v[100:103], v[16:19], v[156:159], v[100:103]
  v_add_f32 v8, v8, v93
  v_mfma_f32_16x16x32_bf16 v[116:119], v[24:27], v[156:159], v[116:119]
  v_add_f32 v82, v82, v85
  v_mfma_f32_16x16x32_bf16 v[132:135], v[32:35], v[156:159], v[132:135]
  v_add_f32 v9, v91, v94
  ds_read_b64 v[156:157], v3 offset:3008
  ds_read_b64 v[158:159], v3 offset:3016
  s_waitcnt lgkmcnt(15)
  v_mfma_f32_16x16x32_bf16 v[104:107], v[16:19], v[160:163], v[104:107]
  ds_bpermute_b32 v10, v5, v8
  v_mfma_f32_16x16x32_bf16 v[120:123], v[24:27], v[160:163], v[120:123]
  ds_bpermute_b32 v11, v5, v9
  v_mfma_f32_16x16x32_bf16 v[136:139], v[32:35], v[160:163], v[136:139]
  ds_bpermute_b32 v12, v5, v95
  ds_read_b64 v[160:161], v3 offset:4160
  ds_read_b64 v[162:163], v3 offset:4168
  s_waitcnt lgkmcnt(15)
  v_mfma_f32_16x16x32_bf16 v[108:111], v[16:19], v[144:147], v[108:111]
  v_add_f32 v83, v83, v86
  v_mfma_f32_16x16x32_bf16 v[124:127], v[24:27], v[144:147], v[124:127]
  v_add_f32 v82, v82, v88
  v_mfma_f32_16x16x32_bf16 v[140:143], v[32:35], v[144:147], v[140:143]
  v_add_f32 v83, v83, v89
  ds_read_b64 v[144:145], v3 offset:640
  ds_read_b64 v[146:147], v3 offset:648
  s_waitcnt lgkmcnt(12)
  v_mfma_f32_16x16x32_bf16 v[112:115], v[20:23], v[148:151], v[112:115]
  v_add_f32 v83, v83, v92
  v_mfma_f32_16x16x32_bf16 v[128:131], v[28:31], v[148:151], v[128:131]
  s_waitcnt lgkmcnt(6)
  v_cndmask_b32 v13, v10, v13, s[40:41]
  s_waitcnt lgkmcnt(5)
  v_cndmask_b32 v14, v11, v14, s[40:41]
  s_waitcnt lgkmcnt(4)
  v_cndmask_b32 v15, v12, v15, s[40:41]
  v_add_f32 v80, v80, v13
  v_add_f32 v81, v81, v14
  v_add_f32 v82, v82, v15
  v_cvt_pk_bf16_f32 v6, v80, v81
  v_cvt_pk_bf16_f32 v7, v82, v83
  ds_write_b64 v4, v[6:7] offset:0
  v_mfma_f32_16x16x32_bf16 v[80:83], v[36:39], v[148:151], 0
  v_add_f32 v8, v103, v106
  ds_read_b64 v[148:149], v3 offset:1792
  ds_read_b64 v[150:151], v3 offset:1800
  v_mfma_f32_16x16x32_bf16 v[116:119], v[20:23], v[152:155], v[116:119]
  v_add_f32 v97, v97, v100
  v_mfma_f32_16x16x32_bf16 v[132:135], v[28:31], v[152:155], v[132:135]
  v_add_f32 v8, v8, v109
  v_mfma_f32_16x16x32_bf16 v[84:87], v[36:39], v[152:155], 0
  v_add_f32 v98, v98, v101
  ds_read_b64 v[152:153], v3 offset:2944
  ds_read_b64 v[154:155], v3 offset:2952
  v_mfma_f32_16x16x32_bf16 v[120:123], v[20:23], v[156:159], v[120:123]
  v_add_f32 v9, v107, v110
  v_mfma_f32_16x16x32_bf16 v[136:139], v[28:31], v[156:159], v[136:139]
  ds_bpermute_b32 v13, v5, v8
  v_mfma_f32_16x16x32_bf16 v[88:91], v[36:39], v[156:159], 0
  ds_bpermute_b32 v14, v5, v9
  ds_read_b64 v[156:157], v3 offset:4096
  ds_read_b64 v[158:159], v3 offset:4104
  s_waitcnt lgkmcnt(11)
  v_mfma_f32_16x16x32_bf16 v[124:127], v[20:23], v[160:163], v[124:127]
  ds_bpermute_b32 v15, v5, v111
  v_mfma_f32_16x16x32_bf16 v[140:143], v[28:31], v[160:163], v[140:143]
  v_add_f32 v99, v99, v102
  v_mfma_f32_16x16x32_bf16 v[92:95], v[36:39], v[160:163], 0
  v_add_f32 v98, v98, v104
  ds_read_b64 v[160:161], v3 offset:576
  ds_read_b64 v[162:163], v3 offset:584
  s_waitcnt lgkmcnt(12)
  v_mfma_f32_16x16x32_bf16 v[112:115], v[16:19], v[144:147], v[112:115]
  v_add_f32 v99, v99, v105
  v_mfma_f32_16x16x32_bf16 v[128:131], v[24:27], v[144:147], v[128:131]
  v_add_f32 v99, v99, v108
  v_mfma_f32_16x16x32_bf16 v[80:83], v[32:35], v[144:147], v[80:83]
  ds_read_b64 v[144:145], v3 offset:1728
  ds_read_b64 v[146:147], v3 offset:1736
  s_waitcnt lgkmcnt(11)
  v_mfma_f32_16x16x32_bf16 v[116:119], v[16:19], v[148:151], v[116:119]
  v_mfma_f32_16x16x32_bf16 v[132:135], v[24:27], v[148:151], v[132:135]
  v_mfma_f32_16x16x32_bf16 v[84:87], v[32:35], v[148:151], v[84:87]
  s_waitcnt lgkmcnt(8)
  v_cndmask_b32 v10, v13, v10, s[40:41]
  ds_read_b64 v[148:149], v3 offset:2880
  ds_read_b64 v[150:151], v3 offset:2888
  v_mfma_f32_16x16x32_bf16 v[120:123], v[16:19], v[152:155], v[120:123]
  s_waitcnt lgkmcnt(9)
  v_cndmask_b32 v11, v14, v11, s[40:41]
  v_mfma_f32_16x16x32_bf16 v[136:139], v[24:27], v[152:155], v[136:139]
  s_waitcnt lgkmcnt(6)
  v_cndmask_b32 v12, v15, v12, s[40:41]
  v_mfma_f32_16x16x32_bf16 v[88:91], v[32:35], v[152:155], v[88:91]
  v_add_f32 v96, v96, v10
  ds_read_b64 v[152:153], v3 offset:4032
  ds_read_b64 v[154:155], v3 offset:4040
  v_mfma_f32_16x16x32_bf16 v[124:127], v[16:19], v[156:159], v[124:127]
  v_add_f32 v97, v97, v11
  v_mfma_f32_16x16x32_bf16 v[140:143], v[24:27], v[156:159], v[140:143]
  v_add_f32 v98, v98, v12
  v_mfma_f32_16x16x32_bf16 v[92:95], v[32:35], v[156:159], v[92:95]
  v_cvt_pk_bf16_f32 v6, v96, v97
  ds_read_b64 v[156:157], v3 offset:512
  ds_read_b64 v[158:159], v3 offset:520
  s_waitcnt lgkmcnt(8)
  v_mfma_f32_16x16x32_bf16 v[128:131], v[20:23], v[160:163], v[128:131]
  v_cvt_pk_bf16_f32 v7, v98, v99
  v_mfma_f32_16x16x32_bf16 v[80:83], v[28:31], v[160:163], v[80:83]
  ds_write_b64 v4, v[6:7] offset:576
  v_mfma_f32_16x16x32_bf16 v[96:99], v[36:39], v[160:163], 0
  v_add_f32 v8, v119, v122
  ds_read_b64 v[160:161], v3 offset:1664
  ds_read_b64 v[162:163], v3 offset:1672
  s_waitcnt lgkmcnt(9)
  v_mfma_f32_16x16x32_bf16 v[132:135], v[20:23], v[144:147], v[132:135]
  v_add_f32 v113, v113, v116
  v_mfma_f32_16x16x32_bf16 v[84:87], v[28:31], v[144:147], v[84:87]
  v_add_f32 v8, v8, v125
  v_mfma_f32_16x16x32_bf16 v[100:103], v[36:39], v[144:147], 0
  v_add_f32 v114, v114, v117
  ds_read_b64 v[144:145], v3 offset:2816
  ds_read_b64 v[146:147], v3 offset:2824
  s_waitcnt lgkmcnt(9)
  v_mfma_f32_16x16x32_bf16 v[136:139], v[20:23], v[148:151], v[136:139]
  v_add_f32 v9, v123, v126
  v_mfma_f32_16x16x32_bf16 v[88:91], v[28:31], v[148:151], v[88:91]
  ds_bpermute_b32 v10, v5, v8
  v_mfma_f32_16x16x32_bf16 v[104:107], v[36:39], v[148:151], 0
  ds_bpermute_b32 v11, v5, v9
  ds_read_b64 v[148:149], v3 offset:3968
  ds_read_b64 v[150:151], v3 offset:3976
  s_waitcnt lgkmcnt(11)
  v_mfma_f32_16x16x32_bf16 v[140:143], v[20:23], v[152:155], v[140:143]
  ds_bpermute_b32 v12, v5, v127
  v_mfma_f32_16x16x32_bf16 v[92:95], v[28:31], v[152:155], v[92:95]
  v_add_f32 v115, v115, v118
  v_mfma_f32_16x16x32_bf16 v[108:111], v[36:39], v[152:155], 0
  v_add_f32 v114, v114, v120
  ds_read_b64 v[152:153], v3 offset:960
  ds_read_b64 v[154:155], v3 offset:968
  s_waitcnt lgkmcnt(12)
  v_mfma_f32_16x16x32_bf16 v[128:131], v[16:19], v[156:159], v[128:131]
  v_add_f32 v115, v115, v121
  v_mfma_f32_16x16x32_bf16 v[80:83], v[24:27], v[156:159], v[80:83]
  v_add_f32 v115, v115, v124
  v_mfma_f32_16x16x32_bf16 v[96:99], v[32:35], v[156:159], v[96:99]
  ds_read_b64 v[156:157], v3 offset:2112
  ds_read_b64 v[158:159], v3 offset:2120
  s_waitcnt lgkmcnt(11)
  v_mfma_f32_16x16x32_bf16 v[132:135], v[16:19], v[160:163], v[132:135]
  v_mfma_f32_16x16x32_bf16 v[84:87], v[24:27], v[160:163], v[84:87]
  v_mfma_f32_16x16x32_bf16 v[100:103], v[32:35], v[160:163], v[100:103]
  s_waitcnt lgkmcnt(8)
  v_cndmask_b32 v13, v10, v13, s[40:41]
  ds_read_b64 v[160:161], v3 offset:3264
  ds_read_b64 v[162:163], v3 offset:3272
  v_mfma_f32_16x16x32_bf16 v[136:139], v[16:19], v[144:147], v[136:139]
  s_waitcnt lgkmcnt(9)
  v_cndmask_b32 v14, v11, v14, s[40:41]
  v_mfma_f32_16x16x32_bf16 v[88:91], v[24:27], v[144:147], v[88:91]
  s_waitcnt lgkmcnt(6)
  v_cndmask_b32 v15, v12, v15, s[40:41]
  v_mfma_f32_16x16x32_bf16 v[104:107], v[32:35], v[144:147], v[104:107]
  v_add_f32 v112, v112, v13
  ds_read_b64 v[144:145], v3 offset:4416
  ds_read_b64 v[146:147], v3 offset:4424
  v_mfma_f32_16x16x32_bf16 v[140:143], v[16:19], v[148:151], v[140:143]
  v_add_f32 v113, v113, v14
  v_mfma_f32_16x16x32_bf16 v[92:95], v[24:27], v[148:151], v[92:95]
  v_add_f32 v114, v114, v15
  v_mfma_f32_16x16x32_bf16 v[108:111], v[32:35], v[148:151], v[108:111]
  v_cvt_pk_bf16_f32 v6, v112, v113
  ds_read_b64 v[148:149], v3 offset:896
  ds_read_b64 v[150:151], v3 offset:904
  s_waitcnt lgkmcnt(8)
  v_mfma_f32_16x16x32_bf16 v[80:83], v[52:55], v[152:155], v[80:83]
  v_cvt_pk_bf16_f32 v7, v114, v115
  v_mfma_f32_16x16x32_bf16 v[96:99], v[60:63], v[152:155], v[96:99]
  ds_write_b64 v4, v[6:7] offset:1152
  v_mfma_f32_16x16x32_bf16 v[112:115], v[68:71], v[152:155], 0
  v_add_f32 v8, v135, v138
  ds_read_b64 v[152:153], v3 offset:2048
  ds_read_b64 v[154:155], v3 offset:2056
  s_waitcnt lgkmcnt(9)
  v_mfma_f32_16x16x32_bf16 v[84:87], v[52:55], v[156:159], v[84:87]
  v_add_f32 v129, v129, v132
  v_mfma_f32_16x16x32_bf16 v[100:103], v[60:63], v[156:159], v[100:103]
  v_add_f32 v8, v8, v141
  v_mfma_f32_16x16x32_bf16 v[116:119], v[68:71], v[156:159], 0
  v_add_f32 v130, v130, v133
  ds_read_b64 v[156:157], v3 offset:3200
  ds_read_b64 v[158:159], v3 offset:3208
  s_waitcnt lgkmcnt(9)
  v_mfma_f32_16x16x32_bf16 v[88:91], v[52:55], v[160:163], v[88:91]
  v_add_f32 v9, v139, v142
  v_mfma_f32_16x16x32_bf16 v[104:107], v[60:63], v[160:163], v[104:107]
  ds_bpermute_b32 v13, v5, v8
  v_mfma_f32_16x16x32_bf16 v[120:123], v[68:71], v[160:163], 0
  ds_bpermute_b32 v14, v5, v9
  ds_read_b64 v[160:161], v3 offset:4352
  ds_read_b64 v[162:163], v3 offset:4360
  s_waitcnt lgkmcnt(11)
  v_mfma_f32_16x16x32_bf16 v[92:95], v[52:55], v[144:147], v[92:95]
  ds_bpermute_b32 v15, v5, v143
  v_mfma_f32_16x16x32_bf16 v[108:111], v[60:63], v[144:147], v[108:111]
  v_add_f32 v131, v131, v134
  v_mfma_f32_16x16x32_bf16 v[124:127], v[68:71], v[144:147], 0
  v_add_f32 v130, v130, v136
  ds_read_b64 v[144:145], v3 offset:832
  ds_read_b64 v[146:147], v3 offset:840
  s_waitcnt lgkmcnt(12)
  v_mfma_f32_16x16x32_bf16 v[80:83], v[48:51], v[148:151], v[80:83]
  v_add_f32 v131, v131, v137
  v_mfma_f32_16x16x32_bf16 v[96:99], v[56:59], v[148:151], v[96:99]
  v_add_f32 v131, v131, v140
  v_mfma_f32_16x16x32_bf16 v[112:115], v[64:67], v[148:151], v[112:115]
  ds_read_b64 v[148:149], v3 offset:1984
  ds_read_b64 v[150:151], v3 offset:1992
  s_waitcnt lgkmcnt(11)
  v_mfma_f32_16x16x32_bf16 v[84:87], v[48:51], v[152:155], v[84:87]
  v_mfma_f32_16x16x32_bf16 v[100:103], v[56:59], v[152:155], v[100:103]
  v_mfma_f32_16x16x32_bf16 v[116:119], v[64:67], v[152:155], v[116:119]
  s_waitcnt lgkmcnt(8)
  v_cndmask_b32 v10, v13, v10, s[40:41]
  ds_read_b64 v[152:153], v3 offset:3136
  ds_read_b64 v[154:155], v3 offset:3144
  v_mfma_f32_16x16x32_bf16 v[88:91], v[48:51], v[156:159], v[88:91]
  s_waitcnt lgkmcnt(9)
  v_cndmask_b32 v11, v14, v11, s[40:41]
  v_mfma_f32_16x16x32_bf16 v[104:107], v[56:59], v[156:159], v[104:107]
  s_waitcnt lgkmcnt(6)
  v_cndmask_b32 v12, v15, v12, s[40:41]
  v_mfma_f32_16x16x32_bf16 v[120:123], v[64:67], v[156:159], v[120:123]
  v_add_f32 v128, v128, v10
  ds_read_b64 v[156:157], v3 offset:4288
  ds_read_b64 v[158:159], v3 offset:4296
  v_mfma_f32_16x16x32_bf16 v[92:95], v[48:51], v[160:163], v[92:95]
  v_add_f32 v129, v129, v11
  v_mfma_f32_16x16x32_bf16 v[108:111], v[56:59], v[160:163], v[108:111]
  v_add_f32 v130, v130, v12
  v_mfma_f32_16x16x32_bf16 v[124:127], v[64:67], v[160:163], v[124:127]
  v_cvt_pk_bf16_f32 v6, v128, v129
  ds_read_b64 v[160:161], v3 offset:768
  ds_read_b64 v[162:163], v3 offset:776
  s_waitcnt lgkmcnt(8)
  v_mfma_f32_16x16x32_bf16 v[80:83], v[44:47], v[144:147], v[80:83]
  v_cvt_pk_bf16_f32 v7, v130, v131
  v_mfma_f32_16x16x32_bf16 v[96:99], v[52:55], v[144:147], v[96:99]
  ds_write_b64 v4, v[6:7] offset:1728
  v_mfma_f32_16x16x32_bf16 v[112:115], v[60:63], v[144:147], v[112:115]
  s_waitcnt lgkmcnt(0)
  s_barrier
  v_mfma_f32_16x16x32_bf16 v[128:131], v[68:71], v[144:147], 0
  ds_read_b64 v[144:145], v3 offset:1920
  ds_read_b64 v[146:147], v3 offset:1928
  v_mfma_f32_16x16x32_bf16 v[84:87], v[44:47], v[148:151], v[84:87]
  v_mfma_f32_16x16x32_bf16 v[100:103], v[52:55], v[148:151], v[100:103]
  v_mfma_f32_16x16x32_bf16 v[116:119], v[60:63], v[148:151], v[116:119]
  v_mfma_f32_16x16x32_bf16 v[132:135], v[68:71], v[148:151], 0
  ds_read_b64 v[148:149], v3 offset:3072
  ds_read_b64 v[150:151], v3 offset:3080
  v_mfma_f32_16x16x32_bf16 v[88:91], v[44:47], v[152:155], v[88:91]
  v_mfma_f32_16x16x32_bf16 v[104:107], v[52:55], v[152:155], v[104:107]
  v_mfma_f32_16x16x32_bf16 v[120:123], v[60:63], v[152:155], v[120:123]
  v_mfma_f32_16x16x32_bf16 v[136:139], v[68:71], v[152:155], 0
  ds_read_b64 v[152:153], v3 offset:4224
  ds_read_b64 v[154:155], v3 offset:4232
  v_mfma_f32_16x16x32_bf16 v[92:95], v[44:47], v[156:159], v[92:95]
  v_mfma_f32_16x16x32_bf16 v[108:111], v[52:55], v[156:159], v[108:111]
  v_mfma_f32_16x16x32_bf16 v[124:127], v[60:63], v[156:159], v[124:127]
  v_mfma_f32_16x16x32_bf16 v[140:143], v[68:71], v[156:159], 0
  ds_read_b64 v[156:157], v3 offset:704
  ds_read_b64 v[158:159], v3 offset:712
  v_mfma_f32_16x16x32_bf16 v[80:83], v[40:43], v[160:163], v[80:83]
  v_mfma_f32_16x16x32_bf16 v[96:99], v[48:51], v[160:163], v[96:99]
  v_mfma_f32_16x16x32_bf16 v[112:115], v[56:59], v[160:163], v[112:115]
  v_mfma_f32_16x16x32_bf16 v[128:131], v[64:67], v[160:163], v[128:131]
  ds_read_b64 v[160:161], v3 offset:960
  ds_read_b64 v[162:163], v3 offset:968
  s_waitcnt lgkmcnt(8)
  v_mfma_f32_16x16x32_bf16 v[84:87], v[40:43], v[144:147], v[84:87]
  v_mfma_f32_16x16x32_bf16 v[100:103], v[48:51], v[144:147], v[100:103]
  v_mfma_f32_16x16x32_bf16 v[116:119], v[56:59], v[144:147], v[116:119]
  v_mfma_f32_16x16x32_bf16 v[132:135], v[64:67], v[144:147], v[132:135]
  ds_read_b64 v[144:145], v3 offset:1856
  ds_read_b64 v[146:147], v3 offset:1864
  s_waitcnt lgkmcnt(8)
  v_mfma_f32_16x16x32_bf16 v[88:91], v[40:43], v[148:151], v[88:91]
  v_mfma_f32_16x16x32_bf16 v[104:107], v[48:51], v[148:151], v[104:107]
  v_mfma_f32_16x16x32_bf16 v[120:123], v[56:59], v[148:151], v[120:123]
  v_mfma_f32_16x16x32_bf16 v[136:139], v[64:67], v[148:151], v[136:139]
  ds_read_b64 v[148:149], v3 offset:3008
  ds_read_b64 v[150:151], v3 offset:3016
  s_waitcnt lgkmcnt(8)
  v_mfma_f32_16x16x32_bf16 v[92:95], v[40:43], v[152:155], v[92:95]
  v_mfma_f32_16x16x32_bf16 v[108:111], v[48:51], v[152:155], v[108:111]
  v_mfma_f32_16x16x32_bf16 v[124:127], v[56:59], v[152:155], v[124:127]
  v_mfma_f32_16x16x32_bf16 v[140:143], v[64:67], v[152:155], v[140:143]
  ds_read_b64 v[152:153], v3 offset:2112
  ds_read_b64 v[154:155], v3 offset:2120
  s_waitcnt lgkmcnt(8)
  v_mfma_f32_16x16x32_bf16 v[96:99], v[44:47], v[156:159], v[96:99]
  v_mfma_f32_16x16x32_bf16 v[112:115], v[52:55], v[156:159], v[112:115]
  v_mfma_f32_16x16x32_bf16 v[128:131], v[60:63], v[156:159], v[128:131]
  ds_read_b64 v[156:157], v3 offset:4160
  ds_read_b64 v[158:159], v3 offset:4168
  s_waitcnt lgkmcnt(8)
  v_mfma_f32_16x16x32_bf16 v[128:131], v[76:79], v[160:163], v[128:131]
  ds_read_b64 v[160:161], v3 offset:640
  ds_read_b64 v[162:163], v3 offset:648
  s_waitcnt lgkmcnt(8)
  v_mfma_f32_16x16x32_bf16 v[100:103], v[44:47], v[144:147], v[100:103]
  v_mfma_f32_16x16x32_bf16 v[116:119], v[52:55], v[144:147], v[116:119]
  v_mfma_f32_16x16x32_bf16 v[132:135], v[60:63], v[144:147], v[132:135]
  ds_read_b64 v[144:145], v3 offset:3264
  ds_read_b64 v[146:147], v3 offset:3272
  s_waitcnt lgkmcnt(8)
  v_mfma_f32_16x16x32_bf16 v[104:107], v[44:47], v[148:151], v[104:107]
  v_mfma_f32_16x16x32_bf16 v[120:123], v[52:55], v[148:151], v[120:123]
  v_mfma_f32_16x16x32_bf16 v[136:139], v[60:63], v[148:151], v[136:139]
  ds_read_b64 v[148:149], v3 offset:1792
  ds_read_b64 v[150:151], v3 offset:1800
  s_waitcnt lgkmcnt(8)
  v_mfma_f32_16x16x32_bf16 v[132:135], v[76:79], v[152:155], v[132:135]
  ds_read_b64 v[152:153], v3 offset:2944
  ds_read_b64 v[154:155], v3 offset:2952
  s_waitcnt lgkmcnt(8)
  v_mfma_f32_16x16x32_bf16 v[108:111], v[44:47], v[156:159], v[108:111]
  v_mfma_f32_16x16x32_bf16 v[124:127], v[52:55], v[156:159], v[124:127]
  v_mfma_f32_16x16x32_bf16 v[140:143], v[60:63], v[156:159], v[140:143]
  ds_read_b64 v[156:157], v3 offset:4416
  ds_read_b64 v[158:159], v3 offset:4424
  s_waitcnt lgkmcnt(8)
  v_mfma_f32_16x16x32_bf16 v[96:99], v[40:43], v[160:163], v[96:99]
  v_mfma_f32_16x16x32_bf16 v[112:115], v[48:51], v[160:163], v[112:115]
  v_mfma_f32_16x16x32_bf16 v[128:131], v[56:59], v[160:163], v[128:131]
  ds_read_b64 v[160:161], v3 offset:4096
  ds_read_b64 v[162:163], v3 offset:4104
  s_waitcnt lgkmcnt(8)
  v_mfma_f32_16x16x32_bf16 v[136:139], v[76:79], v[144:147], v[136:139]
  ds_read_b64 v[144:145], v3 offset:576
  ds_read_b64 v[146:147], v3 offset:584
  s_waitcnt lgkmcnt(8)
  v_mfma_f32_16x16x32_bf16 v[100:103], v[40:43], v[148:151], v[100:103]
  v_mfma_f32_16x16x32_bf16 v[116:119], v[48:51], v[148:151], v[116:119]
  v_mfma_f32_16x16x32_bf16 v[132:135], v[56:59], v[148:151], v[132:135]
  ds_read_b64 v[148:149], v3 offset:896
  ds_read_b64 v[150:151], v3 offset:904
  s_waitcnt lgkmcnt(8)
  v_mfma_f32_16x16x32_bf16 v[104:107], v[40:43], v[152:155], v[104:107]
  v_mfma_f32_16x16x32_bf16 v[120:123], v[48:51], v[152:155], v[120:123]
  v_mfma_f32_16x16x32_bf16 v[136:139], v[56:59], v[152:155], v[136:139]
  ds_read_b64 v[152:153], v3 offset:1728
  ds_read_b64 v[154:155], v3 offset:1736
  s_waitcnt lgkmcnt(8)
  v_mfma_f32_16x16x32_bf16 v[140:143], v[76:79], v[156:159], v[140:143]
  ds_read_b64 v[156:157], v3 offset:2880
  ds_read_b64 v[158:159], v3 offset:2888
  s_waitcnt lgkmcnt(8)
  v_mfma_f32_16x16x32_bf16 v[108:111], v[40:43], v[160:163], v[108:111]
  v_mfma_f32_16x16x32_bf16 v[124:127], v[48:51], v[160:163], v[124:127]
  v_mfma_f32_16x16x32_bf16 v[140:143], v[56:59], v[160:163], v[140:143]
  ds_read_b64 v[160:161], v3 offset:2048
  ds_read_b64 v[162:163], v3 offset:2056
  s_waitcnt lgkmcnt(8)
  v_mfma_f32_16x16x32_bf16 v[112:115], v[44:47], v[144:147], v[112:115]
  v_mfma_f32_16x16x32_bf16 v[128:131], v[52:55], v[144:147], v[128:131]
  ds_read_b64 v[144:145], v3 offset:4032
  ds_read_b64 v[146:147], v3 offset:4040
  s_waitcnt lgkmcnt(8)
  v_mfma_f32_16x16x32_bf16 v[128:131], v[72:75], v[148:151], v[128:131]
  ds_read_b64 v[148:149], v3 offset:512
  ds_read_b64 v[150:151], v3 offset:520
  s_waitcnt lgkmcnt(8)
  v_mfma_f32_16x16x32_bf16 v[116:119], v[44:47], v[152:155], v[116:119]
  v_mfma_f32_16x16x32_bf16 v[132:135], v[52:55], v[152:155], v[132:135]
  ds_read_b64 v[152:153], v3 offset:3200
  ds_read_b64 v[154:155], v3 offset:3208
  s_waitcnt lgkmcnt(8)
  v_mfma_f32_16x16x32_bf16 v[120:123], v[44:47], v[156:159], v[120:123]
  v_mfma_f32_16x16x32_bf16 v[136:139], v[52:55], v[156:159], v[136:139]
  ds_read_b64 v[156:157], v3 offset:1664
  ds_read_b64 v[158:159], v3 offset:1672
  s_waitcnt lgkmcnt(8)
  v_mfma_f32_16x16x32_bf16 v[132:135], v[72:75], v[160:163], v[132:135]
  ds_read_b64 v[160:161], v3 offset:2816
  ds_read_b64 v[162:163], v3 offset:2824
  s_waitcnt lgkmcnt(8)
  v_mfma_f32_16x16x32_bf16 v[124:127], v[44:47], v[144:147], v[124:127]
  v_mfma_f32_16x16x32_bf16 v[140:143], v[52:55], v[144:147], v[140:143]
  ds_read_b64 v[144:145], v3 offset:4352
  ds_read_b64 v[146:147], v3 offset:4360
  s_waitcnt lgkmcnt(8)
  v_mfma_f32_16x16x32_bf16 v[112:115], v[40:43], v[148:151], v[112:115]
  v_mfma_f32_16x16x32_bf16 v[128:131], v[48:51], v[148:151], v[128:131]
  ds_read_b64 v[148:149], v3 offset:3968
  ds_read_b64 v[150:151], v3 offset:3976
  s_waitcnt lgkmcnt(8)
  v_mfma_f32_16x16x32_bf16 v[136:139], v[72:75], v[152:155], v[136:139]
  ds_read_b64 v[152:153], v3 offset:448
  ds_read_b64 v[154:155], v3 offset:456
  s_waitcnt lgkmcnt(8)
  v_mfma_f32_16x16x32_bf16 v[116:119], v[40:43], v[156:159], v[116:119]
  v_mfma_f32_16x16x32_bf16 v[132:135], v[48:51], v[156:159], v[132:135]
  ds_read_b64 v[156:157], v3 offset:1600
  ds_read_b64 v[158:159], v3 offset:1608
  s_waitcnt lgkmcnt(8)
  v_mfma_f32_16x16x32_bf16 v[120:123], v[40:43], v[160:163], v[120:123]
  v_mfma_f32_16x16x32_bf16 v[136:139], v[48:51], v[160:163], v[136:139]
  ds_read_b64 v[160:161], v3 offset:2752
  ds_read_b64 v[162:163], v3 offset:2760
  s_waitcnt lgkmcnt(8)
  v_mfma_f32_16x16x32_bf16 v[140:143], v[72:75], v[144:147], v[140:143]
  ds_read_b64 v[144:145], v3 offset:3904
  ds_read_b64 v[146:147], v3 offset:3912
  s_waitcnt lgkmcnt(8)
  v_mfma_f32_16x16x32_bf16 v[124:127], v[40:43], v[148:151], v[124:127]
  v_mfma_f32_16x16x32_bf16 v[140:143], v[48:51], v[148:151], v[140:143]
  ds_read_b64 v[148:149], v3 offset:384
  ds_read_b64 v[150:151], v3 offset:392
  s_waitcnt lgkmcnt(8)
  v_mfma_f32_16x16x32_bf16 v[80:83], v[20:23], v[152:155], v[80:83]
  v_mfma_f32_16x16x32_bf16 v[96:99], v[28:31], v[152:155], v[96:99]
  v_mfma_f32_16x16x32_bf16 v[112:115], v[36:39], v[152:155], v[112:115]
  v_mfma_f32_16x16x32_bf16 v[128:131], v[44:47], v[152:155], v[128:131]
  ds_read_b64 v[152:153], v3 offset:1536
  ds_read_b64 v[154:155], v3 offset:1544
  s_waitcnt lgkmcnt(8)
  v_mfma_f32_16x16x32_bf16 v[84:87], v[20:23], v[156:159], v[84:87]
  v_mfma_f32_16x16x32_bf16 v[100:103], v[28:31], v[156:159], v[100:103]
  v_mfma_f32_16x16x32_bf16 v[116:119], v[36:39], v[156:159], v[116:119]
  v_mfma_f32_16x16x32_bf16 v[132:135], v[44:47], v[156:159], v[132:135]
  ds_read_b64 v[156:157], v3 offset:2688
  ds_read_b64 v[158:159], v3 offset:2696
  s_waitcnt lgkmcnt(8)
  v_mfma_f32_16x16x32_bf16 v[88:91], v[20:23], v[160:163], v[88:91]
  v_mfma_f32_16x16x32_bf16 v[104:107], v[28:31], v[160:163], v[104:107]
  v_mfma_f32_16x16x32_bf16 v[120:123], v[36:39], v[160:163], v[120:123]
  v_mfma_f32_16x16x32_bf16 v[136:139], v[44:47], v[160:163], v[136:139]
  ds_read_b64 v[160:161], v3 offset:3840
  ds_read_b64 v[162:163], v3 offset:3848
  s_waitcnt lgkmcnt(8)
  v_mfma_f32_16x16x32_bf16 v[92:95], v[20:23], v[144:147], v[92:95]
  v_mfma_f32_16x16x32_bf16 v[108:111], v[28:31], v[144:147], v[108:111]
  v_mfma_f32_16x16x32_bf16 v[124:127], v[36:39], v[144:147], v[124:127]
  v_mfma_f32_16x16x32_bf16 v[140:143], v[44:47], v[144:147], v[140:143]
  ds_read_b64 v[144:145], v3 offset:320
  ds_read_b64 v[146:147], v3 offset:328
  s_waitcnt lgkmcnt(8)
  v_mfma_f32_16x16x32_bf16 v[80:83], v[16:19], v[148:151], v[80:83]
  v_mfma_f32_16x16x32_bf16 v[96:99], v[24:27], v[148:151], v[96:99]
  v_mfma_f32_16x16x32_bf16 v[112:115], v[32:35], v[148:151], v[112:115]
  v_mfma_f32_16x16x32_bf16 v[128:131], v[40:43], v[148:151], v[128:131]
  ds_read_b64 v[148:149], v3 offset:1472
  ds_read_b64 v[150:151], v3 offset:1480
  s_waitcnt lgkmcnt(8)
  v_mfma_f32_16x16x32_bf16 v[84:87], v[16:19], v[152:155], v[84:87]
  v_mfma_f32_16x16x32_bf16 v[100:103], v[24:27], v[152:155], v[100:103]
  v_mfma_f32_16x16x32_bf16 v[116:119], v[32:35], v[152:155], v[116:119]
  v_mfma_f32_16x16x32_bf16 v[132:135], v[40:43], v[152:155], v[132:135]
  ds_read_b64 v[152:153], v3 offset:2624
  ds_read_b64 v[154:155], v3 offset:2632
  s_waitcnt lgkmcnt(8)
  v_mfma_f32_16x16x32_bf16 v[88:91], v[16:19], v[156:159], v[88:91]
  v_mfma_f32_16x16x32_bf16 v[104:107], v[24:27], v[156:159], v[104:107]
  v_mfma_f32_16x16x32_bf16 v[120:123], v[32:35], v[156:159], v[120:123]
  v_mfma_f32_16x16x32_bf16 v[136:139], v[40:43], v[156:159], v[136:139]
  ds_read_b64 v[156:157], v3 offset:3776
  ds_read_b64 v[158:159], v3 offset:3784
  s_waitcnt lgkmcnt(8)
  v_mfma_f32_16x16x32_bf16 v[92:95], v[16:19], v[160:163], v[92:95]
  v_mfma_f32_16x16x32_bf16 v[108:111], v[24:27], v[160:163], v[108:111]
  v_mfma_f32_16x16x32_bf16 v[124:127], v[32:35], v[160:163], v[124:127]
  v_mfma_f32_16x16x32_bf16 v[140:143], v[40:43], v[160:163], v[140:143]
  ds_read_b64 v[160:161], v3 offset:256
  ds_read_b64 v[162:163], v3 offset:264
  s_waitcnt lgkmcnt(8)
  v_mfma_f32_16x16x32_bf16 v[96:99], v[20:23], v[144:147], v[96:99]
  v_add_f32 v8, v87, v90
  v_mfma_f32_16x16x32_bf16 v[112:115], v[28:31], v[144:147], v[112:115]
  v_add_f32 v81, v81, v84
  v_mfma_f32_16x16x32_bf16 v[128:131], v[36:39], v[144:147], v[128:131]
  v_add_f32 v8, v8, v93
  ds_read_b64 v[144:145], v3 offset:1408
  ds_read_b64 v[146:147], v3 offset:1416
  s_waitcnt lgkmcnt(8)
  v_mfma_f32_16x16x32_bf16 v[100:103], v[20:23], v[148:151], v[100:103]
  v_add_f32 v82, v82, v85
  v_mfma_f32_16x16x32_bf16 v[116:119], v[28:31], v[148:151], v[116:119]
  v_add_f32 v9, v91, v94
  v_mfma_f32_16x16x32_bf16 v[132:135], v[36:39], v[148:151], v[132:135]
  ds_bpermute_b32 v10, v5, v8
  ds_read_b64 v[148:149], v3 offset:2560
  ds_read_b64 v[150:151], v3 offset:2568
  s_waitcnt lgkmcnt(9)
  v_mfma_f32_16x16x32_bf16 v[104:107], v[20:23], v[152:155], v[104:107]
  ds_bpermute_b32 v11, v5, v9
  v_mfma_f32_16x16x32_bf16 v[120:123], v[28:31], v[152:155], v[120:123]
  ds_bpermute_b32 v12, v5, v95
  v_mfma_f32_16x16x32_bf16 v[136:139], v[36:39], v[152:155], v[136:139]
  v_add_f32 v83, v83, v86
  ds_read_b64 v[152:153], v3 offset:3712
  ds_read_b64 v[154:155], v3 offset:3720
  s_waitcnt lgkmcnt(11)
  v_mfma_f32_16x16x32_bf16 v[108:111], v[20:23], v[156:159], v[108:111]
  v_add_f32 v82, v82, v88
  v_mfma_f32_16x16x32_bf16 v[124:127], v[28:31], v[156:159], v[124:127]
  v_add_f32 v83, v83, v89
  v_mfma_f32_16x16x32_bf16 v[140:143], v[36:39], v[156:159], v[140:143]
  v_add_f32 v83, v83, v92
  ds_read_b64 v[156:157], v3 offset:192
  ds_read_b64 v[158:159], v3 offset:200
  s_waitcnt lgkmcnt(11)
  v_mfma_f32_16x16x32_bf16 v[96:99], v[16:19], v[160:163], v[96:99]
  v_mfma_f32_16x16x32_bf16 v[112:115], v[24:27], v[160:163], v[112:115]
  v_mfma_f32_16x16x32_bf16 v[128:131], v[32:35], v[160:163], v[128:131]
  ds_read_b64 v[160:161], v3 offset:1344
  ds_read_b64 v[162:163], v3 offset:1352
  s_waitcnt lgkmcnt(11)
  v_mfma_f32_16x16x32_bf16 v[100:103], v[16:19], v[144:147], v[100:103]
  s_waitcnt lgkmcnt(10)
  v_cndmask_b32 v13, v10, v13, s[40:41]
  v_mfma_f32_16x16x32_bf16 v[116:119], v[24:27], v[144:147], v[116:119]
  s_waitcnt lgkmcnt(7)
  v_cndmask_b32 v14, v11, v14, s[40:41]
  v_mfma_f32_16x16x32_bf16 v[132:135], v[32:35], v[144:147], v[132:135]
  s_waitcnt lgkmcnt(6)
  v_cndmask_b32 v15, v12, v15, s[40:41]
  ds_read_b64 v[144:145], v3 offset:2496
  ds_read_b64 v[146:147], v3 offset:2504
  v_mfma_f32_16x16x32_bf16 v[104:107], v[16:19], v[148:151], v[104:107]
  v_add_f32 v80, v80, v13
  v_mfma_f32_16x16x32_bf16 v[120:123], v[24:27], v[148:151], v[120:123]
  v_add_f32 v81, v81, v14
  v_mfma_f32_16x16x32_bf16 v[136:139], v[32:35], v[148:151], v[136:139]
  v_add_f32 v82, v82, v15
  ds_read_b64 v[148:149], v3 offset:3648
  ds_read_b64 v[150:151], v3 offset:3656
  s_waitcnt lgkmcnt(8)
  v_mfma_f32_16x16x32_bf16 v[108:111], v[16:19], v[152:155], v[108:111]
  v_cvt_pk_bf16_f32 v6, v80, v81
  v_mfma_f32_16x16x32_bf16 v[124:127], v[24:27], v[152:155], v[124:127]
  v_cvt_pk_bf16_f32 v7, v82, v83
  v_mfma_f32_16x16x32_bf16 v[140:143], v[32:35], v[152:155], v[140:143]
  ds_write_b64 v4, v[6:7] offset:2304
  ds_read_b64 v[152:153], v3 offset:128
  ds_read_b64 v[154:155], v3 offset:136
  s_waitcnt lgkmcnt(9)
  v_mfma_f32_16x16x32_bf16 v[112:115], v[20:23], v[156:159], v[112:115]
  v_add_f32 v8, v103, v106
  v_mfma_f32_16x16x32_bf16 v[128:131], v[28:31], v[156:159], v[128:131]
  v_add_f32 v97, v97, v100
  ds_read_b64 v[156:157], v3 offset:1280
  ds_read_b64 v[158:159], v3 offset:1288
  s_waitcnt lgkmcnt(9)
  v_mfma_f32_16x16x32_bf16 v[116:119], v[20:23], v[160:163], v[116:119]
  v_add_f32 v8, v8, v109
  v_mfma_f32_16x16x32_bf16 v[132:135], v[28:31], v[160:163], v[132:135]
  v_add_f32 v98, v98, v101
  ds_read_b64 v[160:161], v3 offset:2432
  ds_read_b64 v[162:163], v3 offset:2440
  s_waitcnt lgkmcnt(9)
  v_mfma_f32_16x16x32_bf16 v[120:123], v[20:23], v[144:147], v[120:123]
  v_add_f32 v9, v107, v110
  v_mfma_f32_16x16x32_bf16 v[136:139], v[28:31], v[144:147], v[136:139]
  ds_bpermute_b32 v13, v5, v8
  ds_read_b64 v[144:145], v3 offset:3584
  ds_read_b64 v[146:147], v3 offset:3592
  s_waitcnt lgkmcnt(10)
  v_mfma_f32_16x16x32_bf16 v[124:127], v[20:23], v[148:151], v[124:127]
  ds_bpermute_b32 v14, v5, v9
  v_mfma_f32_16x16x32_bf16 v[140:143], v[28:31], v[148:151], v[140:143]
  ds_bpermute_b32 v15, v5, v111
  ds_read_b64 v[148:149], v3 offset:64
  ds_read_b64 v[150:151], v3 offset:72
  s_waitcnt lgkmcnt(11)
  v_mfma_f32_16x16x32_bf16 v[112:115], v[16:19], v[152:155], v[112:115]
  v_add_f32 v99, v99, v102
  v_mfma_f32_16x16x32_bf16 v[128:131], v[24:27], v[152:155], v[128:131]
  v_add_f32 v98, v98, v104
  ds_read_b64 v[152:153], v3 offset:1216
  ds_read_b64 v[154:155], v3 offset:1224
  s_waitcnt lgkmcnt(11)
  v_mfma_f32_16x16x32_bf16 v[116:119], v[16:19], v[156:159], v[116:119]
  v_add_f32 v99, v99, v105
  v_mfma_f32_16x16x32_bf16 v[132:135], v[24:27], v[156:159], v[132:135]
  v_add_f32 v99, v99, v108
  ds_read_b64 v[156:157], v3 offset:2368
  ds_read_b64 v[158:159], v3 offset:2376
  s_waitcnt lgkmcnt(11)
  v_mfma_f32_16x16x32_bf16 v[120:123], v[16:19], v[160:163], v[120:123]
  v_mfma_f32_16x16x32_bf16 v[136:139], v[24:27], v[160:163], v[136:139]
  ds_read_b64 v[160:161], v3 offset:3520
  ds_read_b64 v[162:163], v3 offset:3528
  s_waitcnt lgkmcnt(10)
  v_mfma_f32_16x16x32_bf16 v[124:127], v[16:19], v[144:147], v[124:127]
  v_mfma_f32_16x16x32_bf16 v[140:143], v[24:27], v[144:147], v[140:143]
  v_cndmask_b32 v10, v13, v10, s[40:41]
  ds_read_b64 v[144:145], v3 offset:0
  ds_read_b64 v[146:147], v3 offset:8
  s_waitcnt lgkmcnt(8)
  v_mfma_f32_16x16x32_bf16 v[128:131], v[20:23], v[148:151], v[128:131]
  v_cndmask_b32 v11, v14, v11, s[40:41]
  ds_read_b64 v[148:149], v3 offset:1152
  ds_read_b64 v[150:151], v3 offset:1160
  s_waitcnt lgkmcnt(8)
  v_mfma_f32_16x16x32_bf16 v[132:135], v[20:23], v[152:155], v[132:135]
  v_cndmask_b32 v12, v15, v12, s[40:41]
  ds_read_b64 v[152:153], v3 offset:2304
  ds_read_b64 v[154:155], v3 offset:2312
  s_waitcnt lgkmcnt(8)
  v_mfma_f32_16x16x32_bf16 v[136:139], v[20:23], v[156:159], v[136:139]
  v_add_f32 v96, v96, v10
  ds_read_b64 v[156:157], v3 offset:3456
  ds_read_b64 v[158:159], v3 offset:3464
  s_waitcnt lgkmcnt(8)
  v_mfma_f32_16x16x32_bf16 v[140:143], v[20:23], v[160:163], v[140:143]
  v_add_f32 v97, v97, v11
  s_waitcnt lgkmcnt(6)
  v_mfma_f32_16x16x32_bf16 v[128:131], v[16:19], v[144:147], v[128:131]
  v_add_f32 v98, v98, v12
  s_waitcnt lgkmcnt(4)
  v_mfma_f32_16x16x32_bf16 v[132:135], v[16:19], v[148:151], v[132:135]
  v_cvt_pk_bf16_f32 v6, v96, v97
  s_waitcnt lgkmcnt(2)
  v_mfma_f32_16x16x32_bf16 v[136:139], v[16:19], v[152:155], v[136:139]
  v_cvt_pk_bf16_f32 v7, v98, v99
  s_waitcnt lgkmcnt(0)
  v_mfma_f32_16x16x32_bf16 v[140:143], v[16:19], v[156:159], v[140:143]
  ds_write_b64 v4, v[6:7] offset:2880
  s_waitcnt lgkmcnt(0)
  s_barrier
  v_add_f32 v8, v119, v122
  v_add_f32 v113, v113, v116
  v_add_f32 v8, v8, v125
  v_add_f32 v114, v114, v117
  v_add_f32 v9, v123, v126
  ds_bpermute_b32 v10, v5, v8
  ds_bpermute_b32 v11, v5, v9
  ds_bpermute_b32 v12, v5, v127
  v_add_f32 v115, v115, v118
  v_add_f32 v114, v114, v120
  v_add_f32 v115, v115, v121
  v_add_f32 v115, v115, v124
  s_waitcnt lgkmcnt(2)
  v_cndmask_b32 v13, v10, v13, s[40:41]
  s_waitcnt lgkmcnt(1)
  v_cndmask_b32 v14, v11, v14, s[40:41]
  s_waitcnt lgkmcnt(0)
  v_cndmask_b32 v15, v12, v15, s[40:41]
  v_add_f32 v112, v112, v13
  v_add_f32 v113, v113, v14
  v_add_f32 v114, v114, v15
  v_cvt_pk_bf16_f32 v6, v112, v113
  v_cvt_pk_bf16_f32 v7, v114, v115
  ds_write_b64 v4, v[6:7] offset:3456
  v_add_f32 v8, v135, v138
  v_add_f32 v129, v129, v132
  v_add_f32 v8, v8, v141
  v_add_f32 v130, v130, v133
  v_add_f32 v9, v139, v142
  ds_bpermute_b32 v13, v5, v8
  ds_bpermute_b32 v14, v5, v9
  ds_bpermute_b32 v15, v5, v143
  v_add_f32 v131, v131, v134
  v_add_f32 v130, v130, v136
  v_add_f32 v131, v131, v137
  v_add_f32 v131, v131, v140
  s_waitcnt lgkmcnt(2)
  v_cndmask_b32 v10, v13, v10, s[40:41]
  s_waitcnt lgkmcnt(1)
  v_cndmask_b32 v11, v14, v11, s[40:41]
  s_waitcnt lgkmcnt(0)
  v_cndmask_b32 v12, v15, v12, s[40:41]
  v_add_f32 v128, v128, v10
  v_add_f32 v129, v129, v11
  v_add_f32 v130, v130, v12
  v_cvt_pk_bf16_f32 v6, v128, v129
  v_cvt_pk_bf16_f32 v7, v130, v131
  ds_write_b64 v4, v[6:7] offset:4032
  s_waitcnt lgkmcnt(0)
  s_barrier
  s_endpgm
L_AG:
  s_lshl_b32 s5, s3, 3
  s_add_u32 s5, s5, s4
  s_lshl_b32 s6, s5, 8
  v_lshl_add_u32 v94, v1, 2, s6
  s_waitcnt lgkmcnt(0)
  global_load_dword v10, v94, s[66:67]
  global_load_dword v11, v94, s[68:69]
  global_load_dword v12, v94, s[70:71]
  global_load_dword v13, v94, s[72:73]
  s_lshl_b32 s6, s5, 1
  v_mov_b32 v95, s6
  global_load_short_d16_hi v14, v95, s[74:75]
  global_load_short_d16_hi v21, v95, s[76:77]
  v_and_b32 v160, 15, v1
  v_lshrrev_b32 v161, 4, v1
  v_lshrrev_b32 v162, 2, v160
  v_and_b32 v163, 3, v160
  v_add_u32 v162, v162, v163
  v_lshlrev_b32 v162, 3, v162
  v_lshl_add_u32 v162, v161, 6, v162
  s_mul_i32 s61, s4, 4128
  s_add_u32 s61, s61, 37024
  s_sub_u32 s5, s61, 24
  v_add_u32 v2, s5, v162
  v_lshlrev_b32 v162, 4, v161
  v_lshlrev_b32 v163, 3, v160
  v_sub_u32 v162, v162, v163
  s_mul_i32 s5, s4, 4624
  s_add_u32 s5, s5, 120
  v_add_u32 v3, s5, v162
  v_lshlrev_b32 v162, 5, v160
  v_lshl_add_u32 v162, v161, 3, v162
  v_lshrrev_b32 v163, 2, v160
  v_lshl_add_u32 v162, v163, 4, v162
  s_mul_i32 s5, s4, 4672
  s_add_u32 s5, s5, 70016
  v_add_u32 v4, s5, v162
  v_add_u32 v162, 47, v1
  v_subrev_u32 v163, 16, v1
  v_cmp_gt_u32 vcc, 16, v1
  v_cndmask_b32 v162, v163, v162, vcc
  v_mov_b32 v163, 63
  v_cmp_eq_u32 vcc, 0, v1
  v_cndmask_b32 v162, v162, v163, vcc
  v_lshlrev_b32 v5, 2, v162
  s_mov_b64 s[40:41], 1
  s_mov_b32 s44, 0xffff0000
  v_lshrrev_b32 v160, 4, v1
  v_mul_u32_u24 v160, 1152, v160
  v_and_b32 v161, 15, v1
  v_lshl_add_u32 v160, v161, 3, v160
  s_mul_i32 s5, s4, 4624
  s_add_u32 s5, s5, 1024
  v_add_u32 v160, s5, v160
  v_mov_b32 v162, 0
  v_mov_b32 v163, 0
  ds_write_b64 v160, v[162:163]
  v_and_b32 v161, 3, v1
  v_lshlrev_b32 v161, 3, v161
  s_sub_u32 s5, s61, 32
  v_add_u32 v161, s5, v161
  ds_write_b64 v161, v[162:163]
  s_mul_i32 s7, s4, 8704
  s_add_u32 s5, s7, 70016
  s_add_u32 s6, s7, 72576
  s_cmp_lt_u32 s4, 4
  s_cselect_b32 s60, s5, s6
  s_lshl_b32 s62, s4, 10
  s_add_u32 s62, s62, 142208
  v_lshl_add_u32 v16, v1, 3, s60
  v_add_u32 v7, 2176, v16
  v_add_u32 v8, 4352, v16
  v_add_u32 v9, 6528, v16
  v_and_b32 v94, 15, v1
  v_lshrrev_b32 v95, 4, v1
  v_mul_u32_u24 v17, 544, v94
  v_lshl_add_u32 v17, v95, 4, v17
  v_add_u32 v17, s60, v17
  v_lshlrev_b32 v96, 3, v94
  v_lshlrev_b32 v97, 2, v94
  v_cmp_gt_u32 vcc, 32, v1
  v_cndmask_b32 v96, v97, v96, vcc
  v_lshl_add_u32 v96, v95, 7, v96
  v_add_u32 v18, s62, v96
  v_mov_b32 v97, 64
  v_mov_b32 v98, 4
  v_cndmask_b32 v97, v97, v98, vcc
  v_add_u32 v19, v18, v97
  v_lshlrev_b32 v6, 5, v94
  v_lshl_add_u32 v6, v95, 3, v6
  v_add_u32 v6, s62, v6
  v_lshrrev_b32 v95, 5, v1
  v_bfe_u32 v96, v1, 4, 1
  v_lshlrev_b32 v94, 4, v94
  v_lshl_add_u32 v94, v95, 8, v94
  v_lshl_add_u32 v94, v96, 3, v94
  v_add_u32 v20, s61, v94
  s_mov_b32 s48, 0x01000100
  s_mov_b32 s49, 0x03020302
  s_mov_b32 s50, 0x05040302
  s_waitcnt vmcnt(1)
  v_mul_f32 v22, 1069066811, v14
  v_lshlrev_b32 v24, 16, v10
  v_lshlrev_b32 v26, 16, v11
  v_lshlrev_b32 v34, 16, v12
  v_lshlrev_b32 v35, 16, v13
  v_and_b32 v25, s44, v10
  v_and_b32 v27, s44, v11
  v_and_b32 v52, s44, v12
  v_and_b32 v53, s44, v13
  v_exp_f32 v22, v22
  v_mul_f32 v24, 1069066811, v24
  v_mul_f32 v25, 1069066811, v25
  v_exp_f32 v24, v24
  v_exp_f32 v25, v25
  v_cvt_pk_bf16_f32 v22, v22, v22
  s_waitcnt vmcnt(0)
  v_cndmask_b32 v21, 0, v21, s[40:41]
  v_and_b32 v22, s44, v22
  v_cvt_pk_bf16_f32 v28, v24, v25
  v_add_f32 v23, v22, v22
  v_and_b32 v25, s44, v28
  v_lshlrev_b32 v24, 16, v28
  v_mul_f32 v26, v26, v22
  v_mul_f32 v24, -v24, v22
  v_mul_f32 v27, v27, v22
  v_mul_f32 v25, -v25, v22
  v_mul_f32 v26, 1042479491, v26
  v_mul_f32 v24, 1069066811, v24
  v_mul_f32 v27, 1042479491, v27
  v_mul_f32 v25, 1069066811, v25
  v_mul_f32 v34, v34, v23
  v_mul_f32 v35, v35, v23
  v_mul_f32 v52, v52, v23
  v_mul_f32 v53, v53, v23
  v_exp_f32 v28, v24
  v_fract_f32 v30, v26
  v_mul_f32 v32, 0x43000000, v24
  v_mul_f32 v71, 0x43000000, v26
  v_exp_f32 v29, v25
  v_fract_f32 v31, v27
  v_mul_f32 v33, 0x43000000, v25
  v_mul_f32 v73, 0x43000000, v27
  v_exp_f32 v70, v32
  v_fract_f32 v71, v71
  v_cos_f32 v36, v30
  v_sin_f32 v37, v30
  v_exp_f32 v72, v33
  v_fract_f32 v73, v73
  v_cos_f32 v54, v31
  v_sin_f32 v55, v31
  v_cos_f32 v44, v71
  v_sin_f32 v45, v71
  v_cos_f32 v62, v73
  v_sin_f32 v63, v73
  v_mul_f32 v36, v36, v28
  v_mul_f32 v37, v37, v28
  v_mul_f32 v54, v54, v29
  v_mul_f32 v55, v55, v29
  v_mul_f32 v44, v44, v70
  v_mul_f32 v45, v45, v70
  v_mul_f32 v62, v62, v72
  v_mul_f32 v63, v63, v72
  v_pk_mul_f32 v[70:71], v[36:37], v[36:37] op_sel:[0,0] op_sel_hi:[1,0]
  v_pk_mul_f32 v[72:73], v[54:55], v[54:55] op_sel:[0,0] op_sel_hi:[1,0]
  v_pk_mul_f32 v[74:75], v[44:45], v[44:45] op_sel:[0,0] op_sel_hi:[1,0]
  v_pk_mul_f32 v[76:77], v[62:63], v[62:63] op_sel:[0,0] op_sel_hi:[1,0]
  v_pk_fma_f32 v[38:39], v[36:37], v[36:37], v[70:71] op_sel:[1,1,0] op_sel_hi:[0,1,1] neg_lo:[1,0,0]
  v_pk_fma_f32 v[56:57], v[54:55], v[54:55], v[72:73] op_sel:[1,1,0] op_sel_hi:[0,1,1] neg_lo:[1,0,0]
  v_pk_fma_f32 v[46:47], v[44:45], v[44:45], v[74:75] op_sel:[1,1,0] op_sel_hi:[0,1,1] neg_lo:[1,0,0]
  v_pk_fma_f32 v[64:65], v[62:63], v[62:63], v[76:77] op_sel:[1,1,0] op_sel_hi:[0,1,1] neg_lo:[1,0,0]
  v_pk_mul_f32 v[70:71], v[38:39], v[38:39] op_sel:[0,0] op_sel_hi:[1,0]
  v_pk_mul_f32 v[72:73], v[56:57], v[56:57] op_sel:[0,0] op_sel_hi:[1,0]
  v_pk_mul_f32 v[74:75], v[46:47], v[46:47] op_sel:[0,0] op_sel_hi:[1,0]
  v_pk_mul_f32 v[76:77], v[64:65], v[64:65] op_sel:[0,0] op_sel_hi:[1,0]
  v_pk_fma_f32 v[40:41], v[38:39], v[38:39], v[70:71] op_sel:[1,1,0] op_sel_hi:[0,1,1] neg_lo:[1,0,0]
  v_pk_fma_f32 v[58:59], v[56:57], v[56:57], v[72:73] op_sel:[1,1,0] op_sel_hi:[0,1,1] neg_lo:[1,0,0]
  v_pk_fma_f32 v[48:49], v[46:47], v[46:47], v[74:75] op_sel:[1,1,0] op_sel_hi:[0,1,1] neg_lo:[1,0,0]
  v_pk_fma_f32 v[66:67], v[64:65], v[64:65], v[76:77] op_sel:[1,1,0] op_sel_hi:[0,1,1] neg_lo:[1,0,0]
  v_pk_mul_f32 v[70:71], v[40:41], v[40:41] op_sel:[0,0] op_sel_hi:[1,0]
  v_pk_mul_f32 v[72:73], v[58:59], v[58:59] op_sel:[0,0] op_sel_hi:[1,0]
  v_pk_mul_f32 v[74:75], v[48:49], v[48:49] op_sel:[0,0] op_sel_hi:[1,0]
  v_pk_mul_f32 v[76:77], v[66:67], v[66:67] op_sel:[0,0] op_sel_hi:[1,0]
  v_pk_fma_f32 v[42:43], v[40:41], v[40:41], v[70:71] op_sel:[1,1,0] op_sel_hi:[0,1,1] neg_lo:[1,0,0]
  v_pk_fma_f32 v[60:61], v[58:59], v[58:59], v[72:73] op_sel:[1,1,0] op_sel_hi:[0,1,1] neg_lo:[1,0,0]
  v_pk_fma_f32 v[50:51], v[48:49], v[48:49], v[74:75] op_sel:[1,1,0] op_sel_hi:[0,1,1] neg_lo:[1,0,0]
  v_pk_fma_f32 v[68:69], v[66:67], v[66:67], v[76:77] op_sel:[1,1,0] op_sel_hi:[0,1,1] neg_lo:[1,0,0]
  v_mov_b32 v94, 0x3f80
  v_mov_b32 v95, 0x3f80
  v_pk_mul_f32 v[70:71], v[42:43], v[42:43] op_sel:[0,0] op_sel_hi:[1,0]
  v_pk_mul_f32 v[72:73], v[60:61], v[60:61] op_sel:[0,0] op_sel_hi:[1,0]
  v_pk_fma_f32 v[84:85], v[42:43], v[42:43], v[70:71] op_sel:[1,1,0] op_sel_hi:[0,1,1] neg_lo:[1,0,0]
  v_pk_fma_f32 v[92:93], v[60:61], v[60:61], v[72:73] op_sel:[1,1,0] op_sel_hi:[0,1,1] neg_lo:[1,0,0]
  v_cvt_pk_bf16_f32 v96, v42, -v43
  v_cvt_pk_bf16_f32 v97, v60, -v61
  ds_write2_b64 v16, v[94:95], v[96:97] offset0:0 offset1:68
  v_pk_mul_f32 v[74:75], v[42:43], v[84:85] op_sel:[0,0] op_sel_hi:[1,0]
  v_pk_mul_f32 v[76:77], v[60:61], v[92:93] op_sel:[0,0] op_sel_hi:[1,0]
  v_pk_mul_f32 v[70:71], v[84:85], v[84:85] op_sel:[0,0] op_sel_hi:[1,0]
  v_pk_mul_f32 v[72:73], v[92:93], v[92:93] op_sel:[0,0] op_sel_hi:[1,0]
  v_pk_fma_f32 v[78:79], v[42:43], v[84:85], v[74:75] op_sel:[1,1,0] op_sel_hi:[0,1,1] neg_lo:[1,0,0]
  v_pk_fma_f32 v[86:87], v[60:61], v[92:93], v[76:77] op_sel:[1,1,0] op_sel_hi:[0,1,1] neg_lo:[1,0,0]
  v_pk_fma_f32 v[80:81], v[84:85], v[84:85], v[70:71] op_sel:[1,1,0] op_sel_hi:[0,1,1] neg_lo:[1,0,0]
  v_pk_fma_f32 v[88:89], v[92:93], v[92:93], v[72:73] op_sel:[1,1,0] op_sel_hi:[0,1,1] neg_lo:[1,0,0]
  v_cvt_pk_bf16_f32 v98, v84, -v85
  v_cvt_pk_bf16_f32 v99, v92, -v93
  v_cvt_pk_bf16_f32 v100, v78, -v79
  v_cvt_pk_bf16_f32 v101, v86, -v87
  ds_write2_b64 v16, v[98:99], v[100:101] offset0:136 offset1:204
  v_pk_mul_f32 v[74:75], v[78:79], v[84:85] op_sel:[0,0] op_sel_hi:[1,0]
  v_pk_mul_f32 v[76:77], v[86:87], v[92:93] op_sel:[0,0] op_sel_hi:[1,0]
  v_pk_fma_f32 v[78:79], v[78:79], v[84:85], v[74:75] op_sel:[1,1,0] op_sel_hi:[0,1,1] neg_lo:[1,0,0]
  v_pk_fma_f32 v[86:87], v[86:87], v[92:93], v[76:77] op_sel:[1,1,0] op_sel_hi:[0,1,1] neg_lo:[1,0,0]
  v_cvt_pk_bf16_f32 v94, v80, -v81
  v_cvt_pk_bf16_f32 v95, v88, -v89
  v_cvt_pk_bf16_f32 v96, v78, -v79
  v_cvt_pk_bf16_f32 v97, v86, -v87
  ds_write2_b64 v7, v[94:95], v[96:97] offset0:0 offset1:68
  v_pk_mul_f32 v[70:71], v[78:79], v[84:85] op_sel:[0,0] op_sel_hi:[1,0]
  v_pk_mul_f32 v[72:73], v[86:87], v[92:93] op_sel:[0,0] op_sel_hi:[1,0]
  v_pk_mul_f32 v[74:75], v[80:81], v[84:85] op_sel:[0,0] op_sel_hi:[1,0]
  v_pk_mul_f32 v[76:77], v[88:89], v[92:93] op_sel:[0,0] op_sel_hi:[1,0]
  v_pk_fma_f32 v[78:79], v[78:79], v[84:85], v[70:71] op_sel:[1,1,0] op_sel_hi:[0,1,1] neg_lo:[1,0,0]
  v_pk_fma_f32 v[86:87], v[86:87], v[92:93], v[72:73] op_sel:[1,1,0] op_sel_hi:[0,1,1] neg_lo:[1,0,0]
  v_pk_fma_f32 v[80:81], v[80:81], v[84:85], v[74:75] op_sel:[1,1,0] op_sel_hi:[0,1,1] neg_lo:[1,0,0]
  v_pk_fma_f32 v[88:89], v[88:89], v[92:93], v[76:77] op_sel:[1,1,0] op_sel_hi:[0,1,1] neg_lo:[1,0,0]
  v_cvt_pk_bf16_f32 v98, v80, -v81
  v_cvt_pk_bf16_f32 v99, v88, -v89
  v_cvt_pk_bf16_f32 v100, v78, -v79
  v_cvt_pk_bf16_f32 v101, v86, -v87
  ds_write2_b64 v7, v[98:99], v[100:101] offset0:136 offset1:204
  v_pk_mul_f32 v[70:71], v[78:79], v[84:85] op_sel:[0,0] op_sel_hi:[1,0]
  v_pk_mul_f32 v[72:73], v[86:87], v[92:93] op_sel:[0,0] op_sel_hi:[1,0]
  v_pk_mul_f32 v[74:75], v[80:81], v[84:85] op_sel:[0,0] op_sel_hi:[1,0]
  v_pk_mul_f32 v[76:77], v[88:89], v[92:93] op_sel:[0,0] op_sel_hi:[1,0]
  v_pk_fma_f32 v[78:79], v[78:79], v[84:85], v[70:71] op_sel:[1,1,0] op_sel_hi:[0,1,1] neg_lo:[1,0,0]
  v_pk_fma_f32 v[86:87], v[86:87], v[92:93], v[72:73] op_sel:[1,1,0] op_sel_hi:[0,1,1] neg_lo:[1,0,0]
  v_pk_fma_f32 v[80:81], v[80:81], v[84:85], v[74:75] op_sel:[1,1,0] op_sel_hi:[0,1,1] neg_lo:[1,0,0]
  v_pk_fma_f32 v[88:89], v[88:89], v[92:93], v[76:77] op_sel:[1,1,0] op_sel_hi:[0,1,1] neg_lo:[1,0,0]
  v_cvt_pk_bf16_f32 v94, v80, -v81
  v_cvt_pk_bf16_f32 v95, v88, -v89
  v_cvt_pk_bf16_f32 v96, v78, -v79
  v_cvt_pk_bf16_f32 v97, v86, -v87
  ds_write2_b64 v8, v[94:95], v[96:97] offset0:0 offset1:68
  v_pk_mul_f32 v[70:71], v[78:79], v[84:85] op_sel:[0,0] op_sel_hi:[1,0]
  v_pk_mul_f32 v[72:73], v[86:87], v[92:93] op_sel:[0,0] op_sel_hi:[1,0]
  v_pk_mul_f32 v[74:75], v[80:81], v[84:85] op_sel:[0,0] op_sel_hi:[1,0]
  v_pk_mul_f32 v[76:77], v[88:89], v[92:93] op_sel:[0,0] op_sel_hi:[1,0]
  v_pk_fma_f32 v[78:79], v[78:79], v[84:85], v[70:71] op_sel:[1,1,0] op_sel_hi:[0,1,1] neg_lo:[1,0,0]
  v_pk_fma_f32 v[86:87], v[86:87], v[92:93], v[72:73] op_sel:[1,1,0] op_sel_hi:[0,1,1] neg_lo:[1,0,0]
  v_pk_fma_f32 v[80:81], v[80:81], v[84:85], v[74:75] op_sel:[1,1,0] op_sel_hi:[0,1,1] neg_lo:[1,0,0]
  v_pk_fma_f32 v[88:89], v[88:89], v[92:93], v[76:77] op_sel:[1,1,0] op_sel_hi:[0,1,1] neg_lo:[1,0,0]
  v_cvt_pk_bf16_f32 v98, v80, -v81
  v_cvt_pk_bf16_f32 v99, v88, -v89
  v_cvt_pk_bf16_f32 v100, v78, -v79
  v_cvt_pk_bf16_f32 v101, v86, -v87
  ds_write2_b64 v8, v[98:99], v[100:101] offset0:136 offset1:204
  v_pk_mul_f32 v[70:71], v[78:79], v[84:85] op_sel:[0,0] op_sel_hi:[1,0]
  v_pk_mul_f32 v[72:73], v[86:87], v[92:93] op_sel:[0,0] op_sel_hi:[1,0]
  v_pk_mul_f32 v[74:75], v[80:81], v[84:85] op_sel:[0,0] op_sel_hi:[1,0]
  v_pk_mul_f32 v[76:77], v[88:89], v[92:93] op_sel:[0,0] op_sel_hi:[1,0]
  v_pk_fma_f32 v[78:79], v[78:79], v[84:85], v[70:71] op_sel:[1,1,0] op_sel_hi:[0,1,1] neg_lo:[1,0,0]
  v_pk_fma_f32 v[86:87], v[86:87], v[92:93], v[72:73] op_sel:[1,1,0] op_sel_hi:[0,1,1] neg_lo:[1,0,0]
  v_pk_fma_f32 v[80:81], v[80:81], v[84:85], v[74:75] op_sel:[1,1,0] op_sel_hi:[0,1,1] neg_lo:[1,0,0]
  v_pk_fma_f32 v[88:89], v[88:89], v[92:93], v[76:77] op_sel:[1,1,0] op_sel_hi:[0,1,1] neg_lo:[1,0,0]
  v_cvt_pk_bf16_f32 v94, v80, -v81
  v_cvt_pk_bf16_f32 v95, v88, -v89
  v_cvt_pk_bf16_f32 v96, v78, -v79
  v_cvt_pk_bf16_f32 v97, v86, -v87
  ds_write2_b64 v9, v[94:95], v[96:97] offset0:0 offset1:68
  v_pk_mul_f32 v[70:71], v[78:79], v[84:85] op_sel:[0,0] op_sel_hi:[1,0]
  v_pk_mul_f32 v[72:73], v[86:87], v[92:93] op_sel:[0,0] op_sel_hi:[1,0]
  v_pk_mul_f32 v[74:75], v[80:81], v[84:85] op_sel:[0,0] op_sel_hi:[1,0]
  v_pk_mul_f32 v[76:77], v[88:89], v[92:93] op_sel:[0,0] op_sel_hi:[1,0]
  v_pk_fma_f32 v[78:79], v[78:79], v[84:85], v[70:71] op_sel:[1,1,0] op_sel_hi:[0,1,1] neg_lo:[1,0,0]
  v_pk_fma_f32 v[86:87], v[86:87], v[92:93], v[72:73] op_sel:[1,1,0] op_sel_hi:[0,1,1] neg_lo:[1,0,0]
  v_pk_fma_f32 v[80:81], v[80:81], v[84:85], v[74:75] op_sel:[1,1,0] op_sel_hi:[0,1,1] neg_lo:[1,0,0]
  v_pk_fma_f32 v[88:89], v[88:89], v[92:93], v[76:77] op_sel:[1,1,0] op_sel_hi:[0,1,1] neg_lo:[1,0,0]
  v_cvt_pk_bf16_f32 v98, v80, -v81
  v_cvt_pk_bf16_f32 v99, v88, -v89
  v_cvt_pk_bf16_f32 v100, v78, -v79
  v_cvt_pk_bf16_f32 v101, v86, -v87
  ds_write2_b64 v9, v[98:99], v[100:101] offset0:136 offset1:204
  ds_read_b128 v[102:105], v17 offset:0
  ds_read_b128 v[106:109], v17 offset:64
  ds_read_b128 v[110:113], v17 offset:128
  ds_read_b128 v[114:117], v17 offset:192
  ds_read_b128 v[118:121], v17 offset:256
  ds_read_b128 v[122:125], v17 offset:320
  ds_read_b128 v[126:129], v17 offset:384
  ds_read_b128 v[130:133], v17 offset:448
  v_pk_mul_f32 v[70:71], v[34:35], v[44:45] op_sel:[0,0] op_sel_hi:[1,0]
  v_pk_mul_f32 v[72:73], v[52:53], v[62:63] op_sel:[0,0] op_sel_hi:[1,0]
  v_pk_mul_f32 v[74:75], v[34:35], v[36:37] op_sel:[0,0] op_sel_hi:[1,0]
  v_pk_mul_f32 v[76:77], v[52:53], v[54:55] op_sel:[0,0] op_sel_hi:[1,0]
  v_pk_fma_f32 v[80:81], v[34:35], v[44:45], v[70:71] op_sel:[1,1,0] op_sel_hi:[0,1,1] neg_lo:[1,0,0]
  v_pk_fma_f32 v[88:89], v[52:53], v[62:63], v[72:73] op_sel:[1,1,0] op_sel_hi:[0,1,1] neg_lo:[1,0,0]
  v_pk_fma_f32 v[78:79], v[34:35], v[36:37], v[74:75] op_sel:[1,1,0] op_sel_hi:[0,1,1] neg_lo:[1,0,0]
  v_pk_fma_f32 v[86:87], v[52:53], v[54:55], v[76:77] op_sel:[1,1,0] op_sel_hi:[0,1,1] neg_lo:[1,0,0]
  v_cvt_pk_bf16_f32 v94, v34, v35
  v_cvt_pk_bf16_f32 v95, v52, v53
  v_cvt_pk_bf16_f32 v96, v78, v79
  v_cvt_pk_bf16_f32 v97, v86, v87
  ds_write2_b64 v16, v[94:95], v[96:97] offset0:0 offset1:68
  v_cvt_pk_bf16_f32 v98, v80, v81
  v_cvt_pk_bf16_f32 v99, v88, v89
  v_pk_mul_f32 v[70:71], v[80:81], v[36:37] op_sel:[0,0] op_sel_hi:[1,0]
  v_pk_mul_f32 v[72:73], v[88:89], v[54:55] op_sel:[0,0] op_sel_hi:[1,0]
  v_pk_mul_f32 v[74:75], v[78:79], v[36:37] op_sel:[0,0] op_sel_hi:[1,0]
  v_pk_mul_f32 v[76:77], v[86:87], v[54:55] op_sel:[0,0] op_sel_hi:[1,0]
  v_pk_fma_f32 v[80:81], v[80:81], v[36:37], v[70:71] op_sel:[1,1,0] op_sel_hi:[0,1,1] neg_lo:[1,0,0]
  v_pk_fma_f32 v[88:89], v[88:89], v[54:55], v[72:73] op_sel:[1,1,0] op_sel_hi:[0,1,1] neg_lo:[1,0,0]
  v_pk_fma_f32 v[78:79], v[78:79], v[36:37], v[74:75] op_sel:[1,1,0] op_sel_hi:[0,1,1] neg_lo:[1,0,0]
  v_pk_fma_f32 v[86:87], v[86:87], v[54:55], v[76:77] op_sel:[1,1,0] op_sel_hi:[0,1,1] neg_lo:[1,0,0]
  v_cvt_pk_bf16_f32 v100, v80, v81
  v_cvt_pk_bf16_f32 v101, v88, v89
  ds_write2_b64 v8, v[98:99], v[100:101] offset0:0 offset1:68
  v_cvt_pk_bf16_f32 v94, v78, v79
  v_cvt_pk_bf16_f32 v95, v86, v87
  v_pk_mul_f32 v[70:71], v[78:79], v[36:37] op_sel:[0,0] op_sel_hi:[1,0]
  v_pk_mul_f32 v[72:73], v[86:87], v[54:55] op_sel:[0,0] op_sel_hi:[1,0]
  v_pk_mul_f32 v[74:75], v[80:81], v[36:37] op_sel:[0,0] op_sel_hi:[1,0]
  v_pk_mul_f32 v[76:77], v[88:89], v[54:55] op_sel:[0,0] op_sel_hi:[1,0]
  v_pk_fma_f32 v[78:79], v[78:79], v[36:37], v[70:71] op_sel:[1,1,0] op_sel_hi:[0,1,1] neg_lo:[1,0,0]
  v_pk_fma_f32 v[86:87], v[86:87], v[54:55], v[72:73] op_sel:[1,1,0] op_sel_hi:[0,1,1] neg_lo:[1,0,0]
  v_pk_fma_f32 v[80:81], v[80:81], v[36:37], v[74:75] op_sel:[1,1,0] op_sel_hi:[0,1,1] neg_lo:[1,0,0]
  v_pk_fma_f32 v[88:89], v[88:89], v[54:55], v[76:77] op_sel:[1,1,0] op_sel_hi:[0,1,1] neg_lo:[1,0,0]
  v_cvt_pk_bf16_f32 v96, v78, v79
  v_cvt_pk_bf16_f32 v97, v86, v87
  ds_write2_b64 v16, v[94:95], v[96:97] offset0:136 offset1:204
  v_cvt_pk_bf16_f32 v98, v80, v81
  v_cvt_pk_bf16_f32 v99, v88, v89
  v_pk_mul_f32 v[70:71], v[80:81], v[36:37] op_sel:[0,0] op_sel_hi:[1,0]
  v_pk_mul_f32 v[72:73], v[88:89], v[54:55] op_sel:[0,0] op_sel_hi:[1,0]
  v_pk_mul_f32 v[74:75], v[78:79], v[36:37] op_sel:[0,0] op_sel_hi:[1,0]
  v_pk_mul_f32 v[76:77], v[86:87], v[54:55] op_sel:[0,0] op_sel_hi:[1,0]
  v_pk_fma_f32 v[80:81], v[80:81], v[36:37], v[70:71] op_sel:[1,1,0] op_sel_hi:[0,1,1] neg_lo:[1,0,0]
  v_pk_fma_f32 v[88:89], v[88:89], v[54:55], v[72:73] op_sel:[1,1,0] op_sel_hi:[0,1,1] neg_lo:[1,0,0]
  v_pk_fma_f32 v[78:79], v[78:79], v[36:37], v[74:75] op_sel:[1,1,0] op_sel_hi:[0,1,1] neg_lo:[1,0,0]
  v_pk_fma_f32 v[86:87], v[86:87], v[54:55], v[76:77] op_sel:[1,1,0] op_sel_hi:[0,1,1] neg_lo:[1,0,0]
  v_cvt_pk_bf16_f32 v100, v80, v81
  v_cvt_pk_bf16_f32 v101, v88, v89
  ds_write2_b64 v8, v[98:99], v[100:101] offset0:136 offset1:204
  v_cvt_pk_bf16_f32 v94, v78, v79
  v_cvt_pk_bf16_f32 v95, v86, v87
  v_pk_mul_f32 v[70:71], v[78:79], v[36:37] op_sel:[0,0] op_sel_hi:[1,0]
  v_pk_mul_f32 v[72:73], v[86:87], v[54:55] op_sel:[0,0] op_sel_hi:[1,0]
  v_pk_mul_f32 v[74:75], v[80:81], v[36:37] op_sel:[0,0] op_sel_hi:[1,0]
  v_pk_mul_f32 v[76:77], v[88:89], v[54:55] op_sel:[0,0] op_sel_hi:[1,0]
  v_pk_fma_f32 v[78:79], v[78:79], v[36:37], v[70:71] op_sel:[1,1,0] op_sel_hi:[0,1,1] neg_lo:[1,0,0]
  v_pk_fma_f32 v[86:87], v[86:87], v[54:55], v[72:73] op_sel:[1,1,0] op_sel_hi:[0,1,1] neg_lo:[1,0,0]
  v_pk_fma_f32 v[80:81], v[80:81], v[36:37], v[74:75] op_sel:[1,1,0] op_sel_hi:[0,1,1] neg_lo:[1,0,0]
  v_pk_fma_f32 v[88:89], v[88:89], v[54:55], v[76:77] op_sel:[1,1,0] op_sel_hi:[0,1,1] neg_lo:[1,0,0]
  v_cvt_pk_bf16_f32 v96, v78, v79
  v_cvt_pk_bf16_f32 v97, v86, v87
  ds_write2_b64 v7, v[94:95], v[96:97] offset0:0 offset1:68
  v_cvt_pk_bf16_f32 v98, v80, v81
  v_cvt_pk_bf16_f32 v99, v88, v89
  v_pk_mul_f32 v[70:71], v[80:81], v[36:37] op_sel:[0,0] op_sel_hi:[1,0]
  v_pk_mul_f32 v[72:73], v[88:89], v[54:55] op_sel:[0,0] op_sel_hi:[1,0]
  v_pk_mul_f32 v[74:75], v[78:79], v[36:37] op_sel:[0,0] op_sel_hi:[1,0]
  v_pk_mul_f32 v[76:77], v[86:87], v[54:55] op_sel:[0,0] op_sel_hi:[1,0]
  v_pk_fma_f32 v[80:81], v[80:81], v[36:37], v[70:71] op_sel:[1,1,0] op_sel_hi:[0,1,1] neg_lo:[1,0,0]
  v_pk_fma_f32 v[88:89], v[88:89], v[54:55], v[72:73] op_sel:[1,1,0] op_sel_hi:[0,1,1] neg_lo:[1,0,0]
  v_pk_fma_f32 v[78:79], v[78:79], v[36:37], v[74:75] op_sel:[1,1,0] op_sel_hi:[0,1,1] neg_lo:[1,0,0]
  v_pk_fma_f32 v[86:87], v[86:87], v[54:55], v[76:77] op_sel:[1,1,0] op_sel_hi:[0,1,1] neg_lo:[1,0,0]
  v_cvt_pk_bf16_f32 v100, v80, v81
  v_cvt_pk_bf16_f32 v101, v88, v89
  ds_write2_b64 v9, v[98:99], v[100:101] offset0:0 offset1:68
  v_cvt_pk_bf16_f32 v94, v78, v79
  v_cvt_pk_bf16_f32 v95, v86, v87
  v_pk_mul_f32 v[70:71], v[78:79], v[36:37] op_sel:[0,0] op_sel_hi:[1,0]
  v_pk_mul_f32 v[72:73], v[86:87], v[54:55] op_sel:[0,0] op_sel_hi:[1,0]
  v_pk_mul_f32 v[74:75], v[80:81], v[36:37] op_sel:[0,0] op_sel_hi:[1,0]
  v_pk_mul_f32 v[76:77], v[88:89], v[54:55] op_sel:[0,0] op_sel_hi:[1,0]
  v_pk_fma_f32 v[78:79], v[78:79], v[36:37], v[70:71] op_sel:[1,1,0] op_sel_hi:[0,1,1] neg_lo:[1,0,0]
  v_pk_fma_f32 v[86:87], v[86:87], v[54:55], v[72:73] op_sel:[1,1,0] op_sel_hi:[0,1,1] neg_lo:[1,0,0]
  v_pk_fma_f32 v[80:81], v[80:81], v[36:37], v[74:75] op_sel:[1,1,0] op_sel_hi:[0,1,1] neg_lo:[1,0,0]
  v_pk_fma_f32 v[88:89], v[88:89], v[54:55], v[76:77] op_sel:[1,1,0] op_sel_hi:[0,1,1] neg_lo:[1,0,0]
  v_cvt_pk_bf16_f32 v96, v78, v79
  v_cvt_pk_bf16_f32 v97, v86, v87
  ds_write2_b64 v7, v[94:95], v[96:97] offset0:136 offset1:204
  v_cvt_pk_bf16_f32 v98, v80, v81
  v_cvt_pk_bf16_f32 v99, v88, v89
  v_pk_mul_f32 v[70:71], v[80:81], v[36:37] op_sel:[0,0] op_sel_hi:[1,0]
  v_pk_mul_f32 v[72:73], v[88:89], v[54:55] op_sel:[0,0] op_sel_hi:[1,0]
  v_pk_fma_f32 v[80:81], v[80:81], v[36:37], v[70:71] op_sel:[1,1,0] op_sel_hi:[0,1,1] neg_lo:[1,0,0]
  v_pk_fma_f32 v[88:89], v[88:89], v[54:55], v[72:73] op_sel:[1,1,0] op_sel_hi:[0,1,1] neg_lo:[1,0,0]
  v_cvt_pk_bf16_f32 v100, v80, v81
  v_cvt_pk_bf16_f32 v101, v88, v89
  ds_write2_b64 v9, v[98:99], v[100:101] offset0:136 offset1:204
  ds_read_b128 v[134:137], v17 offset:0
  ds_read_b128 v[138:141], v17 offset:64
  ds_read_b128 v[142:145], v17 offset:128
  ds_read_b128 v[146:149], v17 offset:192
  ds_read_b128 v[150:153], v17 offset:256
  ds_read_b128 v[154:157], v17 offset:320
  ds_read_b128 v[158:161], v17 offset:384
  ds_read_b128 v[162:165], v17 offset:448
  v_pk_mul_f32 v[74:75], v[34:35], v[50:51] op_sel:[0,0] op_sel_hi:[1,0]
  v_pk_mul_f32 v[76:77], v[52:53], v[68:69] op_sel:[0,0] op_sel_hi:[1,0]
  v_pk_fma_f32 v[78:79], v[34:35], v[50:51], v[74:75] op_sel:[1,1,0] op_sel_hi:[0,1,1] neg_lo:[1,0,0]
  v_pk_fma_f32 v[86:87], v[52:53], v[68:69], v[76:77] op_sel:[1,1,0] op_sel_hi:[0,1,1] neg_lo:[1,0,0]
  v_pk_mul_f32 v[70:71], v[78:79], v[44:45] op_sel:[0,0] op_sel_hi:[1,0]
  v_pk_mul_f32 v[72:73], v[86:87], v[62:63] op_sel:[0,0] op_sel_hi:[1,0]
  v_pk_fma_f32 v[80:81], v[78:79], v[44:45], v[70:71] op_sel:[1,1,0] op_sel_hi:[0,1,1] neg_lo:[1,0,0]
  v_pk_fma_f32 v[88:89], v[86:87], v[62:63], v[72:73] op_sel:[1,1,0] op_sel_hi:[0,1,1] neg_lo:[1,0,0]
  v_cvt_pk_bf16_f32 v94, v78, v79
  s_waitcnt lgkmcnt(7)
  v_mfma_f32_16x16x32_bf16 v[24:27], v[134:137], v[102:105], 0
  v_cvt_pk_bf16_f32 v95, v86, v87
  v_cvt_pk_bf16_f32 v96, v80, v81
  v_cvt_pk_bf16_f32 v97, v88, v89
  s_waitcnt lgkmcnt(6)
  v_mfma_f32_16x16x32_bf16 v[24:27], v[138:141], v[106:109], v[24:27]
  ds_write2_b64 v16, v[94:95], v[96:97] offset0:0 offset1:68
  v_pk_mul_f32 v[74:75], v[78:79], v[46:47] op_sel:[0,0] op_sel_hi:[1,0]
  v_pk_mul_f32 v[76:77], v[86:87], v[64:65] op_sel:[0,0] op_sel_hi:[1,0]
  s_waitcnt lgkmcnt(6)
  v_mfma_f32_16x16x32_bf16 v[24:27], v[142:145], v[110:113], v[24:27]
  v_pk_mul_f32 v[70:71], v[80:81], v[46:47] op_sel:[0,0] op_sel_hi:[1,0]
  v_pk_mul_f32 v[72:73], v[88:89], v[64:65] op_sel:[0,0] op_sel_hi:[1,0]
  v_pk_fma_f32 v[78:79], v[78:79], v[46:47], v[74:75] op_sel:[1,1,0] op_sel_hi:[0,1,1] neg_lo:[1,0,0]
  s_waitcnt lgkmcnt(5)
  v_mfma_f32_16x16x32_bf16 v[24:27], v[146:149], v[114:117], v[24:27]
  v_pk_fma_f32 v[86:87], v[86:87], v[64:65], v[76:77] op_sel:[1,1,0] op_sel_hi:[0,1,1] neg_lo:[1,0,0]
  v_pk_fma_f32 v[80:81], v[80:81], v[46:47], v[70:71] op_sel:[1,1,0] op_sel_hi:[0,1,1] neg_lo:[1,0,0]
  v_pk_fma_f32 v[88:89], v[88:89], v[64:65], v[72:73] op_sel:[1,1,0] op_sel_hi:[0,1,1] neg_lo:[1,0,0]
  s_waitcnt lgkmcnt(4)
  v_mfma_f32_16x16x32_bf16 v[24:27], v[150:153], v[118:121], v[24:27]
  v_cvt_pk_bf16_f32 v98, v78, v79
  v_cvt_pk_bf16_f32 v99, v86, v87
  v_cvt_pk_bf16_f32 v100, v80, v81
  s_waitcnt lgkmcnt(3)
  v_mfma_f32_16x16x32_bf16 v[24:27], v[154:157], v[122:125], v[24:27]
  v_cvt_pk_bf16_f32 v101, v88, v89
  ds_write2_b64 v16, v[98:99], v[100:101] offset0:136 offset1:204
  v_pk_mul_f32 v[74:75], v[78:79], v[46:47] op_sel:[0,0] op_sel_hi:[1,0]
  s_waitcnt lgkmcnt(3)
  v_mfma_f32_16x16x32_bf16 v[24:27], v[158:161], v[126:129], v[24:27]
  v_pk_mul_f32 v[76:77], v[86:87], v[64:65] op_sel:[0,0] op_sel_hi:[1,0]
  v_pk_mul_f32 v[70:71], v[80:81], v[46:47] op_sel:[0,0] op_sel_hi:[1,0]
  v_pk_mul_f32 v[72:73], v[88:89], v[64:65] op_sel:[0,0] op_sel_hi:[1,0]
  s_waitcnt lgkmcnt(2)
  v_mfma_f32_16x16x32_bf16 v[24:27], v[162:165], v[130:133], v[24:27]
  v_pk_fma_f32 v[78:79], v[78:79], v[46:47], v[74:75] op_sel:[1,1,0] op_sel_hi:[0,1,1] neg_lo:[1,0,0]
  v_pk_fma_f32 v[86:87], v[86:87], v[64:65], v[76:77] op_sel:[1,1,0] op_sel_hi:[0,1,1] neg_lo:[1,0,0]
  v_pk_fma_f32 v[80:81], v[80:81], v[46:47], v[70:71] op_sel:[1,1,0] op_sel_hi:[0,1,1] neg_lo:[1,0,0]
  v_pk_fma_f32 v[88:89], v[88:89], v[64:65], v[72:73] op_sel:[1,1,0] op_sel_hi:[0,1,1] neg_lo:[1,0,0]
  v_cvt_pk_bf16_f32 v94, v78, v79
  v_cvt_pk_bf16_f32 v95, v86, v87
  v_cvt_pk_bf16_f32 v96, v80, v81
  v_cvt_pk_bf16_f32 v97, v88, v89
  ds_write2_b64 v7, v[94:95], v[96:97] offset0:0 offset1:68
  v_pk_mul_f32 v[74:75], v[78:79], v[46:47] op_sel:[0,0] op_sel_hi:[1,0]
  v_pk_mul_f32 v[76:77], v[86:87], v[64:65] op_sel:[0,0] op_sel_hi:[1,0]
  v_pk_mul_f32 v[70:71], v[80:81], v[46:47] op_sel:[0,0] op_sel_hi:[1,0]
  v_pk_mul_f32 v[72:73], v[88:89], v[64:65] op_sel:[0,0] op_sel_hi:[1,0]
  v_pk_fma_f32 v[78:79], v[78:79], v[46:47], v[74:75] op_sel:[1,1,0] op_sel_hi:[0,1,1] neg_lo:[1,0,0]
  v_pk_fma_f32 v[86:87], v[86:87], v[64:65], v[76:77] op_sel:[1,1,0] op_sel_hi:[0,1,1] neg_lo:[1,0,0]
  v_pk_fma_f32 v[80:81], v[80:81], v[46:47], v[70:71] op_sel:[1,1,0] op_sel_hi:[0,1,1] neg_lo:[1,0,0]
  v_pk_fma_f32 v[88:89], v[88:89], v[64:65], v[72:73] op_sel:[1,1,0] op_sel_hi:[0,1,1] neg_lo:[1,0,0]
  v_cvt_pk_bf16_f32 v98, v78, v79
  v_cvt_pk_bf16_f32 v99, v86, v87
  v_cvt_pk_bf16_f32 v100, v80, v81
  v_cvt_pk_bf16_f32 v101, v88, v89
  ds_write2_b64 v7, v[98:99], v[100:101] offset0:136 offset1:204
  v_pk_mul_f32 v[74:75], v[78:79], v[46:47] op_sel:[0,0] op_sel_hi:[1,0]
  v_pk_mul_f32 v[76:77], v[86:87], v[64:65] op_sel:[0,0] op_sel_hi:[1,0]
  v_pk_fma_f32 v[78:79], v[78:79], v[46:47], v[74:75] op_sel:[1,1,0] op_sel_hi:[0,1,1] neg_lo:[1,0,0]
  v_pk_fma_f32 v[86:87], v[86:87], v[64:65], v[76:77] op_sel:[1,1,0] op_sel_hi:[0,1,1] neg_lo:[1,0,0]
  v_cvt_pk_bf16_f32 v94, v78, v79
  v_cvt_pk_bf16_f32 v95, v86, v87
  ds_write_b64 v8, v[94:95] offset:0
  ds_read_b128 v[134:137], v17 offset:0
  ds_read_b128 v[138:141], v17 offset:64
  ds_read_b128 v[142:145], v17 offset:128
  ds_read_b128 v[146:149], v17 offset:192
  ds_read_b128 v[150:153], v17 offset:256
  ds_read_b128 v[154:157], v17 offset:320
  ds_read_b128 v[158:161], v17 offset:384
  ds_read_b128 v[162:165], v17 offset:448
  v_add_f32 v24, v24, v21
  v_cvt_pk_bf16_f32 v10, v24, v25
  v_cvt_pk_bf16_f32 v11, v26, v27
  ds_write_b64 v20, v[10:11]
  v_pk_mul_f32 v[70:71], v[34:35], v[46:47] op_sel:[0,0] op_sel_hi:[1,0]
  v_pk_mul_f32 v[72:73], v[52:53], v[64:65] op_sel:[0,0] op_sel_hi:[1,0]
  v_pk_mul_f32 v[74:75], v[34:35], v[48:49] op_sel:[0,0] op_sel_hi:[1,0]
  v_pk_mul_f32 v[76:77], v[52:53], v[66:67] op_sel:[0,0] op_sel_hi:[1,0]
  v_pk_fma_f32 v[78:79], v[34:35], v[46:47], v[70:71] op_sel:[1,1,0] op_sel_hi:[0,1,1] neg_lo:[1,0,0]
  v_pk_fma_f32 v[86:87], v[52:53], v[64:65], v[72:73] op_sel:[1,1,0] op_sel_hi:[0,1,1] neg_lo:[1,0,0]
  v_pk_fma_f32 v[82:83], v[34:35], v[48:49], v[74:75] op_sel:[1,1,0] op_sel_hi:[0,1,1] neg_lo:[1,0,0]
  s_waitcnt lgkmcnt(8)
  v_mfma_f32_16x16x32_bf16 v[24:27], v[102:105], v[134:137], 0
  v_pk_fma_f32 v[90:91], v[52:53], v[66:67], v[76:77] op_sel:[1,1,0] op_sel_hi:[0,1,1] neg_lo:[1,0,0]
  v_pk_mul_f32 v[70:71], v[78:79], v[44:45] op_sel:[0,0] op_sel_hi:[1,0]
  v_pk_mul_f32 v[72:73], v[86:87], v[62:63] op_sel:[0,0] op_sel_hi:[1,0]
  s_waitcnt lgkmcnt(7)
  v_mfma_f32_16x16x32_bf16 v[24:27], v[106:109], v[138:141], v[24:27]
  v_pk_mul_f32 v[74:75], v[82:83], v[40:41] op_sel:[0,0] op_sel_hi:[1,0]
  v_pk_mul_f32 v[76:77], v[90:91], v[58:59] op_sel:[0,0] op_sel_hi:[1,0]
  v_pk_fma_f32 v[80:81], v[78:79], v[44:45], v[70:71] op_sel:[1,1,0] op_sel_hi:[0,1,1] neg_lo:[1,0,0]
  s_waitcnt lgkmcnt(6)
  v_mfma_f32_16x16x32_bf16 v[24:27], v[110:113], v[142:145], v[24:27]
  v_pk_fma_f32 v[88:89], v[86:87], v[62:63], v[72:73] op_sel:[1,1,0] op_sel_hi:[0,1,1] neg_lo:[1,0,0]
  v_pk_fma_f32 v[84:85], v[82:83], v[40:41], v[74:75] op_sel:[1,1,0] op_sel_hi:[0,1,1] neg_lo:[1,0,0]
  v_pk_fma_f32 v[92:93], v[90:91], v[58:59], v[76:77] op_sel:[1,1,0] op_sel_hi:[0,1,1] neg_lo:[1,0,0]
  s_waitcnt lgkmcnt(5)
  v_mfma_f32_16x16x32_bf16 v[24:27], v[114:117], v[146:149], v[24:27]
  v_cvt_pk_bf16_f32 v98, v82, v83
  v_cvt_pk_bf16_f32 v99, v90, v91
  v_cvt_pk_bf16_f32 v100, v84, v85
  s_waitcnt lgkmcnt(4)
  v_mfma_f32_16x16x32_bf16 v[24:27], v[118:121], v[150:153], v[24:27]
  v_cvt_pk_bf16_f32 v101, v92, v93
  ds_write2_b64 v8, v[98:99], v[100:101] offset0:0 offset1:68
  v_cvt_pk_bf16_f32 v94, v78, v79
  s_waitcnt lgkmcnt(4)
  v_mfma_f32_16x16x32_bf16 v[24:27], v[122:125], v[154:157], v[24:27]
  v_cvt_pk_bf16_f32 v95, v86, v87
  v_cvt_pk_bf16_f32 v96, v80, v81
  v_cvt_pk_bf16_f32 v97, v88, v89
  s_waitcnt lgkmcnt(3)
  v_mfma_f32_16x16x32_bf16 v[24:27], v[126:129], v[158:161], v[24:27]
  v_pk_mul_f32 v[70:71], v[78:79], v[38:39] op_sel:[0,0] op_sel_hi:[1,0]
  v_pk_mul_f32 v[72:73], v[86:87], v[56:57] op_sel:[0,0] op_sel_hi:[1,0]
  v_pk_mul_f32 v[74:75], v[80:81], v[38:39] op_sel:[0,0] op_sel_hi:[1,0]
  s_waitcnt lgkmcnt(2)
  v_mfma_f32_16x16x32_bf16 v[24:27], v[130:133], v[162:165], v[24:27]
  v_pk_mul_f32 v[76:77], v[88:89], v[56:57] op_sel:[0,0] op_sel_hi:[1,0]
  v_pk_fma_f32 v[78:79], v[78:79], v[38:39], v[70:71] op_sel:[1,1,0] op_sel_hi:[0,1,1] neg_lo:[1,0,0]
  v_pk_fma_f32 v[86:87], v[86:87], v[56:57], v[72:73] op_sel:[1,1,0] op_sel_hi:[0,1,1] neg_lo:[1,0,0]
  v_pk_fma_f32 v[80:81], v[80:81], v[38:39], v[74:75] op_sel:[1,1,0] op_sel_hi:[0,1,1] neg_lo:[1,0,0]
  v_pk_fma_f32 v[88:89], v[88:89], v[56:57], v[76:77] op_sel:[1,1,0] op_sel_hi:[0,1,1] neg_lo:[1,0,0]
  v_cvt_pk_bf16_f32 v98, v78, v79
  v_cvt_pk_bf16_f32 v99, v86, v87
  v_cvt_pk_bf16_f32 v100, v80, v81
  v_cvt_pk_bf16_f32 v101, v88, v89
  ds_write2_b64 v16, v[94:95], v[98:99] offset0:0 offset1:68
  ds_write2_b64 v7, v[96:97], v[100:101] offset0:0 offset1:68
  v_pk_mul_f32 v[70:71], v[82:83], v[44:45] op_sel:[0,0] op_sel_hi:[1,0]
  v_pk_mul_f32 v[72:73], v[90:91], v[62:63] op_sel:[0,0] op_sel_hi:[1,0]
  v_pk_fma_f32 v[82:83], v[82:83], v[44:45], v[70:71] op_sel:[1,1,0] op_sel_hi:[0,1,1] neg_lo:[1,0,0]
  v_pk_fma_f32 v[90:91], v[90:91], v[62:63], v[72:73] op_sel:[1,1,0] op_sel_hi:[0,1,1] neg_lo:[1,0,0]
  v_cvt_pk_bf16_f32 v12, v24, v25
  v_pk_mul_f32 v[74:75], v[82:83], v[40:41] op_sel:[0,0] op_sel_hi:[1,0]
  v_pk_mul_f32 v[76:77], v[90:91], v[58:59] op_sel:[0,0] op_sel_hi:[1,0]
  v_cvt_pk_bf16_f32 v13, v26, v27
  v_pk_fma_f32 v[84:85], v[82:83], v[40:41], v[74:75] op_sel:[1,1,0] op_sel_hi:[0,1,1] neg_lo:[1,0,0]
  v_pk_fma_f32 v[92:93], v[90:91], v[58:59], v[76:77] op_sel:[1,1,0] op_sel_hi:[0,1,1] neg_lo:[1,0,0]
  ds_write_b64 v6, v[12:13] offset:512
  v_cvt_pk_bf16_f32 v98, v82, v83
  v_cvt_pk_bf16_f32 v99, v90, v91
  v_lshl_add_u32 v14, v1, 1, s62
  v_cvt_pk_bf16_f32 v100, v84, v85
  v_cvt_pk_bf16_f32 v101, v92, v93
  ds_read_u16 v10, v14 offset:512
  ds_write2_b64 v8, v[98:99], v[100:101] offset0:136 offset1:204
  v_pk_mul_f32 v[70:71], v[78:79], v[38:39] op_sel:[0,0] op_sel_hi:[1,0]
  ds_read_u16 v11, v14 offset:514
  v_pk_mul_f32 v[72:73], v[86:87], v[56:57] op_sel:[0,0] op_sel_hi:[1,0]
  v_pk_mul_f32 v[74:75], v[80:81], v[38:39] op_sel:[0,0] op_sel_hi:[1,0]
  ds_read_u16 v12, v14 offset:640
  v_pk_mul_f32 v[76:77], v[88:89], v[56:57] op_sel:[0,0] op_sel_hi:[1,0]
  v_pk_fma_f32 v[78:79], v[78:79], v[38:39], v[70:71] op_sel:[1,1,0] op_sel_hi:[0,1,1] neg_lo:[1,0,0]
  ds_read_u16 v13, v14 offset:642
  v_pk_fma_f32 v[86:87], v[86:87], v[56:57], v[72:73] op_sel:[1,1,0] op_sel_hi:[0,1,1] neg_lo:[1,0,0]
  v_pk_fma_f32 v[80:81], v[80:81], v[38:39], v[74:75] op_sel:[1,1,0] op_sel_hi:[0,1,1] neg_lo:[1,0,0]
  v_and_b32 v22, 1, v1
  v_pk_fma_f32 v[88:89], v[88:89], v[56:57], v[76:77] op_sel:[1,1,0] op_sel_hi:[0,1,1] neg_lo:[1,0,0]
  v_cvt_pk_bf16_f32 v94, v78, v79
  v_mov_b32 v23, 0x05040100
  v_cvt_pk_bf16_f32 v95, v86, v87
  v_cvt_pk_bf16_f32 v96, v80, v81
  v_mov_b32 v32, 0x05040504
  v_cvt_pk_bf16_f32 v97, v88, v89
  v_pk_mul_f32 v[70:71], v[82:83], v[44:45] op_sel:[0,0] op_sel_hi:[1,0]
  v_cmp_eq_u32 vcc, 1, v22
  v_pk_mul_f32 v[72:73], v[90:91], v[62:63] op_sel:[0,0] op_sel_hi:[1,0]
  v_pk_fma_f32 v[82:83], v[82:83], v[44:45], v[70:71] op_sel:[1,1,0] op_sel_hi:[0,1,1] neg_lo:[1,0,0]
  v_lshl_add_u32 v15, v1, 4, s61
  v_pk_fma_f32 v[90:91], v[90:91], v[62:63], v[72:73] op_sel:[1,1,0] op_sel_hi:[0,1,1] neg_lo:[1,0,0]
  v_pk_mul_f32 v[74:75], v[82:83], v[40:41] op_sel:[0,0] op_sel_hi:[1,0]
  v_cndmask_b32 v23, v23, v32, vcc
  v_pk_mul_f32 v[76:77], v[90:91], v[58:59] op_sel:[0,0] op_sel_hi:[1,0]
  v_pk_fma_f32 v[84:85], v[82:83], v[40:41], v[74:75] op_sel:[1,1,0] op_sel_hi:[0,1,1] neg_lo:[1,0,0]
  s_waitcnt lgkmcnt(4)
  v_perm_b32 v28, v10, v10, s48
  v_pk_fma_f32 v[92:93], v[90:91], v[58:59], v[76:77] op_sel:[1,1,0] op_sel_hi:[0,1,1] neg_lo:[1,0,0]
  v_cvt_pk_bf16_f32 v98, v82, v83
  s_waitcnt lgkmcnt(2)
  v_perm_b32 v30, v11, v10, v23
  v_cvt_pk_bf16_f32 v99, v90, v91
  v_cvt_pk_bf16_f32 v100, v84, v85
  v_mov_b32 v29, v28
  v_cvt_pk_bf16_f32 v101, v92, v93
  ds_write2_b64 v9, v[98:99], v[100:101] offset0:0 offset1:68
  v_perm_b32 v31, v11, v11, s48
  v_pk_mul_f32 v[70:71], v[78:79], v[38:39] op_sel:[0,0] op_sel_hi:[1,0]
  v_pk_mul_f32 v[72:73], v[86:87], v[56:57] op_sel:[0,0] op_sel_hi:[1,0]
  ds_write_b128 v15, v[28:31] offset:2048
  v_pk_mul_f32 v[74:75], v[80:81], v[38:39] op_sel:[0,0] op_sel_hi:[1,0]
  v_pk_mul_f32 v[76:77], v[88:89], v[56:57] op_sel:[0,0] op_sel_hi:[1,0]
  s_waitcnt lgkmcnt(3)
  v_perm_b32 v28, v12, v12, s48
  v_pk_fma_f32 v[78:79], v[78:79], v[38:39], v[70:71] op_sel:[1,1,0] op_sel_hi:[0,1,1] neg_lo:[1,0,0]
  v_pk_fma_f32 v[86:87], v[86:87], v[56:57], v[72:73] op_sel:[1,1,0] op_sel_hi:[0,1,1] neg_lo:[1,0,0]
  s_waitcnt lgkmcnt(2)
  v_perm_b32 v30, v13, v12, v23
  v_pk_fma_f32 v[80:81], v[80:81], v[38:39], v[74:75] op_sel:[1,1,0] op_sel_hi:[0,1,1] neg_lo:[1,0,0]
  v_pk_fma_f32 v[88:89], v[88:89], v[56:57], v[76:77] op_sel:[1,1,0] op_sel_hi:[0,1,1] neg_lo:[1,0,0]
  v_mov_b32 v29, v28
  v_cvt_pk_bf16_f32 v98, v78, v79
  v_cvt_pk_bf16_f32 v99, v86, v87
  v_perm_b32 v31, v13, v13, s48
  v_cvt_pk_bf16_f32 v100, v80, v81
  v_cvt_pk_bf16_f32 v101, v88, v89
  ds_write_b128 v15, v[28:31] offset:3072
  ds_write2_b64 v16, v[94:95], v[98:99] offset0:136 offset1:204
  ds_write2_b64 v7, v[96:97], v[100:101] offset0:136 offset1:204
  v_pk_mul_f32 v[70:71], v[82:83], v[44:45] op_sel:[0,0] op_sel_hi:[1,0]
  v_pk_mul_f32 v[72:73], v[90:91], v[62:63] op_sel:[0,0] op_sel_hi:[1,0]
  v_pk_fma_f32 v[82:83], v[82:83], v[44:45], v[70:71] op_sel:[1,1,0] op_sel_hi:[0,1,1] neg_lo:[1,0,0]
  v_pk_fma_f32 v[90:91], v[90:91], v[62:63], v[72:73] op_sel:[1,1,0] op_sel_hi:[0,1,1] neg_lo:[1,0,0]
  v_pk_mul_f32 v[74:75], v[82:83], v[40:41] op_sel:[0,0] op_sel_hi:[1,0]
  v_pk_mul_f32 v[76:77], v[90:91], v[58:59] op_sel:[0,0] op_sel_hi:[1,0]
  v_pk_fma_f32 v[84:85], v[82:83], v[40:41], v[74:75] op_sel:[1,1,0] op_sel_hi:[0,1,1] neg_lo:[1,0,0]
  v_pk_fma_f32 v[92:93], v[90:91], v[58:59], v[76:77] op_sel:[1,1,0] op_sel_hi:[0,1,1] neg_lo:[1,0,0]
  v_cvt_pk_bf16_f32 v98, v82, v83
  v_cvt_pk_bf16_f32 v99, v90, v91
  v_cvt_pk_bf16_f32 v100, v84, v85
  v_cvt_pk_bf16_f32 v101, v92, v93
  ds_write2_b64 v9, v[98:99], v[100:101] offset0:136 offset1:204
  ds_read_b128 v[134:137], v17 offset:0
  ds_read_b128 v[138:141], v17 offset:64
  ds_read_b128 v[142:145], v17 offset:128
  ds_read_b128 v[146:149], v17 offset:192
  ds_read_b128 v[150:153], v17 offset:256
  ds_read_b128 v[154:157], v17 offset:320
  ds_read_b128 v[158:161], v17 offset:384
  ds_read_b128 v[162:165], v17 offset:448
  v_and_b32 v34, 31, v1
  v_lshl_add_u32 v35, v34, 3, s62
  v_lshl_add_u32 v36, v34, 4, s61
  v_lshl_add_u32 v37, v1, 2, s62
  v_lshl_add_u32 v38, v1, 4, s61
  s_waitcnt lgkmcnt(7)
  v_mfma_f32_16x16x32_bf16 v[28:31], v[134:137], v[102:105], 0
  s_waitcnt lgkmcnt(6)
  v_mfma_f32_16x16x32_bf16 v[28:31], v[138:141], v[106:109], v[28:31]
  s_waitcnt lgkmcnt(5)
  v_mfma_f32_16x16x32_bf16 v[28:31], v[142:145], v[110:113], v[28:31]
  s_waitcnt lgkmcnt(4)
  v_mfma_f32_16x16x32_bf16 v[28:31], v[146:149], v[114:117], v[28:31]
  s_waitcnt lgkmcnt(3)
  v_mfma_f32_16x16x32_bf16 v[28:31], v[150:153], v[118:121], v[28:31]
  s_waitcnt lgkmcnt(2)
  v_mfma_f32_16x16x32_bf16 v[28:31], v[154:157], v[122:125], v[28:31]
  s_waitcnt lgkmcnt(1)
  v_mfma_f32_16x16x32_bf16 v[28:31], v[158:161], v[126:129], v[28:31]
  s_waitcnt lgkmcnt(0)
  v_mfma_f32_16x16x32_bf16 v[28:31], v[162:165], v[130:133], v[28:31]
  s_nop 7
  v_cvt_pk_bf16_f32 v40, v28, v29
  v_cvt_pk_bf16_f32 v41, v30, v31
  ds_write_b32 v18, v40
  ds_write_b32 v19, v41
  ds_read_b64 v[78:79], v35
  ds_read_b32 v80, v35 offset:8
  ds_read2_b32 v[82:83], v37 offset0:64 offset1:65
  ds_read_b64_tr_b16 v[16:17], v2 offset:0
  ds_read_b64_tr_b16 v[18:19], v2 offset:32
  ds_read_b64_tr_b16 v[20:21], v2 offset:256
  ds_read_b64_tr_b16 v[22:23], v2 offset:288
  s_waitcnt lgkmcnt(6)
  v_perm_b32 v88, v78, v78, s48
  v_perm_b32 v89, v79, v78, s50
  v_perm_b32 v90, v79, v79, s48
  s_waitcnt lgkmcnt(5)
  v_perm_b32 v91, v80, v79, s50
  ds_write_b128 v36, v[88:91] offset:512
  s_waitcnt lgkmcnt(5)
  v_perm_b32 v92, v82, v82, s48
  v_mov_b32 v93, v82
  v_perm_b32 v94, v82, v82, s49
  v_perm_b32 v95, v83, v83, s48
  ds_write_b128 v38, v[92:95] offset:1024
  ds_read_b64_tr_b16 v[24:25], v2 offset:512
  ds_read_b64_tr_b16 v[26:27], v2 offset:544
  ds_read_b64_tr_b16 v[28:29], v2 offset:768
  ds_read_b64_tr_b16 v[30:31], v2 offset:800
  ds_read_b64_tr_b16 v[32:33], v2 offset:1024
  ds_read_b64_tr_b16 v[34:35], v2 offset:1056
  ds_read_b64_tr_b16 v[36:37], v2 offset:1280
  ds_read_b64_tr_b16 v[38:39], v2 offset:1312
  ds_read_b64_tr_b16 v[40:41], v2 offset:1536
  ds_read_b64_tr_b16 v[42:43], v2 offset:1568
  ds_read_b64_tr_b16 v[44:45], v2 offset:1792
  ds_read_b64_tr_b16 v[46:47], v2 offset:1824
  v_mov_b32 v10, 0
  v_mov_b32 v11, 0
  v_mov_b32 v12, 0
  v_mov_b32 v13, 0
  v_mov_b32 v14, 0
  v_mov_b32 v15, 0
  s_waitcnt lgkmcnt(0)
  s_barrier
  s_setprio 0
  ds_read_b64 v[144:145], v3 offset:960
  ds_read_b64 v[146:147], v3 offset:968
  ds_read_b64 v[148:149], v3 offset:2112
  ds_read_b64 v[150:151], v3 offset:2120
  ds_read_b64 v[152:153], v3 offset:3264
  ds_read_b64 v[154:155], v3 offset:3272
  ds_read_b64 v[156:157], v3 offset:4416
  ds_read_b64 v[158:159], v3 offset:4424
  ds_read_b64 v[160:161], v3 offset:896
  ds_read_b64 v[162:163], v3 offset:904
  s_waitcnt lgkmcnt(8)
  v_mfma_f32_16x16x32_bf16 v[80:83], v[20:23], v[144:147], 0
  v_mfma_f32_16x16x32_bf16 v[96:99], v[28:31], v[144:147], 0
  v_mfma_f32_16x16x32_bf16 v[112:115], v[36:39], v[144:147], 0
  v_mfma_f32_16x16x32_bf16 v[128:131], v[44:47], v[144:147], 0
  ds_read_b64 v[144:145], v3 offset:2048
  ds_read_b64 v[146:147], v3 offset:2056
  s_waitcnt lgkmcnt(8)
  v_mfma_f32_16x16x32_bf16 v[84:87], v[20:23], v[148:151], 0
  v_mfma_f32_16x16x32_bf16 v[100:103], v[28:31], v[148:151], 0
  v_mfma_f32_16x16x32_bf16 v[116:119], v[36:39], v[148:151], 0
  v_mfma_f32_16x16x32_bf16 v[132:135], v[44:47], v[148:151], 0
  ds_read_b64 v[148:149], v3 offset:3200
  ds_read_b64 v[150:151], v3 offset:3208
  s_waitcnt lgkmcnt(8)
  v_mfma_f32_16x16x32_bf16 v[88:91], v[20:23], v[152:155], 0
  v_mfma_f32_16x16x32_bf16 v[104:107], v[28:31], v[152:155], 0
  v_mfma_f32_16x16x32_bf16 v[120:123], v[36:39], v[152:155], 0
  v_mfma_f32_16x16x32_bf16 v[136:139], v[44:47], v[152:155], 0
  ds_read_b64 v[152:153], v3 offset:4352
  ds_read_b64 v[154:155], v3 offset:4360
  s_waitcnt lgkmcnt(8)
  v_mfma_f32_16x16x32_bf16 v[92:95], v[20:23], v[156:159], 0
  v_mfma_f32_16x16x32_bf16 v[108:111], v[28:31], v[156:159], 0
  v_mfma_f32_16x16x32_bf16 v[124:127], v[36:39], v[156:159], 0
  v_mfma_f32_16x16x32_bf16 v[140:143], v[44:47], v[156:159], 0
  ds_read_b64 v[156:157], v3 offset:832
  ds_read_b64 v[158:159], v3 offset:840
  s_waitcnt lgkmcnt(8)
  v_mfma_f32_16x16x32_bf16 v[80:83], v[16:19], v[160:163], v[80:83]
  v_mfma_f32_16x16x32_bf16 v[96:99], v[24:27], v[160:163], v[96:99]
  v_mfma_f32_16x16x32_bf16 v[112:115], v[32:35], v[160:163], v[112:115]
  v_mfma_f32_16x16x32_bf16 v[128:131], v[40:43], v[160:163], v[128:131]
  ds_read_b64 v[160:161], v3 offset:1984
  ds_read_b64 v[162:163], v3 offset:1992
  s_waitcnt lgkmcnt(8)
  v_mfma_f32_16x16x32_bf16 v[84:87], v[16:19], v[144:147], v[84:87]
  v_mfma_f32_16x16x32_bf16 v[100:103], v[24:27], v[144:147], v[100:103]
  v_mfma_f32_16x16x32_bf16 v[116:119], v[32:35], v[144:147], v[116:119]
  v_mfma_f32_16x16x32_bf16 v[132:135], v[40:43], v[144:147], v[132:135]
  ds_read_b64 v[144:145], v3 offset:3136
  ds_read_b64 v[146:147], v3 offset:3144
  s_waitcnt lgkmcnt(8)
  v_mfma_f32_16x16x32_bf16 v[88:91], v[16:19], v[148:151], v[88:91]
  v_mfma_f32_16x16x32_bf16 v[104:107], v[24:27], v[148:151], v[104:107]
  v_mfma_f32_16x16x32_bf16 v[120:123], v[32:35], v[148:151], v[120:123]
  v_mfma_f32_16x16x32_bf16 v[136:139], v[40:43], v[148:151], v[136:139]
  ds_read_b64 v[148:149], v3 offset:4288
  ds_read_b64 v[150:151], v3 offset:4296
  s_waitcnt lgkmcnt(8)
  v_mfma_f32_16x16x32_bf16 v[92:95], v[16:19], v[152:155], v[92:95]
  v_mfma_f32_16x16x32_bf16 v[108:111], v[24:27], v[152:155], v[108:111]
  ds_read_b64_tr_b16 v[48:49], v2 offset:2048
  v_mfma_f32_16x16x32_bf16 v[124:127], v[32:35], v[152:155], v[124:127]
  ds_read_b64_tr_b16 v[50:51], v2 offset:2080
  v_mfma_f32_16x16x32_bf16 v[140:143], v[40:43], v[152:155], v[140:143]
  ds_read_b64_tr_b16 v[52:53], v2 offset:2304
  ds_read_b64 v[152:153], v3 offset:768
  ds_read_b64 v[154:155], v3 offset:776
  s_waitcnt lgkmcnt(11)
  v_mfma_f32_16x16x32_bf16 v[96:99], v[20:23], v[156:159], v[96:99]
  ds_read_b64_tr_b16 v[54:55], v2 offset:2336
  v_mfma_f32_16x16x32_bf16 v[112:115], v[28:31], v[156:159], v[112:115]
  ds_read_b64_tr_b16 v[56:57], v2 offset:2560
  v_mfma_f32_16x16x32_bf16 v[128:131], v[36:39], v[156:159], v[128:131]
  ds_read_b64_tr_b16 v[58:59], v2 offset:2592
  ds_read_b64 v[156:157], v3 offset:1920
  ds_read_b64 v[158:159], v3 offset:1928
  s_waitcnt lgkmcnt(14)
  v_mfma_f32_16x16x32_bf16 v[100:103], v[20:23], v[160:163], v[100:103]
  ds_read_b64_tr_b16 v[60:61], v2 offset:2816
  v_mfma_f32_16x16x32_bf16 v[116:119], v[28:31], v[160:163], v[116:119]
  ds_read_b64_tr_b16 v[62:63], v2 offset:2848
  v_mfma_f32_16x16x32_bf16 v[132:135], v[36:39], v[160:163], v[132:135]
  ds_read_b64_tr_b16 v[64:65], v2 offset:3072
  ds_read_b64 v[160:161], v3 offset:3072
  ds_read_b64 v[162:163], v3 offset:3080
  s_waitcnt lgkmcnt(15)
  v_mfma_f32_16x16x32_bf16 v[104:107], v[20:23], v[144:147], v[104:107]
  ds_read_b64_tr_b16 v[66:67], v2 offset:3104
  v_mfma_f32_16x16x32_bf16 v[120:123], v[28:31], v[144:147], v[120:123]
  ds_read_b64_tr_b16 v[68:69], v2 offset:3328
  v_mfma_f32_16x16x32_bf16 v[136:139], v[36:39], v[144:147], v[136:139]
  ds_read_b64_tr_b16 v[70:71], v2 offset:3360
  ds_read_b64 v[144:145], v3 offset:4224
  ds_read_b64 v[146:147], v3 offset:4232
  v_mfma_f32_16x16x32_bf16 v[108:111], v[20:23], v[148:151], v[108:111]
  ds_read_b64_tr_b16 v[72:73], v2 offset:3584
  v_mfma_f32_16x16x32_bf16 v[124:127], v[28:31], v[148:151], v[124:127]
  ds_read_b64_tr_b16 v[74:75], v2 offset:3616
  v_mfma_f32_16x16x32_bf16 v[140:143], v[36:39], v[148:151], v[140:143]
  ds_read_b64_tr_b16 v[76:77], v2 offset:3840
  ds_read_b64 v[148:149], v3 offset:704
  ds_read_b64 v[150:151], v3 offset:712
  s_waitcnt lgkmcnt(15)
  v_mfma_f32_16x16x32_bf16 v[96:99], v[16:19], v[152:155], v[96:99]
  ds_read_b64_tr_b16 v[78:79], v2 offset:3872
  v_mfma_f32_16x16x32_bf16 v[112:115], v[24:27], v[152:155], v[112:115]
  v_add_f32 v8, v87, v90
  v_mfma_f32_16x16x32_bf16 v[128:131], v[32:35], v[152:155], v[128:131]
  v_add_f32 v81, v81, v84
  ds_read_b64 v[152:153], v3 offset:1856
  ds_read_b64 v[154:155], v3 offset:1864
  v_mfma_f32_16x16x32_bf16 v[100:103], v[16:19], v[156:159], v[100:103]
  v_add_f32 v8, v8, v93
  v_mfma_f32_16x16x32_bf16 v[116:119], v[24:27], v[156:159], v[116:119]
  v_add_f32 v82, v82, v85
  v_mfma_f32_16x16x32_bf16 v[132:135], v[32:35], v[156:159], v[132:135]
  v_add_f32 v9, v91, v94
  ds_read_b64 v[156:157], v3 offset:3008
  ds_read_b64 v[158:159], v3 offset:3016
  s_waitcnt lgkmcnt(15)
  v_mfma_f32_16x16x32_bf16 v[104:107], v[16:19], v[160:163], v[104:107]
  ds_bpermute_b32 v10, v5, v8
  v_mfma_f32_16x16x32_bf16 v[120:123], v[24:27], v[160:163], v[120:123]
  ds_bpermute_b32 v11, v5, v9
  v_mfma_f32_16x16x32_bf16 v[136:139], v[32:35], v[160:163], v[136:139]
  ds_bpermute_b32 v12, v5, v95
  ds_read_b64 v[160:161], v3 offset:4160
  ds_read_b64 v[162:163], v3 offset:4168
  s_waitcnt lgkmcnt(15)
  v_mfma_f32_16x16x32_bf16 v[108:111], v[16:19], v[144:147], v[108:111]
  v_add_f32 v83, v83, v86
  v_mfma_f32_16x16x32_bf16 v[124:127], v[24:27], v[144:147], v[124:127]
  v_add_f32 v82, v82, v88
  v_mfma_f32_16x16x32_bf16 v[140:143], v[32:35], v[144:147], v[140:143]
  v_add_f32 v83, v83, v89
  ds_read_b64 v[144:145], v3 offset:640
  ds_read_b64 v[146:147], v3 offset:648
  s_waitcnt lgkmcnt(12)
  v_mfma_f32_16x16x32_bf16 v[112:115], v[20:23], v[148:151], v[112:115]
  v_add_f32 v83, v83, v92
  v_mfma_f32_16x16x32_bf16 v[128:131], v[28:31], v[148:151], v[128:131]
  s_waitcnt lgkmcnt(6)
  v_cndmask_b32 v13, v10, v13, s[40:41]
  s_waitcnt lgkmcnt(5)
  v_cndmask_b32 v14, v11, v14, s[40:41]
  s_waitcnt lgkmcnt(4)
  v_cndmask_b32 v15, v12, v15, s[40:41]
  v_add_f32 v80, v80, v13
  v_add_f32 v81, v81, v14
  v_add_f32 v82, v82, v15
  v_cvt_pk_bf16_f32 v6, v80, v81
  v_cvt_pk_bf16_f32 v7, v82, v83
  ds_write_b64 v4, v[6:7] offset:0
  v_mfma_f32_16x16x32_bf16 v[80:83], v[36:39], v[148:151], 0
  v_add_f32 v8, v103, v106
  ds_read_b64 v[148:149], v3 offset:1792
  ds_read_b64 v[150:151], v3 offset:1800
  v_mfma_f32_16x16x32_bf16 v[116:119], v[20:23], v[152:155], v[116:119]
  v_add_f32 v97, v97, v100
  v_mfma_f32_16x16x32_bf16 v[132:135], v[28:31], v[152:155], v[132:135]
  v_add_f32 v8, v8, v109
  v_mfma_f32_16x16x32_bf16 v[84:87], v[36:39], v[152:155], 0
  v_add_f32 v98, v98, v101
  ds_read_b64 v[152:153], v3 offset:2944
  ds_read_b64 v[154:155], v3 offset:2952
  v_mfma_f32_16x16x32_bf16 v[120:123], v[20:23], v[156:159], v[120:123]
  v_add_f32 v9, v107, v110
  v_mfma_f32_16x16x32_bf16 v[136:139], v[28:31], v[156:159], v[136:139]
  ds_bpermute_b32 v13, v5, v8
  v_mfma_f32_16x16x32_bf16 v[88:91], v[36:39], v[156:159], 0
  ds_bpermute_b32 v14, v5, v9
  ds_read_b64 v[156:157], v3 offset:4096
  ds_read_b64 v[158:159], v3 offset:4104
  s_waitcnt lgkmcnt(11)
  v_mfma_f32_16x16x32_bf16 v[124:127], v[20:23], v[160:163], v[124:127]
  ds_bpermute_b32 v15, v5, v111
  v_mfma_f32_16x16x32_bf16 v[140:143], v[28:31], v[160:163], v[140:143]
  v_add_f32 v99, v99, v102
  v_mfma_f32_16x16x32_bf16 v[92:95], v[36:39], v[160:163], 0
  v_add_f32 v98, v98, v104
  ds_read_b64 v[160:161], v3 offset:576
  ds_read_b64 v[162:163], v3 offset:584
  s_waitcnt lgkmcnt(12)
  v_mfma_f32_16x16x32_bf16 v[112:115], v[16:19], v[144:147], v[112:115]
  v_add_f32 v99, v99, v105
  v_mfma_f32_16x16x32_bf16 v[128:131], v[24:27], v[144:147], v[128:131]
  v_add_f32 v99, v99, v108
  v_mfma_f32_16x16x32_bf16 v[80:83], v[32:35], v[144:147], v[80:83]
  ds_read_b64 v[144:145], v3 offset:1728
  ds_read_b64 v[146:147], v3 offset:1736
  s_waitcnt lgkmcnt(11)
  v_mfma_f32_16x16x32_bf16 v[116:119], v[16:19], v[148:151], v[116:119]
  v_mfma_f32_16x16x32_bf16 v[132:135], v[24:27], v[148:151], v[132:135]
  v_mfma_f32_16x16x32_bf16 v[84:87], v[32:35], v[148:151], v[84:87]
  s_waitcnt lgkmcnt(8)
  v_cndmask_b32 v10, v13, v10, s[40:41]
  ds_read_b64 v[148:149], v3 offset:2880
  ds_read_b64 v[150:151], v3 offset:2888
  v_mfma_f32_16x16x32_bf16 v[120:123], v[16:19], v[152:155], v[120:123]
  s_waitcnt lgkmcnt(9)
  v_cndmask_b32 v11, v14, v11, s[40:41]
  v_mfma_f32_16x16x32_bf16 v[136:139], v[24:27], v[152:155], v[136:139]
  s_waitcnt lgkmcnt(6)
  v_cndmask_b32 v12, v15, v12, s[40:41]
  v_mfma_f32_16x16x32_bf16 v[88:91], v[32:35], v[152:155], v[88:91]
  v_add_f32 v96, v96, v10
  ds_read_b64 v[152:153], v3 offset:4032
  ds_read_b64 v[154:155], v3 offset:4040
  v_mfma_f32_16x16x32_bf16 v[124:127], v[16:19], v[156:159], v[124:127]
  v_add_f32 v97, v97, v11
  v_mfma_f32_16x16x32_bf16 v[140:143], v[24:27], v[156:159], v[140:143]
  v_add_f32 v98, v98, v12
  v_mfma_f32_16x16x32_bf16 v[92:95], v[32:35], v[156:159], v[92:95]
  v_cvt_pk_bf16_f32 v6, v96, v97
  ds_read_b64 v[156:157], v3 offset:512
  ds_read_b64 v[158:159], v3 offset:520
  s_waitcnt lgkmcnt(8)
  v_mfma_f32_16x16x32_bf16 v[128:131], v[20:23], v[160:163], v[128:131]
  v_cvt_pk_bf16_f32 v7, v98, v99
  v_mfma_f32_16x16x32_bf16 v[80:83], v[28:31], v[160:163], v[80:83]
  ds_write_b64 v4, v[6:7] offset:576
  v_mfma_f32_16x16x32_bf16 v[96:99], v[36:39], v[160:163], 0
  v_add_f32 v8, v119, v122
  ds_read_b64 v[160:161], v3 offset:1664
  ds_read_b64 v[162:163], v3 offset:1672
  s_waitcnt lgkmcnt(9)
  v_mfma_f32_16x16x32_bf16 v[132:135], v[20:23], v[144:147], v[132:135]
  v_add_f32 v113, v113, v116
  v_mfma_f32_16x16x32_bf16 v[84:87], v[28:31], v[144:147], v[84:87]
  v_add_f32 v8, v8, v125
  v_mfma_f32_16x16x32_bf16 v[100:103], v[36:39], v[144:147], 0
  v_add_f32 v114, v114, v117
  ds_read_b64 v[144:145], v3 offset:2816
  ds_read_b64 v[146:147], v3 offset:2824
  s_waitcnt lgkmcnt(9)
  v_mfma_f32_16x16x32_bf16 v[136:139], v[20:23], v[148:151], v[136:139]
  v_add_f32 v9, v123, v126
  v_mfma_f32_16x16x32_bf16 v[88:91], v[28:31], v[148:151], v[88:91]
  ds_bpermute_b32 v10, v5, v8
  v_mfma_f32_16x16x32_bf16 v[104:107], v[36:39], v[148:151], 0
  ds_bpermute_b32 v11, v5, v9
  ds_read_b64 v[148:149], v3 offset:3968
  ds_read_b64 v[150:151], v3 offset:3976
  s_waitcnt lgkmcnt(11)
  v_mfma_f32_16x16x32_bf16 v[140:143], v[20:23], v[152:155], v[140:143]
  ds_bpermute_b32 v12, v5, v127
  v_mfma_f32_16x16x32_bf16 v[92:95], v[28:31], v[152:155], v[92:95]
  v_add_f32 v115, v115, v118
  v_mfma_f32_16x16x32_bf16 v[108:111], v[36:39], v[152:155], 0
  v_add_f32 v114, v114, v120
  ds_read_b64 v[152:153], v3 offset:960
  ds_read_b64 v[154:155], v3 offset:968
  s_waitcnt lgkmcnt(12)
  v_mfma_f32_16x16x32_bf16 v[128:131], v[16:19], v[156:159], v[128:131]
  v_add_f32 v115, v115, v121
  v_mfma_f32_16x16x32_bf16 v[80:83], v[24:27], v[156:159], v[80:83]
  v_add_f32 v115, v115, v124
  v_mfma_f32_16x16x32_bf16 v[96:99], v[32:35], v[156:159], v[96:99]
  ds_read_b64 v[156:157], v3 offset:2112
  ds_read_b64 v[158:159], v3 offset:2120
  s_waitcnt lgkmcnt(11)
  v_mfma_f32_16x16x32_bf16 v[132:135], v[16:19], v[160:163], v[132:135]
  v_mfma_f32_16x16x32_bf16 v[84:87], v[24:27], v[160:163], v[84:87]
  v_mfma_f32_16x16x32_bf16 v[100:103], v[32:35], v[160:163], v[100:103]
  s_waitcnt lgkmcnt(8)
  v_cndmask_b32 v13, v10, v13, s[40:41]
  ds_read_b64 v[160:161], v3 offset:3264
  ds_read_b64 v[162:163], v3 offset:3272
  v_mfma_f32_16x16x32_bf16 v[136:139], v[16:19], v[144:147], v[136:139]
  s_waitcnt lgkmcnt(9)
  v_cndmask_b32 v14, v11, v14, s[40:41]
  v_mfma_f32_16x16x32_bf16 v[88:91], v[24:27], v[144:147], v[88:91]
  s_waitcnt lgkmcnt(6)
  v_cndmask_b32 v15, v12, v15, s[40:41]
  v_mfma_f32_16x16x32_bf16 v[104:107], v[32:35], v[144:147], v[104:107]
  v_add_f32 v112, v112, v13
  ds_read_b64 v[144:145], v3 offset:4416
  ds_read_b64 v[146:147], v3 offset:4424
  v_mfma_f32_16x16x32_bf16 v[140:143], v[16:19], v[148:151], v[140:143]
  v_add_f32 v113, v113, v14
  v_mfma_f32_16x16x32_bf16 v[92:95], v[24:27], v[148:151], v[92:95]
  v_add_f32 v114, v114, v15
  v_mfma_f32_16x16x32_bf16 v[108:111], v[32:35], v[148:151], v[108:111]
  v_cvt_pk_bf16_f32 v6, v112, v113
  ds_read_b64 v[148:149], v3 offset:896
  ds_read_b64 v[150:151], v3 offset:904
  s_waitcnt lgkmcnt(8)
  v_mfma_f32_16x16x32_bf16 v[80:83], v[52:55], v[152:155], v[80:83]
  v_cvt_pk_bf16_f32 v7, v114, v115
  v_mfma_f32_16x16x32_bf16 v[96:99], v[60:63], v[152:155], v[96:99]
  ds_write_b64 v4, v[6:7] offset:1152
  v_mfma_f32_16x16x32_bf16 v[112:115], v[68:71], v[152:155], 0
  v_add_f32 v8, v135, v138
  ds_read_b64 v[152:153], v3 offset:2048
  ds_read_b64 v[154:155], v3 offset:2056
  s_waitcnt lgkmcnt(9)
  v_mfma_f32_16x16x32_bf16 v[84:87], v[52:55], v[156:159], v[84:87]
  v_add_f32 v129, v129, v132
  v_mfma_f32_16x16x32_bf16 v[100:103], v[60:63], v[156:159], v[100:103]
  v_add_f32 v8, v8, v141
  v_mfma_f32_16x16x32_bf16 v[116:119], v[68:71], v[156:159], 0
  v_add_f32 v130, v130, v133
  ds_read_b64 v[156:157], v3 offset:3200
  ds_read_b64 v[158:159], v3 offset:3208
  s_waitcnt lgkmcnt(9)
  v_mfma_f32_16x16x32_bf16 v[88:91], v[52:55], v[160:163], v[88:91]
  v_add_f32 v9, v139, v142
  v_mfma_f32_16x16x32_bf16 v[104:107], v[60:63], v[160:163], v[104:107]
  ds_bpermute_b32 v13, v5, v8
  v_mfma_f32_16x16x32_bf16 v[120:123], v[68:71], v[160:163], 0
  ds_bpermute_b32 v14, v5, v9
  ds_read_b64 v[160:161], v3 offset:4352
  ds_read_b64 v[162:163], v3 offset:4360
  s_waitcnt lgkmcnt(11)
  v_mfma_f32_16x16x32_bf16 v[92:95], v[52:55], v[144:147], v[92:95]
  ds_bpermute_b32 v15, v5, v143
  v_mfma_f32_16x16x32_bf16 v[108:111], v[60:63], v[144:147], v[108:111]
  v_add_f32 v131, v131, v134
  v_mfma_f32_16x16x32_bf16 v[124:127], v[68:71], v[144:147], 0
  v_add_f32 v130, v130, v136
  ds_read_b64 v[144:145], v3 offset:832
  ds_read_b64 v[146:147], v3 offset:840
  s_waitcnt lgkmcnt(12)
  v_mfma_f32_16x16x32_bf16 v[80:83], v[48:51], v[148:151], v[80:83]
  v_add_f32 v131, v131, v137
  v_mfma_f32_16x16x32_bf16 v[96:99], v[56:59], v[148:151], v[96:99]
  v_add_f32 v131, v131, v140
  v_mfma_f32_16x16x32_bf16 v[112:115], v[64:67], v[148:151], v[112:115]
  ds_read_b64 v[148:149], v3 offset:1984
  ds_read_b64 v[150:151], v3 offset:1992
  s_waitcnt lgkmcnt(11)
  v_mfma_f32_16x16x32_bf16 v[84:87], v[48:51], v[152:155], v[84:87]
  v_mfma_f32_16x16x32_bf16 v[100:103], v[56:59], v[152:155], v[100:103]
  v_mfma_f32_16x16x32_bf16 v[116:119], v[64:67], v[152:155], v[116:119]
  s_waitcnt lgkmcnt(8)
  v_cndmask_b32 v10, v13, v10, s[40:41]
  ds_read_b64 v[152:153], v3 offset:3136
  ds_read_b64 v[154:155], v3 offset:3144
  v_mfma_f32_16x16x32_bf16 v[88:91], v[48:51], v[156:159], v[88:91]
  s_waitcnt lgkmcnt(9)
  v_cndmask_b32 v11, v14, v11, s[40:41]
  v_mfma_f32_16x16x32_bf16 v[104:107], v[56:59], v[156:159], v[104:107]
  s_waitcnt lgkmcnt(6)
  v_cndmask_b32 v12, v15, v12, s[40:41]
  v_mfma_f32_16x16x32_bf16 v[120:123], v[64:67], v[156:159], v[120:123]
  v_add_f32 v128, v128, v10
  ds_read_b64 v[156:157], v3 offset:4288
  ds_read_b64 v[158:159], v3 offset:4296
  v_mfma_f32_16x16x32_bf16 v[92:95], v[48:51], v[160:163], v[92:95]
  v_add_f32 v129, v129, v11
  v_mfma_f32_16x16x32_bf16 v[108:111], v[56:59], v[160:163], v[108:111]
  v_add_f32 v130, v130, v12
  v_mfma_f32_16x16x32_bf16 v[124:127], v[64:67], v[160:163], v[124:127]
  v_cvt_pk_bf16_f32 v6, v128, v129
  ds_read_b64 v[160:161], v3 offset:768
  ds_read_b64 v[162:163], v3 offset:776
  s_waitcnt lgkmcnt(8)
  v_mfma_f32_16x16x32_bf16 v[80:83], v[44:47], v[144:147], v[80:83]
  v_cvt_pk_bf16_f32 v7, v130, v131
  v_mfma_f32_16x16x32_bf16 v[96:99], v[52:55], v[144:147], v[96:99]
  ds_write_b64 v4, v[6:7] offset:1728
  v_mfma_f32_16x16x32_bf16 v[112:115], v[60:63], v[144:147], v[112:115]
  s_waitcnt lgkmcnt(0)
  s_barrier
  v_mfma_f32_16x16x32_bf16 v[128:131], v[68:71], v[144:147], 0
  ds_read_b64 v[144:145], v3 offset:1920
  ds_read_b64 v[146:147], v3 offset:1928
  v_mfma_f32_16x16x32_bf16 v[84:87], v[44:47], v[148:151], v[84:87]
  v_mfma_f32_16x16x32_bf16 v[100:103], v[52:55], v[148:151], v[100:103]
  v_mfma_f32_16x16x32_bf16 v[116:119], v[60:63], v[148:151], v[116:119]
  v_mfma_f32_16x16x32_bf16 v[132:135], v[68:71], v[148:151], 0
  ds_read_b64 v[148:149], v3 offset:3072
  ds_read_b64 v[150:151], v3 offset:3080
  v_mfma_f32_16x16x32_bf16 v[88:91], v[44:47], v[152:155], v[88:91]
  v_mfma_f32_16x16x32_bf16 v[104:107], v[52:55], v[152:155], v[104:107]
  v_mfma_f32_16x16x32_bf16 v[120:123], v[60:63], v[152:155], v[120:123]
  v_mfma_f32_16x16x32_bf16 v[136:139], v[68:71], v[152:155], 0
  ds_read_b64 v[152:153], v3 offset:4224
  ds_read_b64 v[154:155], v3 offset:4232
  v_mfma_f32_16x16x32_bf16 v[92:95], v[44:47], v[156:159], v[92:95]
  v_mfma_f32_16x16x32_bf16 v[108:111], v[52:55], v[156:159], v[108:111]
  v_mfma_f32_16x16x32_bf16 v[124:127], v[60:63], v[156:159], v[124:127]
  v_mfma_f32_16x16x32_bf16 v[140:143], v[68:71], v[156:159], 0
  ds_read_b64 v[156:157], v3 offset:704
  ds_read_b64 v[158:159], v3 offset:712
  v_mfma_f32_16x16x32_bf16 v[80:83], v[40:43], v[160:163], v[80:83]
  v_mfma_f32_16x16x32_bf16 v[96:99], v[48:51], v[160:163], v[96:99]
  v_mfma_f32_16x16x32_bf16 v[112:115], v[56:59], v[160:163], v[112:115]
  v_mfma_f32_16x16x32_bf16 v[128:131], v[64:67], v[160:163], v[128:131]
  ds_read_b64 v[160:161], v3 offset:960
  ds_read_b64 v[162:163], v3 offset:968
  s_waitcnt lgkmcnt(8)
  v_mfma_f32_16x16x32_bf16 v[84:87], v[40:43], v[144:147], v[84:87]
  v_mfma_f32_16x16x32_bf16 v[100:103], v[48:51], v[144:147], v[100:103]
  v_mfma_f32_16x16x32_bf16 v[116:119], v[56:59], v[144:147], v[116:119]
  v_mfma_f32_16x16x32_bf16 v[132:135], v[64:67], v[144:147], v[132:135]
  ds_read_b64 v[144:145], v3 offset:1856
  ds_read_b64 v[146:147], v3 offset:1864
  s_waitcnt lgkmcnt(8)
  v_mfma_f32_16x16x32_bf16 v[88:91], v[40:43], v[148:151], v[88:91]
  v_mfma_f32_16x16x32_bf16 v[104:107], v[48:51], v[148:151], v[104:107]
  v_mfma_f32_16x16x32_bf16 v[120:123], v[56:59], v[148:151], v[120:123]
  v_mfma_f32_16x16x32_bf16 v[136:139], v[64:67], v[148:151], v[136:139]
  ds_read_b64 v[148:149], v3 offset:3008
  ds_read_b64 v[150:151], v3 offset:3016
  s_waitcnt lgkmcnt(8)
  v_mfma_f32_16x16x32_bf16 v[92:95], v[40:43], v[152:155], v[92:95]
  v_mfma_f32_16x16x32_bf16 v[108:111], v[48:51], v[152:155], v[108:111]
  v_mfma_f32_16x16x32_bf16 v[124:127], v[56:59], v[152:155], v[124:127]
  v_mfma_f32_16x16x32_bf16 v[140:143], v[64:67], v[152:155], v[140:143]
  ds_read_b64 v[152:153], v3 offset:2112
  ds_read_b64 v[154:155], v3 offset:2120
  s_waitcnt lgkmcnt(8)
  v_mfma_f32_16x16x32_bf16 v[96:99], v[44:47], v[156:159], v[96:99]
  v_mfma_f32_16x16x32_bf16 v[112:115], v[52:55], v[156:159], v[112:115]
  v_mfma_f32_16x16x32_bf16 v[128:131], v[60:63], v[156:159], v[128:131]
  ds_read_b64 v[156:157], v3 offset:4160
  ds_read_b64 v[158:159], v3 offset:4168
  s_waitcnt lgkmcnt(8)
  v_mfma_f32_16x16x32_bf16 v[128:131], v[76:79], v[160:163], v[128:131]
  ds_read_b64 v[160:161], v3 offset:640
  ds_read_b64 v[162:163], v3 offset:648
  s_waitcnt lgkmcnt(8)
  v_mfma_f32_16x16x32_bf16 v[100:103], v[44:47], v[144:147], v[100:103]
  v_mfma_f32_16x16x32_bf16 v[116:119], v[52:55], v[144:147], v[116:119]
  v_mfma_f32_16x16x32_bf16 v[132:135], v[60:63], v[144:147], v[132:135]
  ds_read_b64 v[144:145], v3 offset:3264
  ds_read_b64 v[146:147], v3 offset:3272
  s_waitcnt lgkmcnt(8)
  v_mfma_f32_16x16x32_bf16 v[104:107], v[44:47], v[148:151], v[104:107]
  v_mfma_f32_16x16x32_bf16 v[120:123], v[52:55], v[148:151], v[120:123]
  v_mfma_f32_16x16x32_bf16 v[136:139], v[60:63], v[148:151], v[136:139]
  ds_read_b64 v[148:149], v3 offset:1792
  ds_read_b64 v[150:151], v3 offset:1800
  s_waitcnt lgkmcnt(8)
  v_mfma_f32_16x16x32_bf16 v[132:135], v[76:79], v[152:155], v[132:135]
  ds_read_b64 v[152:153], v3 offset:2944
  ds_read_b64 v[154:155], v3 offset:2952
  s_waitcnt lgkmcnt(8)
  v_mfma_f32_16x16x32_bf16 v[108:111], v[44:47], v[156:159], v[108:111]
  v_mfma_f32_16x16x32_bf16 v[124:127], v[52:55], v[156:159], v[124:127]
  v_mfma_f32_16x16x32_bf16 v[140:143], v[60:63], v[156:159], v[140:143]
  ds_read_b64 v[156:157], v3 offset:4416
  ds_read_b64 v[158:159], v3 offset:4424
  s_waitcnt lgkmcnt(8)
  v_mfma_f32_16x16x32_bf16 v[96:99], v[40:43], v[160:163], v[96:99]
  v_mfma_f32_16x16x32_bf16 v[112:115], v[48:51], v[160:163], v[112:115]
  v_mfma_f32_16x16x32_bf16 v[128:131], v[56:59], v[160:163], v[128:131]
  ds_read_b64 v[160:161], v3 offset:4096
  ds_read_b64 v[162:163], v3 offset:4104
  s_waitcnt lgkmcnt(8)
  v_mfma_f32_16x16x32_bf16 v[136:139], v[76:79], v[144:147], v[136:139]
  ds_read_b64 v[144:145], v3 offset:576
  ds_read_b64 v[146:147], v3 offset:584
  s_waitcnt lgkmcnt(8)
  v_mfma_f32_16x16x32_bf16 v[100:103], v[40:43], v[148:151], v[100:103]
  v_mfma_f32_16x16x32_bf16 v[116:119], v[48:51], v[148:151], v[116:119]
  v_mfma_f32_16x16x32_bf16 v[132:135], v[56:59], v[148:151], v[132:135]
  ds_read_b64 v[148:149], v3 offset:896
  ds_read_b64 v[150:151], v3 offset:904
  s_waitcnt lgkmcnt(8)
  v_mfma_f32_16x16x32_bf16 v[104:107], v[40:43], v[152:155], v[104:107]
  v_mfma_f32_16x16x32_bf16 v[120:123], v[48:51], v[152:155], v[120:123]
  v_mfma_f32_16x16x32_bf16 v[136:139], v[56:59], v[152:155], v[136:139]
  ds_read_b64 v[152:153], v3 offset:1728
  ds_read_b64 v[154:155], v3 offset:1736
  s_waitcnt lgkmcnt(8)
  v_mfma_f32_16x16x32_bf16 v[140:143], v[76:79], v[156:159], v[140:143]
  ds_read_b64 v[156:157], v3 offset:2880
  ds_read_b64 v[158:159], v3 offset:2888
  s_waitcnt lgkmcnt(8)
  v_mfma_f32_16x16x32_bf16 v[108:111], v[40:43], v[160:163], v[108:111]
  v_mfma_f32_16x16x32_bf16 v[124:127], v[48:51], v[160:163], v[124:127]
  v_mfma_f32_16x16x32_bf16 v[140:143], v[56:59], v[160:163], v[140:143]
  ds_read_b64 v[160:161], v3 offset:2048
  ds_read_b64 v[162:163], v3 offset:2056
  s_waitcnt lgkmcnt(8)
  v_mfma_f32_16x16x32_bf16 v[112:115], v[44:47], v[144:147], v[112:115]
  v_mfma_f32_16x16x32_bf16 v[128:131], v[52:55], v[144:147], v[128:131]
  ds_read_b64 v[144:145], v3 offset:4032
  ds_read_b64 v[146:147], v3 offset:4040
  s_waitcnt lgkmcnt(8)
  v_mfma_f32_16x16x32_bf16 v[128:131], v[72:75], v[148:151], v[128:131]
  ds_read_b64 v[148:149], v3 offset:512
  ds_read_b64 v[150:151], v3 offset:520
  s_waitcnt lgkmcnt(8)
  v_mfma_f32_16x16x32_bf16 v[116:119], v[44:47], v[152:155], v[116:119]
  v_mfma_f32_16x16x32_bf16 v[132:135], v[52:55], v[152:155], v[132:135]
  ds_read_b64 v[152:153], v3 offset:3200
  ds_read_b64 v[154:155], v3 offset:3208
  s_waitcnt lgkmcnt(8)
  v_mfma_f32_16x16x32_bf16 v[120:123], v[44:47], v[156:159], v[120:123]
  v_mfma_f32_16x16x32_bf16 v[136:139], v[52:55], v[156:159], v[136:139]
  ds_read_b64 v[156:157], v3 offset:1664
  ds_read_b64 v[158:159], v3 offset:1672
  s_waitcnt lgkmcnt(8)
  v_mfma_f32_16x16x32_bf16 v[132:135], v[72:75], v[160:163], v[132:135]
  ds_read_b64 v[160:161], v3 offset:2816
  ds_read_b64 v[162:163], v3 offset:2824
  s_waitcnt lgkmcnt(8)
  v_mfma_f32_16x16x32_bf16 v[124:127], v[44:47], v[144:147], v[124:127]
  v_mfma_f32_16x16x32_bf16 v[140:143], v[52:55], v[144:147], v[140:143]
  ds_read_b64 v[144:145], v3 offset:4352
  ds_read_b64 v[146:147], v3 offset:4360
  s_waitcnt lgkmcnt(8)
  v_mfma_f32_16x16x32_bf16 v[112:115], v[40:43], v[148:151], v[112:115]
  v_mfma_f32_16x16x32_bf16 v[128:131], v[48:51], v[148:151], v[128:131]
  ds_read_b64 v[148:149], v3 offset:3968
  ds_read_b64 v[150:151], v3 offset:3976
  s_waitcnt lgkmcnt(8)
  v_mfma_f32_16x16x32_bf16 v[136:139], v[72:75], v[152:155], v[136:139]
  ds_read_b64 v[152:153], v3 offset:448
  ds_read_b64 v[154:155], v3 offset:456
  s_waitcnt lgkmcnt(8)
  v_mfma_f32_16x16x32_bf16 v[116:119], v[40:43], v[156:159], v[116:119]
  v_mfma_f32_16x16x32_bf16 v[132:135], v[48:51], v[156:159], v[132:135]
  ds_read_b64 v[156:157], v3 offset:1600
  ds_read_b64 v[158:159], v3 offset:1608
  s_waitcnt lgkmcnt(8)
  v_mfma_f32_16x16x32_bf16 v[120:123], v[40:43], v[160:163], v[120:123]
  v_mfma_f32_16x16x32_bf16 v[136:139], v[48:51], v[160:163], v[136:139]
  ds_read_b64 v[160:161], v3 offset:2752
  ds_read_b64 v[162:163], v3 offset:2760
  s_waitcnt lgkmcnt(8)
  v_mfma_f32_16x16x32_bf16 v[140:143], v[72:75], v[144:147], v[140:143]
  ds_read_b64 v[144:145], v3 offset:3904
  ds_read_b64 v[146:147], v3 offset:3912
  s_waitcnt lgkmcnt(8)
  v_mfma_f32_16x16x32_bf16 v[124:127], v[40:43], v[148:151], v[124:127]
  v_mfma_f32_16x16x32_bf16 v[140:143], v[48:51], v[148:151], v[140:143]
  ds_read_b64 v[148:149], v3 offset:384
  ds_read_b64 v[150:151], v3 offset:392
  s_waitcnt lgkmcnt(8)
  v_mfma_f32_16x16x32_bf16 v[80:83], v[20:23], v[152:155], v[80:83]
  v_mfma_f32_16x16x32_bf16 v[96:99], v[28:31], v[152:155], v[96:99]
  v_mfma_f32_16x16x32_bf16 v[112:115], v[36:39], v[152:155], v[112:115]
  v_mfma_f32_16x16x32_bf16 v[128:131], v[44:47], v[152:155], v[128:131]
  ds_read_b64 v[152:153], v3 offset:1536
  ds_read_b64 v[154:155], v3 offset:1544
  s_waitcnt lgkmcnt(8)
  v_mfma_f32_16x16x32_bf16 v[84:87], v[20:23], v[156:159], v[84:87]
  v_mfma_f32_16x16x32_bf16 v[100:103], v[28:31], v[156:159], v[100:103]
  v_mfma_f32_16x16x32_bf16 v[116:119], v[36:39], v[156:159], v[116:119]
  v_mfma_f32_16x16x32_bf16 v[132:135], v[44:47], v[156:159], v[132:135]
  ds_read_b64 v[156:157], v3 offset:2688
  ds_read_b64 v[158:159], v3 offset:2696
  s_waitcnt lgkmcnt(8)
  v_mfma_f32_16x16x32_bf16 v[88:91], v[20:23], v[160:163], v[88:91]
  v_mfma_f32_16x16x32_bf16 v[104:107], v[28:31], v[160:163], v[104:107]
  v_mfma_f32_16x16x32_bf16 v[120:123], v[36:39], v[160:163], v[120:123]
  v_mfma_f32_16x16x32_bf16 v[136:139], v[44:47], v[160:163], v[136:139]
  ds_read_b64 v[160:161], v3 offset:3840
  ds_read_b64 v[162:163], v3 offset:3848
  s_waitcnt lgkmcnt(8)
  v_mfma_f32_16x16x32_bf16 v[92:95], v[20:23], v[144:147], v[92:95]
  v_mfma_f32_16x16x32_bf16 v[108:111], v[28:31], v[144:147], v[108:111]
  v_mfma_f32_16x16x32_bf16 v[124:127], v[36:39], v[144:147], v[124:127]
  v_mfma_f32_16x16x32_bf16 v[140:143], v[44:47], v[144:147], v[140:143]
  ds_read_b64 v[144:145], v3 offset:320
  ds_read_b64 v[146:147], v3 offset:328
  s_waitcnt lgkmcnt(8)
  v_mfma_f32_16x16x32_bf16 v[80:83], v[16:19], v[148:151], v[80:83]
  v_mfma_f32_16x16x32_bf16 v[96:99], v[24:27], v[148:151], v[96:99]
  v_mfma_f32_16x16x32_bf16 v[112:115], v[32:35], v[148:151], v[112:115]
  v_mfma_f32_16x16x32_bf16 v[128:131], v[40:43], v[148:151], v[128:131]
  ds_read_b64 v[148:149], v3 offset:1472
  ds_read_b64 v[150:151], v3 offset:1480
  s_waitcnt lgkmcnt(8)
  v_mfma_f32_16x16x32_bf16 v[84:87], v[16:19], v[152:155], v[84:87]
  v_mfma_f32_16x16x32_bf16 v[100:103], v[24:27], v[152:155], v[100:103]
  v_mfma_f32_16x16x32_bf16 v[116:119], v[32:35], v[152:155], v[116:119]
  v_mfma_f32_16x16x32_bf16 v[132:135], v[40:43], v[152:155], v[132:135]
  ds_read_b64 v[152:153], v3 offset:2624
  ds_read_b64 v[154:155], v3 offset:2632
  s_waitcnt lgkmcnt(8)
  v_mfma_f32_16x16x32_bf16 v[88:91], v[16:19], v[156:159], v[88:91]
  v_mfma_f32_16x16x32_bf16 v[104:107], v[24:27], v[156:159], v[104:107]
  v_mfma_f32_16x16x32_bf16 v[120:123], v[32:35], v[156:159], v[120:123]
  v_mfma_f32_16x16x32_bf16 v[136:139], v[40:43], v[156:159], v[136:139]
  ds_read_b64 v[156:157], v3 offset:3776
  ds_read_b64 v[158:159], v3 offset:3784
  s_waitcnt lgkmcnt(8)
  v_mfma_f32_16x16x32_bf16 v[92:95], v[16:19], v[160:163], v[92:95]
  v_mfma_f32_16x16x32_bf16 v[108:111], v[24:27], v[160:163], v[108:111]
  v_mfma_f32_16x16x32_bf16 v[124:127], v[32:35], v[160:163], v[124:127]
  v_mfma_f32_16x16x32_bf16 v[140:143], v[40:43], v[160:163], v[140:143]
  ds_read_b64 v[160:161], v3 offset:256
  ds_read_b64 v[162:163], v3 offset:264
  s_waitcnt lgkmcnt(8)
  v_mfma_f32_16x16x32_bf16 v[96:99], v[20:23], v[144:147], v[96:99]
  v_add_f32 v8, v87, v90
  v_mfma_f32_16x16x32_bf16 v[112:115], v[28:31], v[144:147], v[112:115]
  v_add_f32 v81, v81, v84
  v_mfma_f32_16x16x32_bf16 v[128:131], v[36:39], v[144:147], v[128:131]
  v_add_f32 v8, v8, v93
  ds_read_b64 v[144:145], v3 offset:1408
  ds_read_b64 v[146:147], v3 offset:1416
  s_waitcnt lgkmcnt(8)
  v_mfma_f32_16x16x32_bf16 v[100:103], v[20:23], v[148:151], v[100:103]
  v_add_f32 v82, v82, v85
  v_mfma_f32_16x16x32_bf16 v[116:119], v[28:31], v[148:151], v[116:119]
  v_add_f32 v9, v91, v94
  v_mfma_f32_16x16x32_bf16 v[132:135], v[36:39], v[148:151], v[132:135]
  ds_bpermute_b32 v10, v5, v8
  ds_read_b64 v[148:149], v3 offset:2560
  ds_read_b64 v[150:151], v3 offset:2568
  s_waitcnt lgkmcnt(9)
  v_mfma_f32_16x16x32_bf16 v[104:107], v[20:23], v[152:155], v[104:107]
  ds_bpermute_b32 v11, v5, v9
  v_mfma_f32_16x16x32_bf16 v[120:123], v[28:31], v[152:155], v[120:123]
  ds_bpermute_b32 v12, v5, v95
  v_mfma_f32_16x16x32_bf16 v[136:139], v[36:39], v[152:155], v[136:139]
  v_add_f32 v83, v83, v86
  ds_read_b64 v[152:153], v3 offset:3712
  ds_read_b64 v[154:155], v3 offset:3720
  s_waitcnt lgkmcnt(11)
  v_mfma_f32_16x16x32_bf16 v[108:111], v[20:23], v[156:159], v[108:111]
  v_add_f32 v82, v82, v88
  v_mfma_f32_16x16x32_bf16 v[124:127], v[28:31], v[156:159], v[124:127]
  v_add_f32 v83, v83, v89
  v_mfma_f32_16x16x32_bf16 v[140:143], v[36:39], v[156:159], v[140:143]
  v_add_f32 v83, v83, v92
  ds_read_b64 v[156:157], v3 offset:192
  ds_read_b64 v[158:159], v3 offset:200
  s_waitcnt lgkmcnt(11)
  v_mfma_f32_16x16x32_bf16 v[96:99], v[16:19], v[160:163], v[96:99]
  v_mfma_f32_16x16x32_bf16 v[112:115], v[24:27], v[160:163], v[112:115]
  v_mfma_f32_16x16x32_bf16 v[128:131], v[32:35], v[160:163], v[128:131]
  ds_read_b64 v[160:161], v3 offset:1344
  ds_read_b64 v[162:163], v3 offset:1352
  s_waitcnt lgkmcnt(11)
  v_mfma_f32_16x16x32_bf16 v[100:103], v[16:19], v[144:147], v[100:103]
  s_waitcnt lgkmcnt(10)
  v_cndmask_b32 v13, v10, v13, s[40:41]
  v_mfma_f32_16x16x32_bf16 v[116:119], v[24:27], v[144:147], v[116:119]
  s_waitcnt lgkmcnt(7)
  v_cndmask_b32 v14, v11, v14, s[40:41]
  v_mfma_f32_16x16x32_bf16 v[132:135], v[32:35], v[144:147], v[132:135]
  s_waitcnt lgkmcnt(6)
  v_cndmask_b32 v15, v12, v15, s[40:41]
  ds_read_b64 v[144:145], v3 offset:2496
  ds_read_b64 v[146:147], v3 offset:2504
  v_mfma_f32_16x16x32_bf16 v[104:107], v[16:19], v[148:151], v[104:107]
  v_add_f32 v80, v80, v13
  v_mfma_f32_16x16x32_bf16 v[120:123], v[24:27], v[148:151], v[120:123]
  v_add_f32 v81, v81, v14
  v_mfma_f32_16x16x32_bf16 v[136:139], v[32:35], v[148:151], v[136:139]
  v_add_f32 v82, v82, v15
  ds_read_b64 v[148:149], v3 offset:3648
  ds_read_b64 v[150:151], v3 offset:3656
  s_waitcnt lgkmcnt(8)
  v_mfma_f32_16x16x32_bf16 v[108:111], v[16:19], v[152:155], v[108:111]
  v_cvt_pk_bf16_f32 v6, v80, v81
  v_mfma_f32_16x16x32_bf16 v[124:127], v[24:27], v[152:155], v[124:127]
  v_cvt_pk_bf16_f32 v7, v82, v83
  v_mfma_f32_16x16x32_bf16 v[140:143], v[32:35], v[152:155], v[140:143]
  ds_write_b64 v4, v[6:7] offset:2304
  ds_read_b64 v[152:153], v3 offset:128
  ds_read_b64 v[154:155], v3 offset:136
  s_waitcnt lgkmcnt(9)
  v_mfma_f32_16x16x32_bf16 v[112:115], v[20:23], v[156:159], v[112:115]
  v_add_f32 v8, v103, v106
  v_mfma_f32_16x16x32_bf16 v[128:131], v[28:31], v[156:159], v[128:131]
  v_add_f32 v97, v97, v100
  ds_read_b64 v[156:157], v3 offset:1280
  ds_read_b64 v[158:159], v3 offset:1288
  s_waitcnt lgkmcnt(9)
  v_mfma_f32_16x16x32_bf16 v[116:119], v[20:23], v[160:163], v[116:119]
  v_add_f32 v8, v8, v109
  v_mfma_f32_16x16x32_bf16 v[132:135], v[28:31], v[160:163], v[132:135]
  v_add_f32 v98, v98, v101
  ds_read_b64 v[160:161], v3 offset:2432
  ds_read_b64 v[162:163], v3 offset:2440
  s_waitcnt lgkmcnt(9)
  v_mfma_f32_16x16x32_bf16 v[120:123], v[20:23], v[144:147], v[120:123]
  v_add_f32 v9, v107, v110
  v_mfma_f32_16x16x32_bf16 v[136:139], v[28:31], v[144:147], v[136:139]
  ds_bpermute_b32 v13, v5, v8
  ds_read_b64 v[144:145], v3 offset:3584
  ds_read_b64 v[146:147], v3 offset:3592
  s_waitcnt lgkmcnt(10)
  v_mfma_f32_16x16x32_bf16 v[124:127], v[20:23], v[148:151], v[124:127]
  ds_bpermute_b32 v14, v5, v9
  v_mfma_f32_16x16x32_bf16 v[140:143], v[28:31], v[148:151], v[140:143]
  ds_bpermute_b32 v15, v5, v111
  ds_read_b64 v[148:149], v3 offset:64
  ds_read_b64 v[150:151], v3 offset:72
  s_waitcnt lgkmcnt(11)
  v_mfma_f32_16x16x32_bf16 v[112:115], v[16:19], v[152:155], v[112:115]
  v_add_f32 v99, v99, v102
  v_mfma_f32_16x16x32_bf16 v[128:131], v[24:27], v[152:155], v[128:131]
  v_add_f32 v98, v98, v104
  ds_read_b64 v[152:153], v3 offset:1216
  ds_read_b64 v[154:155], v3 offset:1224
  s_waitcnt lgkmcnt(11)
  v_mfma_f32_16x16x32_bf16 v[116:119], v[16:19], v[156:159], v[116:119]
  v_add_f32 v99, v99, v105
  v_mfma_f32_16x16x32_bf16 v[132:135], v[24:27], v[156:159], v[132:135]
  v_add_f32 v99, v99, v108
  ds_read_b64 v[156:157], v3 offset:2368
  ds_read_b64 v[158:159], v3 offset:2376
  s_waitcnt lgkmcnt(11)
  v_mfma_f32_16x16x32_bf16 v[120:123], v[16:19], v[160:163], v[120:123]
  v_mfma_f32_16x16x32_bf16 v[136:139], v[24:27], v[160:163], v[136:139]
  ds_read_b64 v[160:161], v3 offset:3520
  ds_read_b64 v[162:163], v3 offset:3528
  s_waitcnt lgkmcnt(10)
  v_mfma_f32_16x16x32_bf16 v[124:127], v[16:19], v[144:147], v[124:127]
  v_mfma_f32_16x16x32_bf16 v[140:143], v[24:27], v[144:147], v[140:143]
  v_cndmask_b32 v10, v13, v10, s[40:41]
  ds_read_b64 v[144:145], v3 offset:0
  ds_read_b64 v[146:147], v3 offset:8
  s_waitcnt lgkmcnt(8)
  v_mfma_f32_16x16x32_bf16 v[128:131], v[20:23], v[148:151], v[128:131]
  v_cndmask_b32 v11, v14, v11, s[40:41]
  ds_read_b64 v[148:149], v3 offset:1152
  ds_read_b64 v[150:151], v3 offset:1160
  s_waitcnt lgkmcnt(8)
  v_mfma_f32_16x16x32_bf16 v[132:135], v[20:23], v[152:155], v[132:135]
  v_cndmask_b32 v12, v15, v12, s[40:41]
  ds_read_b64 v[152:153], v3 offset:2304
  ds_read_b64 v[154:155], v3 offset:2312
  s_waitcnt lgkmcnt(8)
  v_mfma_f32_16x16x32_bf16 v[136:139], v[20:23], v[156:159], v[136:139]
  v_add_f32 v96, v96, v10
  ds_read_b64 v[156:157], v3 offset:3456
  ds_read_b64 v[158:159], v3 offset:3464
  s_waitcnt lgkmcnt(8)
  v_mfma_f32_16x16x32_bf16 v[140:143], v[20:23], v[160:163], v[140:143]
  v_add_f32 v97, v97, v11
  s_waitcnt lgkmcnt(6)
  v_mfma_f32_16x16x32_bf16 v[128:131], v[16:19], v[144:147], v[128:131]
  v_add_f32 v98, v98, v12
  s_waitcnt lgkmcnt(4)
  v_mfma_f32_16x16x32_bf16 v[132:135], v[16:19], v[148:151], v[132:135]
  v_cvt_pk_bf16_f32 v6, v96, v97
  s_waitcnt lgkmcnt(2)
  v_mfma_f32_16x16x32_bf16 v[136:139], v[16:19], v[152:155], v[136:139]
  v_cvt_pk_bf16_f32 v7, v98, v99
  s_waitcnt lgkmcnt(0)
  v_mfma_f32_16x16x32_bf16 v[140:143], v[16:19], v[156:159], v[140:143]
  ds_write_b64 v4, v[6:7] offset:2880
  s_waitcnt lgkmcnt(0)
  s_barrier
  v_add_f32 v8, v119, v122
  v_add_f32 v113, v113, v116
  v_add_f32 v8, v8, v125
  v_add_f32 v114, v114, v117
  v_add_f32 v9, v123, v126
  ds_bpermute_b32 v10, v5, v8
  ds_bpermute_b32 v11, v5, v9
  ds_bpermute_b32 v12, v5, v127
  v_add_f32 v115, v115, v118
  v_add_f32 v114, v114, v120
  v_add_f32 v115, v115, v121
  v_add_f32 v115, v115, v124
  s_waitcnt lgkmcnt(2)
  v_cndmask_b32 v13, v10, v13, s[40:41]
  s_waitcnt lgkmcnt(1)
  v_cndmask_b32 v14, v11, v14, s[40:41]
  s_waitcnt lgkmcnt(0)
  v_cndmask_b32 v15, v12, v15, s[40:41]
  v_add_f32 v112, v112, v13
  v_add_f32 v113, v113, v14
  v_add_f32 v114, v114, v15
  v_cvt_pk_bf16_f32 v6, v112, v113
  v_cvt_pk_bf16_f32 v7, v114, v115
  ds_write_b64 v4, v[6:7] offset:3456
  v_add_f32 v8, v135, v138
  v_add_f32 v129, v129, v132
  v_add_f32 v8, v8, v141
  v_add_f32 v130, v130, v133
  v_add_f32 v9, v139, v142
  ds_bpermute_b32 v13, v5, v8
  ds_bpermute_b32 v14, v5, v9
  ds_bpermute_b32 v15, v5, v143
  v_add_f32 v131, v131, v134
  v_add_f32 v130, v130, v136
  v_add_f32 v131, v131, v137
  v_add_f32 v131, v131, v140
  s_waitcnt lgkmcnt(2)
  v_cndmask_b32 v10, v13, v10, s[40:41]
  s_waitcnt lgkmcnt(1)
  v_cndmask_b32 v11, v14, v11, s[40:41]
  s_waitcnt lgkmcnt(0)
  v_cndmask_b32 v12, v15, v12, s[40:41]
  v_add_f32 v128, v128, v10
  v_add_f32 v129, v129, v11
  v_add_f32 v130, v130, v12
  v_cvt_pk_bf16_f32 v6, v128, v129
  v_cvt_pk_bf16_f32 v7, v130, v131
  ds_write_b64 v4, v[6:7] offset:4032
  s_waitcnt lgkmcnt(0)
  s_barrier
  s_endpgm
L_AI:
  s_setprio 3
  s_waitcnt lgkmcnt(0)
  s_mov_b32 s8, s64
  s_and_b32 s9, s65, 0xffff
  s_mov_b32 s10, 2621440
  s_mov_b32 s11, 0x20000
  s_sub_u32 s29, s4, 8
  v_and_b32 v16, 7, v1
  v_lshrrev_b32 v17, 3, v1
  s_and_b32 s5, s3, 7
  s_mul_i32 s5, s5, 81920
  s_lshl_b32 s6, s28, 7
  s_add_u32 s5, s5, s6
  v_mul_u32_u24 v7, 1280, v1
  v_add_u32 v7, s5, v7
  s_mul_i32 s36, s29, 655360
  buffer_load_dword v14, v7, s[8:11], s36 offen
  s_mov_b32 s24, s90
  s_and_b32 s25, s91, 0xffff
  s_mov_b32 s26, 5242880
  s_mov_b32 s27, 0x20000
  v_mul_u32_u24 v18, 10240, v17
  v_lshl_add_u32 v18, v16, 1, v18
  s_mul_i32 s5, s29, 163840
  s_lshl_b32 s6, s3, 4
  s_add_u32 s5, s5, s6
  v_add_u32 v2, s5, v18
  v_mul_u32_u24 v18, 20480, v17
  v_lshl_add_u32 v18, v16, 1, v18
  s_mul_i32 s5, s29, 327680
  s_add_u32 s5, s5, s6
  v_add_u32 v5, s5, v18
  v_mul_u32_u24 v18, 4624, v16
  v_lshlrev_b32 v19, 2, v17
  v_sub_u32 v18, v18, v19
  s_lshl_b32 s5, s29, 6
  s_sub_u32 s5, 220, s5
  v_add_u32 v3, s5, v18
  v_mul_u32_u24 v18, 4672, v16
  v_lshl_add_u32 v18, v17, 4, v18
  s_mul_i32 s5, s29, 288
  s_add_u32 s5, s5, 70016
  v_add_u32 v4, s5, v18
  v_subrev_u32 v8, 8, v1
  v_and_b32 v8, 63, v8
  v_lshlrev_b32 v8, 2, v8
  s_mov_b64 s[42:43], 0xff
  s_mov_b32 s44, 0xffff0000
  s_waitcnt vmcnt(0)
  s_mov_b32 s45, 0
  s_mov_b32 s46, 5120
  buffer_load_short_d16_hi v32, v2, s[8:11], s45 offen offset:0
  buffer_load_ushort v36, v2, s[8:11], s46 offen offset:0
  buffer_load_short_d16_hi v33, v2, s[8:11], s45 offen offset:1280
  buffer_load_ushort v37, v2, s[8:11], s46 offen offset:1280
  buffer_load_short_d16_hi v34, v2, s[8:11], s45 offen offset:2560
  buffer_load_ushort v38, v2, s[8:11], s46 offen offset:2560
  buffer_load_short_d16_hi v35, v2, s[8:11], s45 offen offset:3840
  buffer_load_ushort v39, v2, s[8:11], s46 offen offset:3840
  s_mov_b32 s45, 81920
  s_mov_b32 s46, 87040
  buffer_load_short_d16_hi v40, v2, s[8:11], s45 offen offset:0
  buffer_load_ushort v44, v2, s[8:11], s46 offen offset:0
  buffer_load_short_d16_hi v41, v2, s[8:11], s45 offen offset:1280
  buffer_load_ushort v45, v2, s[8:11], s46 offen offset:1280
  buffer_load_short_d16_hi v42, v2, s[8:11], s45 offen offset:2560
  buffer_load_ushort v46, v2, s[8:11], s46 offen offset:2560
  buffer_load_short_d16_hi v43, v2, s[8:11], s45 offen offset:3840
  buffer_load_ushort v47, v2, s[8:11], s46 offen offset:3840
  s_mov_b32 s45, 655360
  s_mov_b32 s46, 660480
  buffer_load_short_d16_hi v48, v2, s[8:11], s45 offen offset:0
  buffer_load_ushort v52, v2, s[8:11], s46 offen offset:0
  buffer_load_short_d16_hi v49, v2, s[8:11], s45 offen offset:1280
  buffer_load_ushort v53, v2, s[8:11], s46 offen offset:1280
  buffer_load_short_d16_hi v50, v2, s[8:11], s45 offen offset:2560
  buffer_load_ushort v54, v2, s[8:11], s46 offen offset:2560
  buffer_load_short_d16_hi v51, v2, s[8:11], s45 offen offset:3840
  buffer_load_ushort v55, v2, s[8:11], s46 offen offset:3840
  s_mov_b32 s45, 737280
  s_mov_b32 s46, 742400
  buffer_load_short_d16_hi v56, v2, s[8:11], s45 offen offset:0
  buffer_load_ushort v60, v2, s[8:11], s46 offen offset:0
  buffer_load_short_d16_hi v57, v2, s[8:11], s45 offen offset:1280
  buffer_load_ushort v61, v2, s[8:11], s46 offen offset:1280
  buffer_load_short_d16_hi v58, v2, s[8:11], s45 offen offset:2560
  buffer_load_ushort v62, v2, s[8:11], s46 offen offset:2560
  buffer_load_short_d16_hi v59, v2, s[8:11], s45 offen offset:3840
  buffer_load_ushort v63, v2, s[8:11], s46 offen offset:3840
  s_waitcnt vmcnt(30)
  v_or_b32 v32, v32, v36
  ds_write_b32 v3, v32 offset:800
  s_waitcnt vmcnt(28)
  v_or_b32 v33, v33, v37
  ds_write_b32 v3, v33 offset:1952
  s_waitcnt vmcnt(26)
  v_or_b32 v34, v34, v38
  ds_write_b32 v3, v34 offset:3104
  s_waitcnt vmcnt(24)
  v_or_b32 v35, v35, v39
  ds_write_b32 v3, v35 offset:4256
  s_waitcnt vmcnt(22)
  v_or_b32 v40, v40, v44
  ds_write_b32 v3, v40 offset:768
  s_waitcnt vmcnt(20)
  v_or_b32 v41, v41, v45
  ds_write_b32 v3, v41 offset:1920
  s_waitcnt vmcnt(18)
  v_or_b32 v42, v42, v46
  ds_write_b32 v3, v42 offset:3072
  s_waitcnt vmcnt(16)
  v_or_b32 v43, v43, v47
  ds_write_b32 v3, v43 offset:4224
  s_waitcnt vmcnt(14)
  v_or_b32 v48, v48, v52
  ds_write_b32 v3, v48 offset:544
  s_waitcnt vmcnt(12)
  v_or_b32 v49, v49, v53
  ds_write_b32 v3, v49 offset:1696
  s_waitcnt vmcnt(10)
  v_or_b32 v50, v50, v54
  ds_write_b32 v3, v50 offset:2848
  s_waitcnt vmcnt(8)
  v_or_b32 v51, v51, v55
  ds_write_b32 v3, v51 offset:4000
  s_waitcnt vmcnt(6)
  v_or_b32 v56, v56, v60
  ds_write_b32 v3, v56 offset:512
  s_waitcnt vmcnt(4)
  v_or_b32 v57, v57, v61
  ds_write_b32 v3, v57 offset:1664
  s_waitcnt vmcnt(2)
  v_or_b32 v58, v58, v62
  ds_write_b32 v3, v58 offset:2816
  s_waitcnt vmcnt(0)
  v_or_b32 v59, v59, v63
  ds_write_b32 v3, v59 offset:3968
  s_waitcnt lgkmcnt(0)
  s_barrier
  s_mov_b32 s45, 1310720
  s_mov_b32 s46, 1315840
  buffer_load_short_d16_hi v64, v2, s[8:11], s45 offen offset:0
  buffer_load_ushort v68, v2, s[8:11], s46 offen offset:0
  buffer_load_short_d16_hi v65, v2, s[8:11], s45 offen offset:1280
  buffer_load_ushort v69, v2, s[8:11], s46 offen offset:1280
  buffer_load_short_d16_hi v66, v2, s[8:11], s45 offen offset:2560
  buffer_load_ushort v70, v2, s[8:11], s46 offen offset:2560
  buffer_load_short_d16_hi v67, v2, s[8:11], s45 offen offset:3840
  buffer_load_ushort v71, v2, s[8:11], s46 offen offset:3840
  s_mov_b32 s45, 1392640
  s_mov_b32 s46, 1397760
  buffer_load_short_d16_hi v72, v2, s[8:11], s45 offen offset:0
  buffer_load_ushort v76, v2, s[8:11], s46 offen offset:0
  buffer_load_short_d16_hi v73, v2, s[8:11], s45 offen offset:1280
  buffer_load_ushort v77, v2, s[8:11], s46 offen offset:1280
  buffer_load_short_d16_hi v74, v2, s[8:11], s45 offen offset:2560
  buffer_load_ushort v78, v2, s[8:11], s46 offen offset:2560
  buffer_load_short_d16_hi v75, v2, s[8:11], s45 offen offset:3840
  buffer_load_ushort v79, v2, s[8:11], s46 offen offset:3840
  s_mov_b32 s45, 1966080
  s_mov_b32 s46, 1971200
  buffer_load_short_d16_hi v80, v2, s[8:11], s45 offen offset:0
  buffer_load_ushort v84, v2, s[8:11], s46 offen offset:0
  buffer_load_short_d16_hi v81, v2, s[8:11], s45 offen offset:1280
  buffer_load_ushort v85, v2, s[8:11], s46 offen offset:1280
  buffer_load_short_d16_hi v82, v2, s[8:11], s45 offen offset:2560
  buffer_load_ushort v86, v2, s[8:11], s46 offen offset:2560
  buffer_load_short_d16_hi v83, v2, s[8:11], s45 offen offset:3840
  buffer_load_ushort v87, v2, s[8:11], s46 offen offset:3840
  s_mov_b32 s45, 2048000
  s_mov_b32 s46, 2053120
  buffer_load_short_d16_hi v88, v2, s[8:11], s45 offen offset:0
  buffer_load_ushort v92, v2, s[8:11], s46 offen offset:0
  buffer_load_short_d16_hi v89, v2, s[8:11], s45 offen offset:1280
  buffer_load_ushort v93, v2, s[8:11], s46 offen offset:1280
  buffer_load_short_d16_hi v90, v2, s[8:11], s45 offen offset:2560
  buffer_load_ushort v94, v2, s[8:11], s46 offen offset:2560
  buffer_load_short_d16_hi v91, v2, s[8:11], s45 offen offset:3840
  buffer_load_ushort v95, v2, s[8:11], s46 offen offset:3840
  s_waitcnt vmcnt(30)
  v_or_b32 v64, v64, v68
  ds_write_b32 v3, v64 offset:288
  s_waitcnt vmcnt(28)
  v_or_b32 v65, v65, v69
  ds_write_b32 v3, v65 offset:1440
  s_waitcnt vmcnt(26)
  v_or_b32 v66, v66, v70
  ds_write_b32 v3, v66 offset:2592
  s_waitcnt vmcnt(24)
  v_or_b32 v67, v67, v71
  ds_write_b32 v3, v67 offset:3744
  s_waitcnt vmcnt(22)
  v_or_b32 v72, v72, v76
  ds_write_b32 v3, v72 offset:256
  s_waitcnt vmcnt(20)
  v_or_b32 v73, v73, v77
  ds_write_b32 v3, v73 offset:1408
  s_waitcnt vmcnt(18)
  v_or_b32 v74, v74, v78
  ds_write_b32 v3, v74 offset:2560
  s_waitcnt vmcnt(16)
  v_or_b32 v75, v75, v79
  ds_write_b32 v3, v75 offset:3712
  s_waitcnt vmcnt(14)
  v_or_b32 v80, v80, v84
  ds_write_b32 v3, v80 offset:32
  s_waitcnt vmcnt(12)
  v_or_b32 v81, v81, v85
  ds_write_b32 v3, v81 offset:1184
  s_waitcnt vmcnt(10)
  v_or_b32 v82, v82, v86
  ds_write_b32 v3, v82 offset:2336
  s_waitcnt vmcnt(8)
  v_or_b32 v83, v83, v87
  ds_write_b32 v3, v83 offset:3488
  s_waitcnt vmcnt(6)
  v_or_b32 v88, v88, v92
  ds_write_b32 v3, v88 offset:0
  s_waitcnt vmcnt(4)
  v_or_b32 v89, v89, v93
  ds_write_b32 v3, v89 offset:1152
  s_waitcnt vmcnt(2)
  v_or_b32 v90, v90, v94
  ds_write_b32 v3, v90 offset:2304
  s_waitcnt vmcnt(0)
  v_or_b32 v91, v91, v95
  ds_write_b32 v3, v91 offset:3456
  s_waitcnt lgkmcnt(0)
  s_barrier
  ds_read_b128 v[144:147], v4 offset:0
  ds_read_b128 v[148:151], v4 offset:144
  s_mov_b32 s46, 0
  s_waitcnt lgkmcnt(1)
  buffer_store_short v144, v5, s[24:27], s46 offen nt
  buffer_store_short_d16_hi v144, v5, s[24:27], s46 offen offset:2560 nt
  s_mov_b32 s46, 5120
  buffer_store_short v145, v5, s[24:27], s46 offen nt
  buffer_store_short_d16_hi v145, v5, s[24:27], s46 offen offset:2560 nt
  s_mov_b32 s46, 10240
  buffer_store_short v146, v5, s[24:27], s46 offen nt
  buffer_store_short_d16_hi v146, v5, s[24:27], s46 offen offset:2560 nt
  s_mov_b32 s46, 15360
  buffer_store_short v147, v5, s[24:27], s46 offen nt
  buffer_store_short_d16_hi v147, v5, s[24:27], s46 offen offset:2560 nt
  s_mov_b32 s46, 163840
  s_waitcnt lgkmcnt(0)
  buffer_store_short v148, v5, s[24:27], s46 offen nt
  buffer_store_short_d16_hi v148, v5, s[24:27], s46 offen offset:2560 nt
  s_mov_b32 s46, 168960
  buffer_store_short v149, v5, s[24:27], s46 offen nt
  buffer_store_short_d16_hi v149, v5, s[24:27], s46 offen offset:2560 nt
  s_mov_b32 s46, 174080
  buffer_store_short v150, v5, s[24:27], s46 offen nt
  buffer_store_short_d16_hi v150, v5, s[24:27], s46 offen offset:2560 nt
  s_mov_b32 s46, 179200
  buffer_store_short v151, v5, s[24:27], s46 offen nt
  buffer_store_short_d16_hi v151, v5, s[24:27], s46 offen offset:2560 nt
  ds_read_b128 v[144:147], v4 offset:1152
  ds_read_b128 v[148:151], v4 offset:1296
  s_mov_b32 s46, 1310720
  s_waitcnt lgkmcnt(1)
  buffer_store_short v144, v5, s[24:27], s46 offen nt
  buffer_store_short_d16_hi v144, v5, s[24:27], s46 offen offset:2560 nt
  s_mov_b32 s46, 1315840
  buffer_store_short v145, v5, s[24:27], s46 offen nt
  buffer_store_short_d16_hi v145, v5, s[24:27], s46 offen offset:2560 nt
  s_mov_b32 s46, 1320960
  buffer_store_short v146, v5, s[24:27], s46 offen nt
  buffer_store_short_d16_hi v146, v5, s[24:27], s46 offen offset:2560 nt
  s_mov_b32 s46, 1326080
  buffer_store_short v147, v5, s[24:27], s46 offen nt
  buffer_store_short_d16_hi v147, v5, s[24:27], s46 offen offset:2560 nt
  s_mov_b32 s46, 1474560
  s_waitcnt lgkmcnt(0)
  buffer_store_short v148, v5, s[24:27], s46 offen nt
  buffer_store_short_d16_hi v148, v5, s[24:27], s46 offen offset:2560 nt
  s_mov_b32 s46, 1479680
  buffer_store_short v149, v5, s[24:27], s46 offen nt
  buffer_store_short_d16_hi v149, v5, s[24:27], s46 offen offset:2560 nt
  s_mov_b32 s46, 1484800
  buffer_store_short v150, v5, s[24:27], s46 offen nt
  buffer_store_short_d16_hi v150, v5, s[24:27], s46 offen offset:2560 nt
  s_mov_b32 s46, 1489920
  buffer_store_short v151, v5, s[24:27], s46 offen nt
  buffer_store_short_d16_hi v151, v5, s[24:27], s46 offen offset:2560 nt
  s_waitcnt lgkmcnt(0)
  s_barrier
  ds_read_b128 v[144:147], v4 offset:2304
  ds_read_b128 v[148:151], v4 offset:2448
  s_mov_b32 s46, 2621440
  s_waitcnt lgkmcnt(1)
  buffer_store_short v144, v5, s[24:27], s46 offen nt
  buffer_store_short_d16_hi v144, v5, s[24:27], s46 offen offset:2560 nt
  s_mov_b32 s46, 2626560
  buffer_store_short v145, v5, s[24:27], s46 offen nt
  buffer_store_short_d16_hi v145, v5, s[24:27], s46 offen offset:2560 nt
  s_mov_b32 s46, 2631680
  buffer_store_short v146, v5, s[24:27], s46 offen nt
  buffer_store_short_d16_hi v146, v5, s[24:27], s46 offen offset:2560 nt
  s_mov_b32 s46, 2636800
  buffer_store_short v147, v5, s[24:27], s46 offen nt
  buffer_store_short_d16_hi v147, v5, s[24:27], s46 offen offset:2560 nt
  s_mov_b32 s46, 2785280
  s_waitcnt lgkmcnt(0)
  buffer_store_short v148, v5, s[24:27], s46 offen nt
  buffer_store_short_d16_hi v148, v5, s[24:27], s46 offen offset:2560 nt
  s_mov_b32 s46, 2790400
  buffer_store_short v149, v5, s[24:27], s46 offen nt
  buffer_store_short_d16_hi v149, v5, s[24:27], s46 offen offset:2560 nt
  s_mov_b32 s46, 2795520
  buffer_store_short v150, v5, s[24:27], s46 offen nt
  buffer_store_short_d16_hi v150, v5, s[24:27], s46 offen offset:2560 nt
  s_mov_b32 s46, 2800640
  buffer_store_short v151, v5, s[24:27], s46 offen nt
  buffer_store_short_d16_hi v151, v5, s[24:27], s46 offen offset:2560 nt
  s_waitcnt lgkmcnt(0)
  s_barrier
  ds_read_b128 v[144:147], v4 offset:3456
  ds_read_b128 v[148:151], v4 offset:3600
  s_mov_b32 s46, 3932160
  s_waitcnt lgkmcnt(1)
  buffer_store_short v144, v5, s[24:27], s46 offen nt
  buffer_store_short_d16_hi v144, v5, s[24:27], s46 offen offset:2560 nt
  s_mov_b32 s46, 3937280
  buffer_store_short v145, v5, s[24:27], s46 offen nt
  buffer_store_short_d16_hi v145, v5, s[24:27], s46 offen offset:2560 nt
  s_mov_b32 s46, 3942400
  buffer_store_short v146, v5, s[24:27], s46 offen nt
  buffer_store_short_d16_hi v146, v5, s[24:27], s46 offen offset:2560 nt
  s_mov_b32 s46, 3947520
  buffer_store_short v147, v5, s[24:27], s46 offen nt
  buffer_store_short_d16_hi v147, v5, s[24:27], s46 offen offset:2560 nt
  s_mov_b32 s46, 4096000
  s_waitcnt lgkmcnt(0)
  buffer_store_short v148, v5, s[24:27], s46 offen nt
  buffer_store_short_d16_hi v148, v5, s[24:27], s46 offen offset:2560 nt
  s_mov_b32 s46, 4101120
  buffer_store_short v149, v5, s[24:27], s46 offen nt
  buffer_store_short_d16_hi v149, v5, s[24:27], s46 offen offset:2560 nt
  s_mov_b32 s46, 4106240
  buffer_store_short v150, v5, s[24:27], s46 offen nt
  buffer_store_short_d16_hi v150, v5, s[24:27], s46 offen offset:2560 nt
  s_mov_b32 s46, 4111360
  buffer_store_short v151, v5, s[24:27], s46 offen nt
  buffer_store_short_d16_hi v151, v5, s[24:27], s46 offen offset:2560 nt
  s_endpgm
L_B:
  s_cmp_ge_u32 s4, 8
  s_cbranch_scc1 L_BI
  s_waitcnt lgkmcnt(0)
  s_mov_b32 s20, s86
  s_and_b32 s21, s87, 0xffff
  s_mov_b32 s22, 2621440
  s_mov_b32 s23, 0x20000
  v_and_b32 v160, 15, v1
  v_lshrrev_b32 v161, 4, v1
  v_lshrrev_b32 v162, 2, v160
  v_and_b32 v163, 3, v160
  v_add_u32 v162, v162, v163
  v_lshlrev_b32 v162, 3, v162
  v_lshl_add_u32 v162, v161, 6, v162
  s_mul_i32 s61, s4, 4128
  s_add_u32 s61, s61, 37024
  s_sub_u32 s5, s61, 24
  v_add_u32 v2, s5, v162
  v_lshlrev_b32 v162, 4, v161
  v_lshlrev_b32 v163, 3, v160
  v_sub_u32 v162, v162, v163
  s_mul_i32 s5, s4, 4624
  s_add_u32 s5, s5, 120
  v_add_u32 v3, s5, v162
  v_lshlrev_b32 v162, 5, v160
  v_lshl_add_u32 v162, v161, 3, v162
  v_lshrrev_b32 v163, 2, v160
  v_lshl_add_u32 v162, v163, 4, v162
  s_mul_i32 s5, s4, 4672
  s_add_u32 s5, s5, 70016
  v_add_u32 v4, s5, v162
  v_add_u32 v162, 47, v1
  v_subrev_u32 v163, 16, v1
  v_cmp_gt_u32 vcc, 16, v1
  v_cndmask_b32 v162, v163, v162, vcc
  v_mov_b32 v163, 63
  v_cmp_eq_u32 vcc, 0, v1
  v_cndmask_b32 v162, v162, v163, vcc
  v_lshlrev_b32 v5, 2, v162
  s_mov_b64 s[40:41], 1
  s_mov_b32 s44, 0xffff0000
  s_lshl_b32 s5, s3, 3
  s_add_u32 s5, s5, s4
  s_lshl_b32 s37, s5, 12
  s_mov_b32 m0, s61
  v_lshlrev_b32 v164, 4, v1
  buffer_load_dwordx4 v164, s[20:23], s37 offen offset:0 lds
  buffer_load_dwordx4 v164, s[20:23], s37 offen offset:1024 lds
  buffer_load_dwordx4 v164, s[20:23], s37 offen offset:2048 lds
  buffer_load_dwordx4 v164, s[20:23], s37 offen offset:3072 lds
  s_lshl_b32 s6, s5, 1
  v_mov_b32 v165, s6
  global_load_short_d16_hi v165, v165, s[88:89]
  v_lshrrev_b32 v160, 4, v1
  v_mul_u32_u24 v160, 1152, v160
  v_and_b32 v161, 15, v1
  v_lshl_add_u32 v160, v161, 3, v160
  s_mul_i32 s5, s4, 4624
  s_add_u32 s5, s5, 1024
  v_add_u32 v160, s5, v160
  v_mov_b32 v162, 0
  v_mov_b32 v163, 0
  ds_write_b64 v160, v[162:163]
  v_and_b32 v161, 3, v1
  v_lshlrev_b32 v161, 3, v161
  s_sub_u32 s5, s61, 32
  v_add_u32 v161, s5, v161
  ds_write_b64 v161, v[162:163]
  v_mov_b32 v10, 0
  v_mov_b32 v11, 0
  v_mov_b32 v12, 0
  v_mov_b32 v13, 0
  v_mov_b32 v14, 0
  v_mov_b32 v15, 0
  s_waitcnt vmcnt(0)
  v_mov_b32 v160, s61
  ds_read_u16 v161, v160
  s_waitcnt lgkmcnt(0)
  v_lshlrev_b32 v161, 16, v161
  v_add_f32 v161, v161, v165
  v_cvt_pk_bf16_f32 v161, v161, v161
  ds_write_b16 v160, v161
  ds_read_b64_tr_b16 v[16:17], v2 offset:0
  ds_read_b64_tr_b16 v[18:19], v2 offset:32
  ds_read_b64_tr_b16 v[20:21], v2 offset:256
  ds_read_b64_tr_b16 v[22:23], v2 offset:288
  ds_read_b64_tr_b16 v[24:25], v2 offset:512
  ds_read_b64_tr_b16 v[26:27], v2 offset:544
  ds_read_b64_tr_b16 v[28:29], v2 offset:768
  ds_read_b64_tr_b16 v[30:31], v2 offset:800
  ds_read_b64_tr_b16 v[32:33], v2 offset:1024
  ds_read_b64_tr_b16 v[34:35], v2 offset:1056
  ds_read_b64_tr_b16 v[36:37], v2 offset:1280
  ds_read_b64_tr_b16 v[38:39], v2 offset:1312
  ds_read_b64_tr_b16 v[40:41], v2 offset:1536
  ds_read_b64_tr_b16 v[42:43], v2 offset:1568
  ds_read_b64_tr_b16 v[44:45], v2 offset:1792
  ds_read_b64_tr_b16 v[46:47], v2 offset:1824
  s_waitcnt lgkmcnt(0)
  s_barrier
  ds_read_b64 v[144:145], v3 offset:960
  ds_read_b64 v[146:147], v3 offset:968
  ds_read_b64 v[148:149], v3 offset:2112
  ds_read_b64 v[150:151], v3 offset:2120
  ds_read_b64 v[152:153], v3 offset:3264
  ds_read_b64 v[154:155], v3 offset:3272
  ds_read_b64 v[156:157], v3 offset:4416
  ds_read_b64 v[158:159], v3 offset:4424
  ds_read_b64 v[160:161], v3 offset:896
  ds_read_b64 v[162:163], v3 offset:904
  s_waitcnt lgkmcnt(8)
  v_mfma_f32_16x16x32_bf16 v[80:83], v[20:23], v[144:147], 0
  v_mfma_f32_16x16x32_bf16 v[96:99], v[28:31], v[144:147], 0
  v_mfma_f32_16x16x32_bf16 v[112:115], v[36:39], v[144:147], 0
  v_mfma_f32_16x16x32_bf16 v[128:131], v[44:47], v[144:147], 0
  ds_read_b64 v[144:145], v3 offset:2048
  ds_read_b64 v[146:147], v3 offset:2056
  s_waitcnt lgkmcnt(8)
  v_mfma_f32_16x16x32_bf16 v[84:87], v[20:23], v[148:151], 0
  v_mfma_f32_16x16x32_bf16 v[100:103], v[28:31], v[148:151], 0
  v_mfma_f32_16x16x32_bf16 v[116:119], v[36:39], v[148:151], 0
  v_mfma_f32_16x16x32_bf16 v[132:135], v[44:47], v[148:151], 0
  ds_read_b64 v[148:149], v3 offset:3200
  ds_read_b64 v[150:151], v3 offset:3208
  s_waitcnt lgkmcnt(8)
  v_mfma_f32_16x16x32_bf16 v[88:91], v[20:23], v[152:155], 0
  v_mfma_f32_16x16x32_bf16 v[104:107], v[28:31], v[152:155], 0
  v_mfma_f32_16x16x32_bf16 v[120:123], v[36:39], v[152:155], 0
  v_mfma_f32_16x16x32_bf16 v[136:139], v[44:47], v[152:155], 0
  ds_read_b64 v[152:153], v3 offset:4352
  ds_read_b64 v[154:155], v3 offset:4360
  s_waitcnt lgkmcnt(8)
  v_mfma_f32_16x16x32_bf16 v[92:95], v[20:23], v[156:159], 0
  v_mfma_f32_16x16x32_bf16 v[108:111], v[28:31], v[156:159], 0
  v_mfma_f32_16x16x32_bf16 v[124:127], v[36:39], v[156:159], 0
  v_mfma_f32_16x16x32_bf16 v[140:143], v[44:47], v[156:159], 0
  ds_read_b64 v[156:157], v3 offset:832
  ds_read_b64 v[158:159], v3 offset:840
  s_waitcnt lgkmcnt(8)
  v_mfma_f32_16x16x32_bf16 v[80:83], v[16:19], v[160:163], v[80:83]
  v_mfma_f32_16x16x32_bf16 v[96:99], v[24:27], v[160:163], v[96:99]
  v_mfma_f32_16x16x32_bf16 v[112:115], v[32:35], v[160:163], v[112:115]
  v_mfma_f32_16x16x32_bf16 v[128:131], v[40:43], v[160:163], v[128:131]
  ds_read_b64 v[160:161], v3 offset:1984
  ds_read_b64 v[162:163], v3 offset:1992
  s_waitcnt lgkmcnt(8)
  v_mfma_f32_16x16x32_bf16 v[84:87], v[16:19], v[144:147], v[84:87]
  v_mfma_f32_16x16x32_bf16 v[100:103], v[24:27], v[144:147], v[100:103]
  v_mfma_f32_16x16x32_bf16 v[116:119], v[32:35], v[144:147], v[116:119]
  v_mfma_f32_16x16x32_bf16 v[132:135], v[40:43], v[144:147], v[132:135]
  ds_read_b64 v[144:145], v3 offset:3136
  ds_read_b64 v[146:147], v3 offset:3144
  s_waitcnt lgkmcnt(8)
  v_mfma_f32_16x16x32_bf16 v[88:91], v[16:19], v[148:151], v[88:91]
  v_mfma_f32_16x16x32_bf16 v[104:107], v[24:27], v[148:151], v[104:107]
  v_mfma_f32_16x16x32_bf16 v[120:123], v[32:35], v[148:151], v[120:123]
  v_mfma_f32_16x16x32_bf16 v[136:139], v[40:43], v[148:151], v[136:139]
  ds_read_b64 v[148:149], v3 offset:4288
  ds_read_b64 v[150:151], v3 offset:4296
  s_waitcnt lgkmcnt(8)
  v_mfma_f32_16x16x32_bf16 v[92:95], v[16:19], v[152:155], v[92:95]
  v_mfma_f32_16x16x32_bf16 v[108:111], v[24:27], v[152:155], v[108:111]
  ds_read_b64_tr_b16 v[48:49], v2 offset:2048
  v_mfma_f32_16x16x32_bf16 v[124:127], v[32:35], v[152:155], v[124:127]
  ds_read_b64_tr_b16 v[50:51], v2 offset:2080
  v_mfma_f32_16x16x32_bf16 v[140:143], v[40:43], v[152:155], v[140:143]
  ds_read_b64_tr_b16 v[52:53], v2 offset:2304
  ds_read_b64 v[152:153], v3 offset:768
  ds_read_b64 v[154:155], v3 offset:776
  s_waitcnt lgkmcnt(11)
  v_mfma_f32_16x16x32_bf16 v[96:99], v[20:23], v[156:159], v[96:99]
  ds_read_b64_tr_b16 v[54:55], v2 offset:2336
  v_mfma_f32_16x16x32_bf16 v[112:115], v[28:31], v[156:159], v[112:115]
  ds_read_b64_tr_b16 v[56:57], v2 offset:2560
  v_mfma_f32_16x16x32_bf16 v[128:131], v[36:39], v[156:159], v[128:131]
  ds_read_b64_tr_b16 v[58:59], v2 offset:2592
  ds_read_b64 v[156:157], v3 offset:1920
  ds_read_b64 v[158:159], v3 offset:1928
  s_waitcnt lgkmcnt(14)
  v_mfma_f32_16x16x32_bf16 v[100:103], v[20:23], v[160:163], v[100:103]
  ds_read_b64_tr_b16 v[60:61], v2 offset:2816
  v_mfma_f32_16x16x32_bf16 v[116:119], v[28:31], v[160:163], v[116:119]
  ds_read_b64_tr_b16 v[62:63], v2 offset:2848
  v_mfma_f32_16x16x32_bf16 v[132:135], v[36:39], v[160:163], v[132:135]
  ds_read_b64_tr_b16 v[64:65], v2 offset:3072
  ds_read_b64 v[160:161], v3 offset:3072
  ds_read_b64 v[162:163], v3 offset:3080
  s_waitcnt lgkmcnt(15)
  v_mfma_f32_16x16x32_bf16 v[104:107], v[20:23], v[144:147], v[104:107]
  ds_read_b64_tr_b16 v[66:67], v2 offset:3104
  v_mfma_f32_16x16x32_bf16 v[120:123], v[28:31], v[144:147], v[120:123]
  ds_read_b64_tr_b16 v[68:69], v2 offset:3328
  v_mfma_f32_16x16x32_bf16 v[136:139], v[36:39], v[144:147], v[136:139]
  ds_read_b64_tr_b16 v[70:71], v2 offset:3360
  ds_read_b64 v[144:145], v3 offset:4224
  ds_read_b64 v[146:147], v3 offset:4232
  v_mfma_f32_16x16x32_bf16 v[108:111], v[20:23], v[148:151], v[108:111]
  ds_read_b64_tr_b16 v[72:73], v2 offset:3584
  v_mfma_f32_16x16x32_bf16 v[124:127], v[28:31], v[148:151], v[124:127]
  ds_read_b64_tr_b16 v[74:75], v2 offset:3616
  v_mfma_f32_16x16x32_bf16 v[140:143], v[36:39], v[148:151], v[140:143]
  ds_read_b64_tr_b16 v[76:77], v2 offset:3840
  ds_read_b64_tr_b16 v[78:79], v2 offset:3872
  v_add_f32 v8, v87, v90
  v_add_f32 v81, v81, v84
  v_add_f32 v8, v8, v93
  v_add_f32 v82, v82, v85
  v_add_f32 v9, v91, v94
  ds_bpermute_b32 v10, v5, v8
  ds_bpermute_b32 v11, v5, v9
  ds_bpermute_b32 v12, v5, v95
  v_add_f32 v83, v83, v86
  v_add_f32 v82, v82, v88
  v_add_f32 v83, v83, v89
  v_add_f32 v83, v83, v92
  s_waitcnt lgkmcnt(2)
  v_cndmask_b32 v13, v10, v13, s[40:41]
  s_waitcnt lgkmcnt(1)
  v_cndmask_b32 v14, v11, v14, s[40:41]
  s_waitcnt lgkmcnt(0)
  v_cndmask_b32 v15, v12, v15, s[40:41]
  v_add_f32 v80, v80, v13
  v_add_f32 v81, v81, v14
  v_add_f32 v82, v82, v15
  v_cvt_pk_bf16_f32 v6, v80, v81
  v_cvt_pk_bf16_f32 v7, v82, v83
  ds_write_b64 v4, v[6:7] offset:0
  s_waitcnt lgkmcnt(0)
  s_barrier
  ds_read_b64 v[148:149], v3 offset:704
  ds_read_b64 v[150:151], v3 offset:712
  v_mfma_f32_16x16x32_bf16 v[96:99], v[16:19], v[152:155], v[96:99]
  v_mfma_f32_16x16x32_bf16 v[112:115], v[24:27], v[152:155], v[112:115]
  v_mfma_f32_16x16x32_bf16 v[128:131], v[32:35], v[152:155], v[128:131]
  ds_read_b64 v[152:153], v3 offset:1856
  ds_read_b64 v[154:155], v3 offset:1864
  v_mfma_f32_16x16x32_bf16 v[100:103], v[16:19], v[156:159], v[100:103]
  v_mfma_f32_16x16x32_bf16 v[116:119], v[24:27], v[156:159], v[116:119]
  v_mfma_f32_16x16x32_bf16 v[132:135], v[32:35], v[156:159], v[132:135]
  ds_read_b64 v[156:157], v3 offset:3008
  ds_read_b64 v[158:159], v3 offset:3016
  v_mfma_f32_16x16x32_bf16 v[104:107], v[16:19], v[160:163], v[104:107]
  v_mfma_f32_16x16x32_bf16 v[120:123], v[24:27], v[160:163], v[120:123]
  v_mfma_f32_16x16x32_bf16 v[136:139], v[32:35], v[160:163], v[136:139]
  ds_read_b64 v[160:161], v3 offset:4160
  ds_read_b64 v[162:163], v3 offset:4168
  v_mfma_f32_16x16x32_bf16 v[108:111], v[16:19], v[144:147], v[108:111]
  v_mfma_f32_16x16x32_bf16 v[124:127], v[24:27], v[144:147], v[124:127]
  v_mfma_f32_16x16x32_bf16 v[140:143], v[32:35], v[144:147], v[140:143]
  ds_read_b64 v[144:145], v3 offset:640
  ds_read_b64 v[146:147], v3 offset:648
  s_waitcnt lgkmcnt(8)
  v_mfma_f32_16x16x32_bf16 v[112:115], v[20:23], v[148:151], v[112:115]
  v_add_f32 v8, v103, v106
  v_mfma_f32_16x16x32_bf16 v[128:131], v[28:31], v[148:151], v[128:131]
  v_add_f32 v97, v97, v100
  v_mfma_f32_16x16x32_bf16 v[80:83], v[36:39], v[148:151], 0
  v_add_f32 v8, v8, v109
  ds_read_b64 v[148:149], v3 offset:1792
  ds_read_b64 v[150:151], v3 offset:1800
  s_waitcnt lgkmcnt(8)
  v_mfma_f32_16x16x32_bf16 v[116:119], v[20:23], v[152:155], v[116:119]
  v_add_f32 v98, v98, v101
  v_mfma_f32_16x16x32_bf16 v[132:135], v[28:31], v[152:155], v[132:135]
  v_add_f32 v9, v107, v110
  v_mfma_f32_16x16x32_bf16 v[84:87], v[36:39], v[152:155], 0
  ds_bpermute_b32 v13, v5, v8
  ds_read_b64 v[152:153], v3 offset:2944
  ds_read_b64 v[154:155], v3 offset:2952
  s_waitcnt lgkmcnt(9)
  v_mfma_f32_16x16x32_bf16 v[120:123], v[20:23], v[156:159], v[120:123]
  ds_bpermute_b32 v14, v5, v9
  v_mfma_f32_16x16x32_bf16 v[136:139], v[28:31], v[156:159], v[136:139]
  ds_bpermute_b32 v15, v5, v111
  v_mfma_f32_16x16x32_bf16 v[88:91], v[36:39], v[156:159], 0
  v_add_f32 v99, v99, v102
  ds_read_b64 v[156:157], v3 offset:4096
  ds_read_b64 v[158:159], v3 offset:4104
  s_waitcnt lgkmcnt(11)
  v_mfma_f32_16x16x32_bf16 v[124:127], v[20:23], v[160:163], v[124:127]
  v_add_f32 v98, v98, v104
  v_mfma_f32_16x16x32_bf16 v[140:143], v[28:31], v[160:163], v[140:143]
  v_add_f32 v99, v99, v105
  v_mfma_f32_16x16x32_bf16 v[92:95], v[36:39], v[160:163], 0
  v_add_f32 v99, v99, v108
  ds_read_b64 v[160:161], v3 offset:576
  ds_read_b64 v[162:163], v3 offset:584
  s_waitcnt lgkmcnt(11)
  v_mfma_f32_16x16x32_bf16 v[112:115], v[16:19], v[144:147], v[112:115]
  v_mfma_f32_16x16x32_bf16 v[128:131], v[24:27], v[144:147], v[128:131]
  v_mfma_f32_16x16x32_bf16 v[80:83], v[32:35], v[144:147], v[80:83]
  ds_read_b64 v[144:145], v3 offset:1728
  ds_read_b64 v[146:147], v3 offset:1736
  s_waitcnt lgkmcnt(11)
  v_mfma_f32_16x16x32_bf16 v[116:119], v[16:19], v[148:151], v[116:119]
  s_waitcnt lgkmcnt(10)
  v_cndmask_b32 v10, v13, v10, s[40:41]
  v_mfma_f32_16x16x32_bf16 v[132:135], v[24:27], v[148:151], v[132:135]
  s_waitcnt lgkmcnt(7)
  v_cndmask_b32 v11, v14, v11, s[40:41]
  v_mfma_f32_16x16x32_bf16 v[84:87], v[32:35], v[148:151], v[84:87]
  s_waitcnt lgkmcnt(6)
  v_cndmask_b32 v12, v15, v12, s[40:41]
  ds_read_b64 v[148:149], v3 offset:2880
  ds_read_b64 v[150:151], v3 offset:2888
  v_mfma_f32_16x16x32_bf16 v[120:123], v[16:19], v[152:155], v[120:123]
  v_add_f32 v96, v96, v10
  v_mfma_f32_16x16x32_bf16 v[136:139], v[24:27], v[152:155], v[136:139]
  v_add_f32 v97, v97, v11
  v_mfma_f32_16x16x32_bf16 v[88:91], v[32:35], v[152:155], v[88:91]
  v_add_f32 v98, v98, v12
  ds_read_b64 v[152:153], v3 offset:4032
  ds_read_b64 v[154:155], v3 offset:4040
  s_waitcnt lgkmcnt(8)
  v_mfma_f32_16x16x32_bf16 v[124:127], v[16:19], v[156:159], v[124:127]
  v_cvt_pk_bf16_f32 v6, v96, v97
  v_mfma_f32_16x16x32_bf16 v[140:143], v[24:27], v[156:159], v[140:143]
  v_cvt_pk_bf16_f32 v7, v98, v99
  v_mfma_f32_16x16x32_bf16 v[92:95], v[32:35], v[156:159], v[92:95]
  ds_write_b64 v4, v[6:7] offset:576
  ds_read_b64 v[156:157], v3 offset:512
  ds_read_b64 v[158:159], v3 offset:520
  s_waitcnt lgkmcnt(9)
  v_mfma_f32_16x16x32_bf16 v[128:131], v[20:23], v[160:163], v[128:131]
  v_add_f32 v8, v119, v122
  v_mfma_f32_16x16x32_bf16 v[80:83], v[28:31], v[160:163], v[80:83]
  v_add_f32 v113, v113, v116
  v_mfma_f32_16x16x32_bf16 v[96:99], v[36:39], v[160:163], 0
  v_add_f32 v8, v8, v125
  ds_read_b64 v[160:161], v3 offset:1664
  ds_read_b64 v[162:163], v3 offset:1672
  s_waitcnt lgkmcnt(9)
  v_mfma_f32_16x16x32_bf16 v[132:135], v[20:23], v[144:147], v[132:135]
  v_add_f32 v114, v114, v117
  v_mfma_f32_16x16x32_bf16 v[84:87], v[28:31], v[144:147], v[84:87]
  v_add_f32 v9, v123, v126
  v_mfma_f32_16x16x32_bf16 v[100:103], v[36:39], v[144:147], 0
  ds_bpermute_b32 v10, v5, v8
  ds_read_b64 v[144:145], v3 offset:2816
  ds_read_b64 v[146:147], v3 offset:2824
  s_waitcnt lgkmcnt(10)
  v_mfma_f32_16x16x32_bf16 v[136:139], v[20:23], v[148:151], v[136:139]
  ds_bpermute_b32 v11, v5, v9
  v_mfma_f32_16x16x32_bf16 v[88:91], v[28:31], v[148:151], v[88:91]
  ds_bpermute_b32 v12, v5, v127
  v_mfma_f32_16x16x32_bf16 v[104:107], v[36:39], v[148:151], 0
  v_add_f32 v115, v115, v118
  ds_read_b64 v[148:149], v3 offset:3968
  ds_read_b64 v[150:151], v3 offset:3976
  s_waitcnt lgkmcnt(12)
  v_mfma_f32_16x16x32_bf16 v[140:143], v[20:23], v[152:155], v[140:143]
  v_add_f32 v114, v114, v120
  v_mfma_f32_16x16x32_bf16 v[92:95], v[28:31], v[152:155], v[92:95]
  v_add_f32 v115, v115, v121
  v_mfma_f32_16x16x32_bf16 v[108:111], v[36:39], v[152:155], 0
  v_add_f32 v115, v115, v124
  ds_read_b64 v[152:153], v3 offset:960
  ds_read_b64 v[154:155], v3 offset:968
  s_waitcnt lgkmcnt(11)
  v_mfma_f32_16x16x32_bf16 v[128:131], v[16:19], v[156:159], v[128:131]
  v_mfma_f32_16x16x32_bf16 v[80:83], v[24:27], v[156:159], v[80:83]
  v_mfma_f32_16x16x32_bf16 v[96:99], v[32:35], v[156:159], v[96:99]
  ds_read_b64 v[156:157], v3 offset:2112
  ds_read_b64 v[158:159], v3 offset:2120
  s_waitcnt lgkmcnt(11)
  v_mfma_f32_16x16x32_bf16 v[132:135], v[16:19], v[160:163], v[132:135]
  s_waitcnt lgkmcnt(10)
  v_cndmask_b32 v13, v10, v13, s[40:41]
  v_mfma_f32_16x16x32_bf16 v[84:87], v[24:27], v[160:163], v[84:87]
  s_waitcnt lgkmcnt(7)
  v_cndmask_b32 v14, v11, v14, s[40:41]
  v_mfma_f32_16x16x32_bf16 v[100:103], v[32:35], v[160:163], v[100:103]
  s_waitcnt lgkmcnt(6)
  v_cndmask_b32 v15, v12, v15, s[40:41]
  ds_read_b64 v[160:161], v3 offset:3264
  ds_read_b64 v[162:163], v3 offset:3272
  v_mfma_f32_16x16x32_bf16 v[136:139], v[16:19], v[144:147], v[136:139]
  v_add_f32 v112, v112, v13
  v_mfma_f32_16x16x32_bf16 v[88:91], v[24:27], v[144:147], v[88:91]
  v_add_f32 v113, v113, v14
  v_mfma_f32_16x16x32_bf16 v[104:107], v[32:35], v[144:147], v[104:107]
  v_add_f32 v114, v114, v15
  ds_read_b64 v[144:145], v3 offset:4416
  ds_read_b64 v[146:147], v3 offset:4424
  s_waitcnt lgkmcnt(8)
  v_mfma_f32_16x16x32_bf16 v[140:143], v[16:19], v[148:151], v[140:143]
  v_cvt_pk_bf16_f32 v6, v112, v113
  v_mfma_f32_16x16x32_bf16 v[92:95], v[24:27], v[148:151], v[92:95]
  v_cvt_pk_bf16_f32 v7, v114, v115
  v_mfma_f32_16x16x32_bf16 v[108:111], v[32:35], v[148:151], v[108:111]
  ds_write_b64 v4, v[6:7] offset:1152
  ds_read_b64 v[148:149], v3 offset:896
  ds_read_b64 v[150:151], v3 offset:904
  s_waitcnt lgkmcnt(9)
  v_mfma_f32_16x16x32_bf16 v[80:83], v[52:55], v[152:155], v[80:83]
  v_add_f32 v8, v135, v138
  v_mfma_f32_16x16x32_bf16 v[96:99], v[60:63], v[152:155], v[96:99]
  v_add_f32 v129, v129, v132
  v_mfma_f32_16x16x32_bf16 v[112:115], v[68:71], v[152:155], 0
  v_add_f32 v8, v8, v141
  ds_read_b64 v[152:153], v3 offset:2048
  ds_read_b64 v[154:155], v3 offset:2056
  s_waitcnt lgkmcnt(9)
  v_mfma_f32_16x16x32_bf16 v[84:87], v[52:55], v[156:159], v[84:87]
  v_add_f32 v130, v130, v133
  v_mfma_f32_16x16x32_bf16 v[100:103], v[60:63], v[156:159], v[100:103]
  v_add_f32 v9, v139, v142
  v_mfma_f32_16x16x32_bf16 v[116:119], v[68:71], v[156:159], 0
  ds_bpermute_b32 v13, v5, v8
  ds_read_b64 v[156:157], v3 offset:3200
  ds_read_b64 v[158:159], v3 offset:3208
  s_waitcnt lgkmcnt(10)
  v_mfma_f32_16x16x32_bf16 v[88:91], v[52:55], v[160:163], v[88:91]
  ds_bpermute_b32 v14, v5, v9
  v_mfma_f32_16x16x32_bf16 v[104:107], v[60:63], v[160:163], v[104:107]
  ds_bpermute_b32 v15, v5, v143
  v_mfma_f32_16x16x32_bf16 v[120:123], v[68:71], v[160:163], 0
  v_add_f32 v131, v131, v134
  ds_read_b64 v[160:161], v3 offset:4352
  ds_read_b64 v[162:163], v3 offset:4360
  s_waitcnt lgkmcnt(12)
  v_mfma_f32_16x16x32_bf16 v[92:95], v[52:55], v[144:147], v[92:95]
  v_add_f32 v130, v130, v136
  v_mfma_f32_16x16x32_bf16 v[108:111], v[60:63], v[144:147], v[108:111]
  v_add_f32 v131, v131, v137
  v_mfma_f32_16x16x32_bf16 v[124:127], v[68:71], v[144:147], 0
  v_add_f32 v131, v131, v140
  ds_read_b64 v[144:145], v3 offset:832
  ds_read_b64 v[146:147], v3 offset:840
  s_waitcnt lgkmcnt(11)
  v_mfma_f32_16x16x32_bf16 v[80:83], v[48:51], v[148:151], v[80:83]
  v_mfma_f32_16x16x32_bf16 v[96:99], v[56:59], v[148:151], v[96:99]
  v_mfma_f32_16x16x32_bf16 v[112:115], v[64:67], v[148:151], v[112:115]
  ds_read_b64 v[148:149], v3 offset:1984
  ds_read_b64 v[150:151], v3 offset:1992
  s_waitcnt lgkmcnt(11)
  v_mfma_f32_16x16x32_bf16 v[84:87], v[48:51], v[152:155], v[84:87]
  s_waitcnt lgkmcnt(10)
  v_cndmask_b32 v10, v13, v10, s[40:41]
  v_mfma_f32_16x16x32_bf16 v[100:103], v[56:59], v[152:155], v[100:103]
  s_waitcnt lgkmcnt(7)
  v_cndmask_b32 v11, v14, v11, s[40:41]
  v_mfma_f32_16x16x32_bf16 v[116:119], v[64:67], v[152:155], v[116:119]
  s_waitcnt lgkmcnt(6)
  v_cndmask_b32 v12, v15, v12, s[40:41]
  ds_read_b64 v[152:153], v3 offset:3136
  ds_read_b64 v[154:155], v3 offset:3144
  v_mfma_f32_16x16x32_bf16 v[88:91], v[48:51], v[156:159], v[88:91]
  v_add_f32 v128, v128, v10
  v_mfma_f32_16x16x32_bf16 v[104:107], v[56:59], v[156:159], v[104:107]
  v_add_f32 v129, v129, v11
  v_mfma_f32_16x16x32_bf16 v[120:123], v[64:67], v[156:159], v[120:123]
  v_add_f32 v130, v130, v12
  ds_read_b64 v[156:157], v3 offset:4288
  ds_read_b64 v[158:159], v3 offset:4296
  s_waitcnt lgkmcnt(8)
  v_mfma_f32_16x16x32_bf16 v[92:95], v[48:51], v[160:163], v[92:95]
  v_cvt_pk_bf16_f32 v6, v128, v129
  v_mfma_f32_16x16x32_bf16 v[108:111], v[56:59], v[160:163], v[108:111]
  v_cvt_pk_bf16_f32 v7, v130, v131
  v_mfma_f32_16x16x32_bf16 v[124:127], v[64:67], v[160:163], v[124:127]
  ds_write_b64 v4, v[6:7] offset:1728
  ds_read_b64 v[160:161], v3 offset:768
  ds_read_b64 v[162:163], v3 offset:776
  s_waitcnt lgkmcnt(9)
  v_mfma_f32_16x16x32_bf16 v[80:83], v[44:47], v[144:147], v[80:83]
  s_waitcnt lgkmcnt(0)
  s_barrier
  v_mfma_f32_16x16x32_bf16 v[96:99], v[52:55], v[144:147], v[96:99]
  v_mfma_f32_16x16x32_bf16 v[112:115], v[60:63], v[144:147], v[112:115]
  v_mfma_f32_16x16x32_bf16 v[128:131], v[68:71], v[144:147], 0
  ds_read_b64 v[144:145], v3 offset:1920
  ds_read_b64 v[146:147], v3 offset:1928
  v_mfma_f32_16x16x32_bf16 v[84:87], v[44:47], v[148:151], v[84:87]
  v_mfma_f32_16x16x32_bf16 v[100:103], v[52:55], v[148:151], v[100:103]
  v_mfma_f32_16x16x32_bf16 v[116:119], v[60:63], v[148:151], v[116:119]
  v_mfma_f32_16x16x32_bf16 v[132:135], v[68:71], v[148:151], 0
  ds_read_b64 v[148:149], v3 offset:3072
  ds_read_b64 v[150:151], v3 offset:3080
  v_mfma_f32_16x16x32_bf16 v[88:91], v[44:47], v[152:155], v[88:91]
  v_mfma_f32_16x16x32_bf16 v[104:107], v[52:55], v[152:155], v[104:107]
  v_mfma_f32_16x16x32_bf16 v[120:123], v[60:63], v[152:155], v[120:123]
  v_mfma_f32_16x16x32_bf16 v[136:139], v[68:71], v[152:155], 0
  ds_read_b64 v[152:153], v3 offset:4224
  ds_read_b64 v[154:155], v3 offset:4232
  v_mfma_f32_16x16x32_bf16 v[92:95], v[44:47], v[156:159], v[92:95]
  v_mfma_f32_16x16x32_bf16 v[108:111], v[52:55], v[156:159], v[108:111]
  v_mfma_f32_16x16x32_bf16 v[124:127], v[60:63], v[156:159], v[124:127]
  v_mfma_f32_16x16x32_bf16 v[140:143], v[68:71], v[156:159], 0
  ds_read_b64 v[156:157], v3 offset:704
  ds_read_b64 v[158:159], v3 offset:712
  v_mfma_f32_16x16x32_bf16 v[80:83], v[40:43], v[160:163], v[80:83]
  v_mfma_f32_16x16x32_bf16 v[96:99], v[48:51], v[160:163], v[96:99]
  v_mfma_f32_16x16x32_bf16 v[112:115], v[56:59], v[160:163], v[112:115]
  v_mfma_f32_16x16x32_bf16 v[128:131], v[64:67], v[160:163], v[128:131]
  ds_read_b64 v[160:161], v3 offset:960
  ds_read_b64 v[162:163], v3 offset:968
  s_waitcnt lgkmcnt(8)
  v_mfma_f32_16x16x32_bf16 v[84:87], v[40:43], v[144:147], v[84:87]
  v_mfma_f32_16x16x32_bf16 v[100:103], v[48:51], v[144:147], v[100:103]
  v_mfma_f32_16x16x32_bf16 v[116:119], v[56:59], v[144:147], v[116:119]
  v_mfma_f32_16x16x32_bf16 v[132:135], v[64:67], v[144:147], v[132:135]
  ds_read_b64 v[144:145], v3 offset:1856
  ds_read_b64 v[146:147], v3 offset:1864
  s_waitcnt lgkmcnt(8)
  v_mfma_f32_16x16x32_bf16 v[88:91], v[40:43], v[148:151], v[88:91]
  v_mfma_f32_16x16x32_bf16 v[104:107], v[48:51], v[148:151], v[104:107]
  v_mfma_f32_16x16x32_bf16 v[120:123], v[56:59], v[148:151], v[120:123]
  v_mfma_f32_16x16x32_bf16 v[136:139], v[64:67], v[148:151], v[136:139]
  ds_read_b64 v[148:149], v3 offset:3008
  ds_read_b64 v[150:151], v3 offset:3016
  s_waitcnt lgkmcnt(8)
  v_mfma_f32_16x16x32_bf16 v[92:95], v[40:43], v[152:155], v[92:95]
  v_mfma_f32_16x16x32_bf16 v[108:111], v[48:51], v[152:155], v[108:111]
  v_mfma_f32_16x16x32_bf16 v[124:127], v[56:59], v[152:155], v[124:127]
  v_mfma_f32_16x16x32_bf16 v[140:143], v[64:67], v[152:155], v[140:143]
  ds_read_b64 v[152:153], v3 offset:2112
  ds_read_b64 v[154:155], v3 offset:2120
  s_waitcnt lgkmcnt(8)
  v_mfma_f32_16x16x32_bf16 v[96:99], v[44:47], v[156:159], v[96:99]
  v_mfma_f32_16x16x32_bf16 v[112:115], v[52:55], v[156:159], v[112:115]
  v_mfma_f32_16x16x32_bf16 v[128:131], v[60:63], v[156:159], v[128:131]
  ds_read_b64 v[156:157], v3 offset:4160
  ds_read_b64 v[158:159], v3 offset:4168
  s_waitcnt lgkmcnt(8)
  v_mfma_f32_16x16x32_bf16 v[128:131], v[76:79], v[160:163], v[128:131]
  ds_read_b64 v[160:161], v3 offset:640
  ds_read_b64 v[162:163], v3 offset:648
  s_waitcnt lgkmcnt(8)
  v_mfma_f32_16x16x32_bf16 v[100:103], v[44:47], v[144:147], v[100:103]
  v_mfma_f32_16x16x32_bf16 v[116:119], v[52:55], v[144:147], v[116:119]
  v_mfma_f32_16x16x32_bf16 v[132:135], v[60:63], v[144:147], v[132:135]
  ds_read_b64 v[144:145], v3 offset:3264
  ds_read_b64 v[146:147], v3 offset:3272
  s_waitcnt lgkmcnt(8)
  v_mfma_f32_16x16x32_bf16 v[104:107], v[44:47], v[148:151], v[104:107]
  v_mfma_f32_16x16x32_bf16 v[120:123], v[52:55], v[148:151], v[120:123]
  v_mfma_f32_16x16x32_bf16 v[136:139], v[60:63], v[148:151], v[136:139]
  ds_read_b64 v[148:149], v3 offset:1792
  ds_read_b64 v[150:151], v3 offset:1800
  s_waitcnt lgkmcnt(8)
  v_mfma_f32_16x16x32_bf16 v[132:135], v[76:79], v[152:155], v[132:135]
  ds_read_b64 v[152:153], v3 offset:2944
  ds_read_b64 v[154:155], v3 offset:2952
  s_waitcnt lgkmcnt(8)
  v_mfma_f32_16x16x32_bf16 v[108:111], v[44:47], v[156:159], v[108:111]
  v_mfma_f32_16x16x32_bf16 v[124:127], v[52:55], v[156:159], v[124:127]
  v_mfma_f32_16x16x32_bf16 v[140:143], v[60:63], v[156:159], v[140:143]
  ds_read_b64 v[156:157], v3 offset:4416
  ds_read_b64 v[158:159], v3 offset:4424
  s_waitcnt lgkmcnt(8)
  v_mfma_f32_16x16x32_bf16 v[96:99], v[40:43], v[160:163], v[96:99]
  v_mfma_f32_16x16x32_bf16 v[112:115], v[48:51], v[160:163], v[112:115]
  v_mfma_f32_16x16x32_bf16 v[128:131], v[56:59], v[160:163], v[128:131]
  ds_read_b64 v[160:161], v3 offset:4096
  ds_read_b64 v[162:163], v3 offset:4104
  s_waitcnt lgkmcnt(8)
  v_mfma_f32_16x16x32_bf16 v[136:139], v[76:79], v[144:147], v[136:139]
  ds_read_b64 v[144:145], v3 offset:576
  ds_read_b64 v[146:147], v3 offset:584
  s_waitcnt lgkmcnt(8)
  v_mfma_f32_16x16x32_bf16 v[100:103], v[40:43], v[148:151], v[100:103]
  v_mfma_f32_16x16x32_bf16 v[116:119], v[48:51], v[148:151], v[116:119]
  v_mfma_f32_16x16x32_bf16 v[132:135], v[56:59], v[148:151], v[132:135]
  ds_read_b64 v[148:149], v3 offset:896
  ds_read_b64 v[150:151], v3 offset:904
  s_waitcnt lgkmcnt(8)
  v_mfma_f32_16x16x32_bf16 v[104:107], v[40:43], v[152:155], v[104:107]
  v_mfma_f32_16x16x32_bf16 v[120:123], v[48:51], v[152:155], v[120:123]
  v_mfma_f32_16x16x32_bf16 v[136:139], v[56:59], v[152:155], v[136:139]
  ds_read_b64 v[152:153], v3 offset:1728
  ds_read_b64 v[154:155], v3 offset:1736
  s_waitcnt lgkmcnt(8)
  v_mfma_f32_16x16x32_bf16 v[140:143], v[76:79], v[156:159], v[140:143]
  ds_read_b64 v[156:157], v3 offset:2880
  ds_read_b64 v[158:159], v3 offset:2888
  s_waitcnt lgkmcnt(8)
  v_mfma_f32_16x16x32_bf16 v[108:111], v[40:43], v[160:163], v[108:111]
  v_mfma_f32_16x16x32_bf16 v[124:127], v[48:51], v[160:163], v[124:127]
  v_mfma_f32_16x16x32_bf16 v[140:143], v[56:59], v[160:163], v[140:143]
  ds_read_b64 v[160:161], v3 offset:2048
  ds_read_b64 v[162:163], v3 offset:2056
  s_waitcnt lgkmcnt(8)
  v_mfma_f32_16x16x32_bf16 v[112:115], v[44:47], v[144:147], v[112:115]
  v_mfma_f32_16x16x32_bf16 v[128:131], v[52:55], v[144:147], v[128:131]
  ds_read_b64 v[144:145], v3 offset:4032
  ds_read_b64 v[146:147], v3 offset:4040
  s_waitcnt lgkmcnt(8)
  v_mfma_f32_16x16x32_bf16 v[128:131], v[72:75], v[148:151], v[128:131]
  ds_read_b64 v[148:149], v3 offset:512
  ds_read_b64 v[150:151], v3 offset:520
  s_waitcnt lgkmcnt(8)
  v_mfma_f32_16x16x32_bf16 v[116:119], v[44:47], v[152:155], v[116:119]
  v_mfma_f32_16x16x32_bf16 v[132:135], v[52:55], v[152:155], v[132:135]
  ds_read_b64 v[152:153], v3 offset:3200
  ds_read_b64 v[154:155], v3 offset:3208
  s_waitcnt lgkmcnt(8)
  v_mfma_f32_16x16x32_bf16 v[120:123], v[44:47], v[156:159], v[120:123]
  v_mfma_f32_16x16x32_bf16 v[136:139], v[52:55], v[156:159], v[136:139]
  ds_read_b64 v[156:157], v3 offset:1664
  ds_read_b64 v[158:159], v3 offset:1672
  s_waitcnt lgkmcnt(8)
  v_mfma_f32_16x16x32_bf16 v[132:135], v[72:75], v[160:163], v[132:135]
  ds_read_b64 v[160:161], v3 offset:2816
  ds_read_b64 v[162:163], v3 offset:2824
  s_waitcnt lgkmcnt(8)
  v_mfma_f32_16x16x32_bf16 v[124:127], v[44:47], v[144:147], v[124:127]
  v_mfma_f32_16x16x32_bf16 v[140:143], v[52:55], v[144:147], v[140:143]
  ds_read_b64 v[144:145], v3 offset:4352
  ds_read_b64 v[146:147], v3 offset:4360
  s_waitcnt lgkmcnt(8)
  v_mfma_f32_16x16x32_bf16 v[112:115], v[40:43], v[148:151], v[112:115]
  v_mfma_f32_16x16x32_bf16 v[128:131], v[48:51], v[148:151], v[128:131]
  ds_read_b64 v[148:149], v3 offset:3968
  ds_read_b64 v[150:151], v3 offset:3976
  s_waitcnt lgkmcnt(8)
  v_mfma_f32_16x16x32_bf16 v[136:139], v[72:75], v[152:155], v[136:139]
  ds_read_b64 v[152:153], v3 offset:448
  ds_read_b64 v[154:155], v3 offset:456
  s_waitcnt lgkmcnt(8)
  v_mfma_f32_16x16x32_bf16 v[116:119], v[40:43], v[156:159], v[116:119]
  v_mfma_f32_16x16x32_bf16 v[132:135], v[48:51], v[156:159], v[132:135]
  ds_read_b64 v[156:157], v3 offset:1600
  ds_read_b64 v[158:159], v3 offset:1608
  s_waitcnt lgkmcnt(8)
  v_mfma_f32_16x16x32_bf16 v[120:123], v[40:43], v[160:163], v[120:123]
  v_mfma_f32_16x16x32_bf16 v[136:139], v[48:51], v[160:163], v[136:139]
  ds_read_b64 v[160:161], v3 offset:2752
  ds_read_b64 v[162:163], v3 offset:2760
  s_waitcnt lgkmcnt(8)
  v_mfma_f32_16x16x32_bf16 v[140:143], v[72:75], v[144:147], v[140:143]
  ds_read_b64 v[144:145], v3 offset:3904
  ds_read_b64 v[146:147], v3 offset:3912
  s_waitcnt lgkmcnt(8)
  v_mfma_f32_16x16x32_bf16 v[124:127], v[40:43], v[148:151], v[124:127]
  v_mfma_f32_16x16x32_bf16 v[140:143], v[48:51], v[148:151], v[140:143]
  ds_read_b64 v[148:149], v3 offset:384
  ds_read_b64 v[150:151], v3 offset:392
  s_waitcnt lgkmcnt(8)
  v_mfma_f32_16x16x32_bf16 v[80:83], v[20:23], v[152:155], v[80:83]
  v_mfma_f32_16x16x32_bf16 v[96:99], v[28:31], v[152:155], v[96:99]
  v_mfma_f32_16x16x32_bf16 v[112:115], v[36:39], v[152:155], v[112:115]
  v_mfma_f32_16x16x32_bf16 v[128:131], v[44:47], v[152:155], v[128:131]
  ds_read_b64 v[152:153], v3 offset:1536
  ds_read_b64 v[154:155], v3 offset:1544
  s_waitcnt lgkmcnt(8)
  v_mfma_f32_16x16x32_bf16 v[84:87], v[20:23], v[156:159], v[84:87]
  v_mfma_f32_16x16x32_bf16 v[100:103], v[28:31], v[156:159], v[100:103]
  v_mfma_f32_16x16x32_bf16 v[116:119], v[36:39], v[156:159], v[116:119]
  v_mfma_f32_16x16x32_bf16 v[132:135], v[44:47], v[156:159], v[132:135]
  ds_read_b64 v[156:157], v3 offset:2688
  ds_read_b64 v[158:159], v3 offset:2696
  s_waitcnt lgkmcnt(8)
  v_mfma_f32_16x16x32_bf16 v[88:91], v[20:23], v[160:163], v[88:91]
  v_mfma_f32_16x16x32_bf16 v[104:107], v[28:31], v[160:163], v[104:107]
  v_mfma_f32_16x16x32_bf16 v[120:123], v[36:39], v[160:163], v[120:123]
  v_mfma_f32_16x16x32_bf16 v[136:139], v[44:47], v[160:163], v[136:139]
  ds_read_b64 v[160:161], v3 offset:3840
  ds_read_b64 v[162:163], v3 offset:3848
  s_waitcnt lgkmcnt(8)
  v_mfma_f32_16x16x32_bf16 v[92:95], v[20:23], v[144:147], v[92:95]
  v_mfma_f32_16x16x32_bf16 v[108:111], v[28:31], v[144:147], v[108:111]
  v_mfma_f32_16x16x32_bf16 v[124:127], v[36:39], v[144:147], v[124:127]
  v_mfma_f32_16x16x32_bf16 v[140:143], v[44:47], v[144:147], v[140:143]
  ds_read_b64 v[144:145], v3 offset:320
  ds_read_b64 v[146:147], v3 offset:328
  s_waitcnt lgkmcnt(8)
  v_mfma_f32_16x16x32_bf16 v[80:83], v[16:19], v[148:151], v[80:83]
  v_mfma_f32_16x16x32_bf16 v[96:99], v[24:27], v[148:151], v[96:99]
  v_mfma_f32_16x16x32_bf16 v[112:115], v[32:35], v[148:151], v[112:115]
  v_mfma_f32_16x16x32_bf16 v[128:131], v[40:43], v[148:151], v[128:131]
  ds_read_b64 v[148:149], v3 offset:1472
  ds_read_b64 v[150:151], v3 offset:1480
  s_waitcnt lgkmcnt(8)
  v_mfma_f32_16x16x32_bf16 v[84:87], v[16:19], v[152:155], v[84:87]
  v_mfma_f32_16x16x32_bf16 v[100:103], v[24:27], v[152:155], v[100:103]
  v_mfma_f32_16x16x32_bf16 v[116:119], v[32:35], v[152:155], v[116:119]
  v_mfma_f32_16x16x32_bf16 v[132:135], v[40:43], v[152:155], v[132:135]
  ds_read_b64 v[152:153], v3 offset:2624
  ds_read_b64 v[154:155], v3 offset:2632
  s_waitcnt lgkmcnt(8)
  v_mfma_f32_16x16x32_bf16 v[88:91], v[16:19], v[156:159], v[88:91]
  v_mfma_f32_16x16x32_bf16 v[104:107], v[24:27], v[156:159], v[104:107]
  v_mfma_f32_16x16x32_bf16 v[120:123], v[32:35], v[156:159], v[120:123]
  v_mfma_f32_16x16x32_bf16 v[136:139], v[40:43], v[156:159], v[136:139]
  ds_read_b64 v[156:157], v3 offset:3776
  ds_read_b64 v[158:159], v3 offset:3784
  s_waitcnt lgkmcnt(8)
  v_mfma_f32_16x16x32_bf16 v[92:95], v[16:19], v[160:163], v[92:95]
  v_mfma_f32_16x16x32_bf16 v[108:111], v[24:27], v[160:163], v[108:111]
  v_mfma_f32_16x16x32_bf16 v[124:127], v[32:35], v[160:163], v[124:127]
  v_mfma_f32_16x16x32_bf16 v[140:143], v[40:43], v[160:163], v[140:143]
  ds_read_b64 v[160:161], v3 offset:256
  ds_read_b64 v[162:163], v3 offset:264
  s_waitcnt lgkmcnt(8)
  v_mfma_f32_16x16x32_bf16 v[96:99], v[20:23], v[144:147], v[96:99]
  v_add_f32 v8, v87, v90
  v_mfma_f32_16x16x32_bf16 v[112:115], v[28:31], v[144:147], v[112:115]
  v_add_f32 v81, v81, v84
  v_mfma_f32_16x16x32_bf16 v[128:131], v[36:39], v[144:147], v[128:131]
  v_add_f32 v8, v8, v93
  ds_read_b64 v[144:145], v3 offset:1408
  ds_read_b64 v[146:147], v3 offset:1416
  s_waitcnt lgkmcnt(8)
  v_mfma_f32_16x16x32_bf16 v[100:103], v[20:23], v[148:151], v[100:103]
  v_add_f32 v82, v82, v85
  v_mfma_f32_16x16x32_bf16 v[116:119], v[28:31], v[148:151], v[116:119]
  v_add_f32 v9, v91, v94
  v_mfma_f32_16x16x32_bf16 v[132:135], v[36:39], v[148:151], v[132:135]
  ds_bpermute_b32 v10, v5, v8
  ds_read_b64 v[148:149], v3 offset:2560
  ds_read_b64 v[150:151], v3 offset:2568
  s_waitcnt lgkmcnt(9)
  v_mfma_f32_16x16x32_bf16 v[104:107], v[20:23], v[152:155], v[104:107]
  ds_bpermute_b32 v11, v5, v9
  v_mfma_f32_16x16x32_bf16 v[120:123], v[28:31], v[152:155], v[120:123]
  ds_bpermute_b32 v12, v5, v95
  v_mfma_f32_16x16x32_bf16 v[136:139], v[36:39], v[152:155], v[136:139]
  v_add_f32 v83, v83, v86
  ds_read_b64 v[152:153], v3 offset:3712
  ds_read_b64 v[154:155], v3 offset:3720
  s_waitcnt lgkmcnt(11)
  v_mfma_f32_16x16x32_bf16 v[108:111], v[20:23], v[156:159], v[108:111]
  v_add_f32 v82, v82, v88
  v_mfma_f32_16x16x32_bf16 v[124:127], v[28:31], v[156:159], v[124:127]
  v_add_f32 v83, v83, v89
  v_mfma_f32_16x16x32_bf16 v[140:143], v[36:39], v[156:159], v[140:143]
  v_add_f32 v83, v83, v92
  ds_read_b64 v[156:157], v3 offset:192
  ds_read_b64 v[158:159], v3 offset:200
  s_waitcnt lgkmcnt(11)
  v_mfma_f32_16x16x32_bf16 v[96:99], v[16:19], v[160:163], v[96:99]
  v_mfma_f32_16x16x32_bf16 v[112:115], v[24:27], v[160:163], v[112:115]
  v_mfma_f32_16x16x32_bf16 v[128:131], v[32:35], v[160:163], v[128:131]
  ds_read_b64 v[160:161], v3 offset:1344
  ds_read_b64 v[162:163], v3 offset:1352
  s_waitcnt lgkmcnt(11)
  v_mfma_f32_16x16x32_bf16 v[100:103], v[16:19], v[144:147], v[100:103]
  s_waitcnt lgkmcnt(10)
  v_cndmask_b32 v13, v10, v13, s[40:41]
  v_mfma_f32_16x16x32_bf16 v[116:119], v[24:27], v[144:147], v[116:119]
  s_waitcnt lgkmcnt(7)
  v_cndmask_b32 v14, v11, v14, s[40:41]
  v_mfma_f32_16x16x32_bf16 v[132:135], v[32:35], v[144:147], v[132:135]
  s_waitcnt lgkmcnt(6)
  v_cndmask_b32 v15, v12, v15, s[40:41]
  ds_read_b64 v[144:145], v3 offset:2496
  ds_read_b64 v[146:147], v3 offset:2504
  v_mfma_f32_16x16x32_bf16 v[104:107], v[16:19], v[148:151], v[104:107]
  v_add_f32 v80, v80, v13
  v_mfma_f32_16x16x32_bf16 v[120:123], v[24:27], v[148:151], v[120:123]
  v_add_f32 v81, v81, v14
  v_mfma_f32_16x16x32_bf16 v[136:139], v[32:35], v[148:151], v[136:139]
  v_add_f32 v82, v82, v15
  ds_read_b64 v[148:149], v3 offset:3648
  ds_read_b64 v[150:151], v3 offset:3656
  s_waitcnt lgkmcnt(8)
  v_mfma_f32_16x16x32_bf16 v[108:111], v[16:19], v[152:155], v[108:111]
  v_cvt_pk_bf16_f32 v6, v80, v81
  v_mfma_f32_16x16x32_bf16 v[124:127], v[24:27], v[152:155], v[124:127]
  v_cvt_pk_bf16_f32 v7, v82, v83
  v_mfma_f32_16x16x32_bf16 v[140:143], v[32:35], v[152:155], v[140:143]
  ds_write_b64 v4, v[6:7] offset:2304
  ds_read_b64 v[152:153], v3 offset:128
  ds_read_b64 v[154:155], v3 offset:136
  s_waitcnt lgkmcnt(9)
  v_mfma_f32_16x16x32_bf16 v[112:115], v[20:23], v[156:159], v[112:115]
  v_add_f32 v8, v103, v106
  v_mfma_f32_16x16x32_bf16 v[128:131], v[28:31], v[156:159], v[128:131]
  v_add_f32 v97, v97, v100
  ds_read_b64 v[156:157], v3 offset:1280
  ds_read_b64 v[158:159], v3 offset:1288
  s_waitcnt lgkmcnt(9)
  v_mfma_f32_16x16x32_bf16 v[116:119], v[20:23], v[160:163], v[116:119]
  v_add_f32 v8, v8, v109
  v_mfma_f32_16x16x32_bf16 v[132:135], v[28:31], v[160:163], v[132:135]
  v_add_f32 v98, v98, v101
  ds_read_b64 v[160:161], v3 offset:2432
  ds_read_b64 v[162:163], v3 offset:2440
  s_waitcnt lgkmcnt(9)
  v_mfma_f32_16x16x32_bf16 v[120:123], v[20:23], v[144:147], v[120:123]
  v_add_f32 v9, v107, v110
  v_mfma_f32_16x16x32_bf16 v[136:139], v[28:31], v[144:147], v[136:139]
  ds_bpermute_b32 v13, v5, v8
  ds_read_b64 v[144:145], v3 offset:3584
  ds_read_b64 v[146:147], v3 offset:3592
  s_waitcnt lgkmcnt(10)
  v_mfma_f32_16x16x32_bf16 v[124:127], v[20:23], v[148:151], v[124:127]
  ds_bpermute_b32 v14, v5, v9
  v_mfma_f32_16x16x32_bf16 v[140:143], v[28:31], v[148:151], v[140:143]
  ds_bpermute_b32 v15, v5, v111
  ds_read_b64 v[148:149], v3 offset:64
  ds_read_b64 v[150:151], v3 offset:72
  s_waitcnt lgkmcnt(11)
  v_mfma_f32_16x16x32_bf16 v[112:115], v[16:19], v[152:155], v[112:115]
  v_add_f32 v99, v99, v102
  v_mfma_f32_16x16x32_bf16 v[128:131], v[24:27], v[152:155], v[128:131]
  v_add_f32 v98, v98, v104
  ds_read_b64 v[152:153], v3 offset:1216
  ds_read_b64 v[154:155], v3 offset:1224
  s_waitcnt lgkmcnt(11)
  v_mfma_f32_16x16x32_bf16 v[116:119], v[16:19], v[156:159], v[116:119]
  v_add_f32 v99, v99, v105
  v_mfma_f32_16x16x32_bf16 v[132:135], v[24:27], v[156:159], v[132:135]
  v_add_f32 v99, v99, v108
  ds_read_b64 v[156:157], v3 offset:2368
  ds_read_b64 v[158:159], v3 offset:2376
  s_waitcnt lgkmcnt(11)
  v_mfma_f32_16x16x32_bf16 v[120:123], v[16:19], v[160:163], v[120:123]
  v_mfma_f32_16x16x32_bf16 v[136:139], v[24:27], v[160:163], v[136:139]
  ds_read_b64 v[160:161], v3 offset:3520
  ds_read_b64 v[162:163], v3 offset:3528
  s_waitcnt lgkmcnt(10)
  v_mfma_f32_16x16x32_bf16 v[124:127], v[16:19], v[144:147], v[124:127]
  v_mfma_f32_16x16x32_bf16 v[140:143], v[24:27], v[144:147], v[140:143]
  v_cndmask_b32 v10, v13, v10, s[40:41]
  ds_read_b64 v[144:145], v3 offset:0
  ds_read_b64 v[146:147], v3 offset:8
  s_waitcnt lgkmcnt(8)
  v_mfma_f32_16x16x32_bf16 v[128:131], v[20:23], v[148:151], v[128:131]
  v_cndmask_b32 v11, v14, v11, s[40:41]
  ds_read_b64 v[148:149], v3 offset:1152
  ds_read_b64 v[150:151], v3 offset:1160
  s_waitcnt lgkmcnt(8)
  v_mfma_f32_16x16x32_bf16 v[132:135], v[20:23], v[152:155], v[132:135]
  v_cndmask_b32 v12, v15, v12, s[40:41]
  ds_read_b64 v[152:153], v3 offset:2304
  ds_read_b64 v[154:155], v3 offset:2312
  s_waitcnt lgkmcnt(8)
  v_mfma_f32_16x16x32_bf16 v[136:139], v[20:23], v[156:159], v[136:139]
  v_add_f32 v96, v96, v10
  ds_read_b64 v[156:157], v3 offset:3456
  ds_read_b64 v[158:159], v3 offset:3464
  s_waitcnt lgkmcnt(8)
  v_mfma_f32_16x16x32_bf16 v[140:143], v[20:23], v[160:163], v[140:143]
  v_add_f32 v97, v97, v11
  s_waitcnt lgkmcnt(6)
  v_mfma_f32_16x16x32_bf16 v[128:131], v[16:19], v[144:147], v[128:131]
  v_add_f32 v98, v98, v12
  s_waitcnt lgkmcnt(4)
  v_mfma_f32_16x16x32_bf16 v[132:135], v[16:19], v[148:151], v[132:135]
  v_cvt_pk_bf16_f32 v6, v96, v97
  s_waitcnt lgkmcnt(2)
  v_mfma_f32_16x16x32_bf16 v[136:139], v[16:19], v[152:155], v[136:139]
  v_cvt_pk_bf16_f32 v7, v98, v99
  s_waitcnt lgkmcnt(0)
  v_mfma_f32_16x16x32_bf16 v[140:143], v[16:19], v[156:159], v[140:143]
  ds_write_b64 v4, v[6:7] offset:2880
  s_waitcnt lgkmcnt(0)
  s_barrier
  v_add_f32 v8, v119, v122
  v_add_f32 v113, v113, v116
  v_add_f32 v8, v8, v125
  v_add_f32 v114, v114, v117
  v_add_f32 v9, v123, v126
  ds_bpermute_b32 v10, v5, v8
  ds_bpermute_b32 v11, v5, v9
  ds_bpermute_b32 v12, v5, v127
  v_add_f32 v115, v115, v118
  v_add_f32 v114, v114, v120
  v_add_f32 v115, v115, v121
  v_add_f32 v115, v115, v124
  s_waitcnt lgkmcnt(2)
  v_cndmask_b32 v13, v10, v13, s[40:41]
  s_waitcnt lgkmcnt(1)
  v_cndmask_b32 v14, v11, v14, s[40:41]
  s_waitcnt lgkmcnt(0)
  v_cndmask_b32 v15, v12, v15, s[40:41]
  v_add_f32 v112, v112, v13
  v_add_f32 v113, v113, v14
  v_add_f32 v114, v114, v15
  v_cvt_pk_bf16_f32 v6, v112, v113
  v_cvt_pk_bf16_f32 v7, v114, v115
  ds_write_b64 v4, v[6:7] offset:3456
  v_add_f32 v8, v135, v138
  v_add_f32 v129, v129, v132
  v_add_f32 v8, v8, v141
  v_add_f32 v130, v130, v133
  v_add_f32 v9, v139, v142
  ds_bpermute_b32 v13, v5, v8
  ds_bpermute_b32 v14, v5, v9
  ds_bpermute_b32 v15, v5, v143
  v_add_f32 v131, v131, v134
  v_add_f32 v130, v130, v136
  v_add_f32 v131, v131, v137
  v_add_f32 v131, v131, v140
  s_waitcnt lgkmcnt(2)
  v_cndmask_b32 v10, v13, v10, s[40:41]
  s_waitcnt lgkmcnt(1)
  v_cndmask_b32 v11, v14, v11, s[40:41]
  s_waitcnt lgkmcnt(0)
  v_cndmask_b32 v12, v15, v12, s[40:41]
  v_add_f32 v128, v128, v10
  v_add_f32 v129, v129, v11
  v_add_f32 v130, v130, v12
  v_cvt_pk_bf16_f32 v6, v128, v129
  v_cvt_pk_bf16_f32 v7, v130, v131
  ds_write_b64 v4, v[6:7] offset:4032
  s_waitcnt lgkmcnt(0)
  s_barrier
  s_endpgm
L_BI:
  s_setprio 3
  s_waitcnt lgkmcnt(0)
  s_mov_b32 s8, s80
  s_and_b32 s9, s81, 0xffff
  s_mov_b32 s10, 2621440
  s_mov_b32 s11, 0x20000
  s_mov_b32 s12, s82
  s_and_b32 s13, s83, 0xffff
  s_mov_b32 s14, 2621440
  s_mov_b32 s15, 0x20000
  s_sub_u32 s29, s4, 8
  v_and_b32 v16, 7, v1
  v_lshrrev_b32 v17, 3, v1
  s_and_b32 s5, s3, 7
  s_mul_i32 s5, s5, 81920
  s_lshl_b32 s6, s28, 7
  s_add_u32 s5, s5, s6
  v_mul_u32_u24 v7, 1280, v1
  v_add_u32 v7, s5, v7
  s_and_b32 s5, s29, 1
  s_cmp_eq_u32 s5, 0
  s_cselect_b32 s32, s8, s12
  s_cselect_b32 s33, s9, s13
  s_mov_b32 s34, 2621440
  s_mov_b32 s35, 0x20000
  s_lshr_b32 s5, s29, 1
  s_mul_i32 s36, s5, 655360
  buffer_load_dword v14, v7, s[32:35], s36 offen
  s_lshl_b32 s6, s3, 6
  v_lshl_add_u32 v20, v16, 3, s6
  global_load_dwordx2 v[22:23], v20, s[84:85]
  s_mov_b32 s16, s94
  s_and_b32 s17, s95, 0xffff
  s_mov_b32 s18, 2621440
  s_mov_b32 s19, 0x20000
  s_add_u32 s52, s94, 4194304
  s_addc_u32 s53, s95, 0
  s_and_b32 s53, s53, 0xffff
  s_mov_b32 s54, 1310720
  s_mov_b32 s55, 0x20000
  s_mov_b32 s24, s90
  s_and_b32 s25, s91, 0xffff
  s_mov_b32 s26, 5242880
  s_mov_b32 s27, 0x20000
  v_mul_u32_u24 v18, 10240, v17
  v_lshl_add_u32 v18, v16, 1, v18
  s_mul_i32 s5, s29, 163840
  s_lshl_b32 s6, s3, 4
  s_add_u32 s5, s5, s6
  v_add_u32 v2, s5, v18
  v_mul_u32_u24 v18, 20480, v17
  v_lshl_add_u32 v18, v16, 1, v18
  s_mul_i32 s5, s29, 327680
  s_add_u32 s5, s5, s6
  s_add_u32 s5, s5, 1280
  v_add_u32 v5, s5, v18
  v_mul_u32_u24 v18, 4624, v16
  v_lshlrev_b32 v19, 2, v17
  v_sub_u32 v18, v18, v19
  s_lshl_b32 s5, s29, 6
  s_sub_u32 s5, 220, s5
  v_add_u32 v3, s5, v18
  v_mul_u32_u24 v18, 4672, v16
  v_lshl_add_u32 v18, v17, 4, v18
  s_mul_i32 s5, s29, 288
  s_add_u32 s5, s5, 70016
  v_add_u32 v4, s5, v18
  v_subrev_u32 v8, 8, v1
  v_and_b32 v8, 63, v8
  v_lshlrev_b32 v8, 2, v8
  s_mov_b64 s[42:43], 0xff
  s_mov_b32 s44, 0xffff0000
  s_lshl_b32 s5, s3, 15
  s_lshl_b32 s6, s29, 8
  s_add_u32 s5, s5, s6
  v_lshlrev_b32 v9, 12, v16
  v_lshl_add_u32 v9, v17, 4, v9
  v_add_u32 v9, s5, v9
  s_lshl_b32 s5, s3, 14
  s_add_u32 s5, s5, s6
  v_lshlrev_b32 v24, 11, v16
  v_lshl_add_u32 v24, v17, 4, v24
  v_add_u32 v165, s5, v24
  s_mov_b32 s48, 0x05040100
  s_mov_b32 s49, 0x07060302
  v_mov_b32 v15, 0
  v_and_b32 v6, 3, v1
  v_lshlrev_b32 v6, 2, v6
  v_add_u32 v6, 150400, v6
  ds_write_b32 v6, v15
  s_waitcnt vmcnt(0)
  v_lshlrev_b32 v10, 16, v22
  v_and_b32 v11, s44, v22
  v_lshlrev_b32 v12, 16, v23
  v_and_b32 v13, s44, v23
  s_waitcnt vmcnt(0)
  v_add_u32 v6, 4294963456, v2
  s_mov_b64 exec, s[42:43]
  buffer_load_short_d16_hi v48, v6, s[8:11], 0 offen offset:0
  buffer_load_short_d16_hi v49, v6, s[8:11], 0 offen offset:1280
  buffer_load_short_d16_hi v50, v6, s[8:11], 0 offen offset:2560
  s_mov_b64 exec, -1
  s_mov_b32 s45, 5120
  buffer_load_short_d16_hi v36, v2, s[8:11], s45 offen offset:0
  buffer_load_short_d16_hi v37, v2, s[8:11], s45 offen offset:1280
  buffer_load_short_d16_hi v38, v2, s[8:11], s45 offen offset:2560
  buffer_load_short_d16_hi v39, v2, s[8:11], s45 offen offset:3840
  s_mov_b32 s45, 0
  buffer_load_short_d16_hi v32, v2, s[8:11], s45 offen offset:0
  buffer_load_short_d16_hi v33, v2, s[8:11], s45 offen offset:1280
  buffer_load_short_d16_hi v34, v2, s[8:11], s45 offen offset:2560
  buffer_load_short_d16_hi v35, v2, s[8:11], s45 offen offset:3840
  s_mov_b32 s45, 0
  buffer_load_short_d16_hi v40, v2, s[12:15], s45 offen offset:0
  buffer_load_short_d16_hi v41, v2, s[12:15], s45 offen offset:1280
  buffer_load_short_d16_hi v42, v2, s[12:15], s45 offen offset:2560
  buffer_load_short_d16_hi v43, v2, s[12:15], s45 offen offset:3840
  s_mov_b32 s45, 5120
  buffer_load_short_d16_hi v44, v2, s[12:15], s45 offen offset:0
  buffer_load_short_d16_hi v45, v2, s[12:15], s45 offen offset:1280
  buffer_load_short_d16_hi v46, v2, s[12:15], s45 offen offset:2560
  buffer_load_short_d16_hi v47, v2, s[12:15], s45 offen offset:3840
  s_mov_b32 s45, 87040
  buffer_load_short_d16_hi v56, v2, s[8:11], s45 offen offset:0
  buffer_load_short_d16_hi v57, v2, s[8:11], s45 offen offset:1280
  buffer_load_short_d16_hi v58, v2, s[8:11], s45 offen offset:2560
  buffer_load_short_d16_hi v59, v2, s[8:11], s45 offen offset:3840
  s_mov_b32 s45, 81920
  buffer_load_short_d16_hi v52, v2, s[8:11], s45 offen offset:0
  buffer_load_short_d16_hi v53, v2, s[8:11], s45 offen offset:1280
  buffer_load_short_d16_hi v54, v2, s[8:11], s45 offen offset:2560
  buffer_load_short_d16_hi v55, v2, s[8:11], s45 offen offset:3840
  s_mov_b32 s45, 81920
  buffer_load_short_d16_hi v60, v2, s[12:15], s45 offen offset:0
  buffer_load_short_d16_hi v61, v2, s[12:15], s45 offen offset:1280
  buffer_load_short_d16_hi v62, v2, s[12:15], s45 offen offset:2560
  buffer_load_short_d16_hi v63, v2, s[12:15], s45 offen offset:3840
  s_mov_b32 s45, 87040
  buffer_load_short_d16_hi v64, v2, s[12:15], s45 offen offset:0
  buffer_load_short_d16_hi v65, v2, s[12:15], s45 offen offset:1280
  buffer_load_short_d16_hi v66, v2, s[12:15], s45 offen offset:2560
  buffer_load_short_d16_hi v67, v2, s[12:15], s45 offen offset:3840
  s_waitcnt vmcnt(30)
  ds_bpermute_b32 v24, v8, v37
  s_waitcnt vmcnt(29)
  ds_bpermute_b32 v25, v8, v38
  s_waitcnt vmcnt(28)
  ds_bpermute_b32 v26, v8, v39
  s_waitcnt vmcnt(24)
  v_mul_f32 v19, v35, v10
  v_mul_f32 v20, v36, v10
  v_mul_f32 v21, v37, v10
  v_mul_f32 v22, v38, v10
  v_mul_f32 v23, v39, v10
  v_fmac_f32 v19, v34, v11
  v_fmac_f32 v20, v35, v11
  v_fmac_f32 v21, v36, v11
  v_fmac_f32 v22, v37, v11
  v_fmac_f32 v23, v38, v11
  v_fmac_f32 v19, v33, v12
  v_fmac_f32 v20, v34, v12
  v_fmac_f32 v21, v35, v12
  v_fmac_f32 v22, v36, v12
  v_fmac_f32 v23, v37, v12
  v_fmac_f32 v19, v32, v13
  v_fmac_f32 v20, v33, v13
  v_fmac_f32 v21, v34, v13
  v_fmac_f32 v22, v35, v13
  v_fmac_f32 v23, v36, v13
  s_waitcnt lgkmcnt(2)
  v_mov_b32 v68, v24
  s_waitcnt lgkmcnt(1)
  v_mov_b32 v69, v25
  s_waitcnt lgkmcnt(0)
  v_mov_b32 v70, v26
  v_cndmask_b32 v24, v24, v48, s[42:43]
  v_cndmask_b32 v25, v25, v49, s[42:43]
  v_cndmask_b32 v26, v26, v50, s[42:43]
  v_mul_f32 v16, v32, v10
  v_mul_f32 v17, v33, v10
  v_mul_f32 v18, v34, v10
  v_fmac_f32 v16, v26, v11
  v_fmac_f32 v17, v32, v11
  v_fmac_f32 v18, v33, v11
  v_fmac_f32 v16, v25, v12
  v_fmac_f32 v17, v26, v12
  v_fmac_f32 v18, v32, v12
  v_fmac_f32 v16, v24, v13
  v_fmac_f32 v17, v25, v13
  v_fmac_f32 v18, v26, v13
  s_waitcnt vmcnt(23)
  v_mul_f32 v16, v16, v40
  s_waitcnt vmcnt(22)
  v_mul_f32 v17, v17, v41
  s_waitcnt vmcnt(21)
  v_mul_f32 v18, v18, v42
  s_waitcnt vmcnt(20)
  v_mul_f32 v19, v19, v43
  s_waitcnt vmcnt(19)
  v_mul_f32 v20, v20, v44
  s_waitcnt vmcnt(18)
  v_mul_f32 v21, v21, v45
  s_waitcnt vmcnt(17)
  v_mul_f32 v22, v22, v46
  s_waitcnt vmcnt(16)
  v_mul_f32 v23, v23, v47
  v_cvt_pk_bf16_f32 v24, v20, v16
  ds_write_b32 v3, v24 offset:800
  v_cvt_pk_bf16_f32 v25, v21, v17
  ds_write_b32 v3, v25 offset:1952
  v_cvt_pk_bf16_f32 v26, v22, v18
  ds_write_b32 v3, v26 offset:3104
  v_cvt_pk_bf16_f32 v27, v23, v19
  ds_write_b32 v3, v27 offset:4256
  s_waitcnt vmcnt(14)
  ds_bpermute_b32 v24, v8, v57
  s_waitcnt vmcnt(13)
  ds_bpermute_b32 v25, v8, v58
  s_waitcnt vmcnt(12)
  ds_bpermute_b32 v26, v8, v59
  s_waitcnt vmcnt(8)
  v_mul_f32 v19, v55, v10
  v_mul_f32 v20, v56, v10
  v_mul_f32 v21, v57, v10
  v_mul_f32 v22, v58, v10
  v_mul_f32 v23, v59, v10
  v_fmac_f32 v19, v54, v11
  v_fmac_f32 v20, v55, v11
  v_fmac_f32 v21, v56, v11
  v_fmac_f32 v22, v57, v11
  v_fmac_f32 v23, v58, v11
  v_fmac_f32 v19, v53, v12
  v_fmac_f32 v20, v54, v12
  v_fmac_f32 v21, v55, v12
  v_fmac_f32 v22, v56, v12
  v_fmac_f32 v23, v57, v12
  v_fmac_f32 v19, v52, v13
  v_fmac_f32 v20, v53, v13
  v_fmac_f32 v21, v54, v13
  v_fmac_f32 v22, v55, v13
  v_fmac_f32 v23, v56, v13
  s_waitcnt lgkmcnt(2)
  v_cndmask_b32 v24, v24, v68, s[42:43]
  s_waitcnt lgkmcnt(1)
  v_cndmask_b32 v25, v25, v69, s[42:43]
  s_waitcnt lgkmcnt(0)
  v_cndmask_b32 v26, v26, v70, s[42:43]
  v_mul_f32 v16, v52, v10
  v_mul_f32 v17, v53, v10
  v_mul_f32 v18, v54, v10
  v_fmac_f32 v16, v26, v11
  v_fmac_f32 v17, v52, v11
  v_fmac_f32 v18, v53, v11
  v_fmac_f32 v16, v25, v12
  v_fmac_f32 v17, v26, v12
  v_fmac_f32 v18, v52, v12
  v_fmac_f32 v16, v24, v13
  v_fmac_f32 v17, v25, v13
  v_fmac_f32 v18, v26, v13
  s_waitcnt vmcnt(7)
  v_mul_f32 v16, v16, v60
  s_waitcnt vmcnt(6)
  v_mul_f32 v17, v17, v61
  s_waitcnt vmcnt(5)
  v_mul_f32 v18, v18, v62
  s_waitcnt vmcnt(4)
  v_mul_f32 v19, v19, v63
  s_waitcnt vmcnt(3)
  v_mul_f32 v20, v20, v64
  s_waitcnt vmcnt(2)
  v_mul_f32 v21, v21, v65
  s_waitcnt vmcnt(1)
  v_mul_f32 v22, v22, v66
  s_waitcnt vmcnt(0)
  v_mul_f32 v23, v23, v67
  v_cvt_pk_bf16_f32 v24, v20, v16
  ds_write_b32 v3, v24 offset:768
  v_cvt_pk_bf16_f32 v25, v21, v17
  ds_write_b32 v3, v25 offset:1920
  v_cvt_pk_bf16_f32 v26, v22, v18
  ds_write_b32 v3, v26 offset:3072
  v_cvt_pk_bf16_f32 v27, v23, v19
  ds_write_b32 v3, v27 offset:4224
  s_waitcnt lgkmcnt(0)
  s_barrier
  v_add_u32 v6, 651520, v2
  s_mov_b64 exec, s[42:43]
  buffer_load_short_d16_hi v88, v6, s[8:11], 0 offen offset:0
  buffer_load_short_d16_hi v89, v6, s[8:11], 0 offen offset:1280
  buffer_load_short_d16_hi v90, v6, s[8:11], 0 offen offset:2560
  s_mov_b64 exec, -1
  s_mov_b32 s45, 660480
  buffer_load_short_d16_hi v76, v2, s[8:11], s45 offen offset:0
  buffer_load_short_d16_hi v77, v2, s[8:11], s45 offen offset:1280
  buffer_load_short_d16_hi v78, v2, s[8:11], s45 offen offset:2560
  buffer_load_short_d16_hi v79, v2, s[8:11], s45 offen offset:3840
  s_mov_b32 s45, 655360
  buffer_load_short_d16_hi v72, v2, s[8:11], s45 offen offset:0
  buffer_load_short_d16_hi v73, v2, s[8:11], s45 offen offset:1280
  buffer_load_short_d16_hi v74, v2, s[8:11], s45 offen offset:2560
  buffer_load_short_d16_hi v75, v2, s[8:11], s45 offen offset:3840
  s_mov_b32 s45, 655360
  buffer_load_short_d16_hi v80, v2, s[12:15], s45 offen offset:0
  buffer_load_short_d16_hi v81, v2, s[12:15], s45 offen offset:1280
  buffer_load_short_d16_hi v82, v2, s[12:15], s45 offen offset:2560
  buffer_load_short_d16_hi v83, v2, s[12:15], s45 offen offset:3840
  s_mov_b32 s45, 660480
  buffer_load_short_d16_hi v84, v2, s[12:15], s45 offen offset:0
  buffer_load_short_d16_hi v85, v2, s[12:15], s45 offen offset:1280
  buffer_load_short_d16_hi v86, v2, s[12:15], s45 offen offset:2560
  buffer_load_short_d16_hi v87, v2, s[12:15], s45 offen offset:3840
  s_mov_b32 s45, 742400
  buffer_load_short_d16_hi v96, v2, s[8:11], s45 offen offset:0
  buffer_load_short_d16_hi v97, v2, s[8:11], s45 offen offset:1280
  buffer_load_short_d16_hi v98, v2, s[8:11], s45 offen offset:2560
  buffer_load_short_d16_hi v99, v2, s[8:11], s45 offen offset:3840
  s_mov_b32 s45, 737280
  buffer_load_short_d16_hi v92, v2, s[8:11], s45 offen offset:0
  buffer_load_short_d16_hi v93, v2, s[8:11], s45 offen offset:1280
  buffer_load_short_d16_hi v94, v2, s[8:11], s45 offen offset:2560
  buffer_load_short_d16_hi v95, v2, s[8:11], s45 offen offset:3840
  s_mov_b32 s45, 737280
  buffer_load_short_d16_hi v100, v2, s[12:15], s45 offen offset:0
  buffer_load_short_d16_hi v101, v2, s[12:15], s45 offen offset:1280
  buffer_load_short_d16_hi v102, v2, s[12:15], s45 offen offset:2560
  buffer_load_short_d16_hi v103, v2, s[12:15], s45 offen offset:3840
  s_mov_b32 s45, 742400
  buffer_load_short_d16_hi v104, v2, s[12:15], s45 offen offset:0
  buffer_load_short_d16_hi v105, v2, s[12:15], s45 offen offset:1280
  buffer_load_short_d16_hi v106, v2, s[12:15], s45 offen offset:2560
  buffer_load_short_d16_hi v107, v2, s[12:15], s45 offen offset:3840
  s_waitcnt vmcnt(30)
  ds_bpermute_b32 v24, v8, v77
  s_waitcnt vmcnt(29)
  ds_bpermute_b32 v25, v8, v78
  s_waitcnt vmcnt(28)
  ds_bpermute_b32 v26, v8, v79
  s_waitcnt vmcnt(24)
  v_mul_f32 v19, v75, v10
  v_mul_f32 v20, v76, v10
  v_mul_f32 v21, v77, v10
  v_mul_f32 v22, v78, v10
  v_mul_f32 v23, v79, v10
  v_fmac_f32 v19, v74, v11
  v_fmac_f32 v20, v75, v11
  v_fmac_f32 v21, v76, v11
  v_fmac_f32 v22, v77, v11
  v_fmac_f32 v23, v78, v11
  v_fmac_f32 v19, v73, v12
  v_fmac_f32 v20, v74, v12
  v_fmac_f32 v21, v75, v12
  v_fmac_f32 v22, v76, v12
  v_fmac_f32 v23, v77, v12
  v_fmac_f32 v19, v72, v13
  v_fmac_f32 v20, v73, v13
  v_fmac_f32 v21, v74, v13
  v_fmac_f32 v22, v75, v13
  v_fmac_f32 v23, v76, v13
  s_waitcnt lgkmcnt(2)
  v_mov_b32 v108, v24
  s_waitcnt lgkmcnt(1)
  v_mov_b32 v109, v25
  s_waitcnt lgkmcnt(0)
  v_mov_b32 v110, v26
  v_cndmask_b32 v24, v24, v88, s[42:43]
  v_cndmask_b32 v25, v25, v89, s[42:43]
  v_cndmask_b32 v26, v26, v90, s[42:43]
  v_mul_f32 v16, v72, v10
  v_mul_f32 v17, v73, v10
  v_mul_f32 v18, v74, v10
  v_fmac_f32 v16, v26, v11
  v_fmac_f32 v17, v72, v11
  v_fmac_f32 v18, v73, v11
  v_fmac_f32 v16, v25, v12
  v_fmac_f32 v17, v26, v12
  v_fmac_f32 v18, v72, v12
  v_fmac_f32 v16, v24, v13
  v_fmac_f32 v17, v25, v13
  v_fmac_f32 v18, v26, v13
  s_waitcnt vmcnt(23)
  v_mul_f32 v16, v16, v80
  s_waitcnt vmcnt(22)
  v_mul_f32 v17, v17, v81
  s_waitcnt vmcnt(21)
  v_mul_f32 v18, v18, v82
  s_waitcnt vmcnt(20)
  v_mul_f32 v19, v19, v83
  s_waitcnt vmcnt(19)
  v_mul_f32 v20, v20, v84
  s_waitcnt vmcnt(18)
  v_mul_f32 v21, v21, v85
  s_waitcnt vmcnt(17)
  v_mul_f32 v22, v22, v86
  s_waitcnt vmcnt(16)
  v_mul_f32 v23, v23, v87
  v_cvt_pk_bf16_f32 v24, v20, v16
  ds_write_b32 v3, v24 offset:544
  v_cvt_pk_bf16_f32 v25, v21, v17
  ds_write_b32 v3, v25 offset:1696
  v_cvt_pk_bf16_f32 v26, v22, v18
  ds_write_b32 v3, v26 offset:2848
  v_cvt_pk_bf16_f32 v27, v23, v19
  ds_write_b32 v3, v27 offset:4000
  s_waitcnt vmcnt(14)
  ds_bpermute_b32 v24, v8, v97
  s_waitcnt vmcnt(13)
  ds_bpermute_b32 v25, v8, v98
  s_waitcnt vmcnt(12)
  ds_bpermute_b32 v26, v8, v99
  s_waitcnt vmcnt(8)
  v_mul_f32 v19, v95, v10
  v_mul_f32 v20, v96, v10
  v_mul_f32 v21, v97, v10
  v_mul_f32 v22, v98, v10
  v_mul_f32 v23, v99, v10
  v_fmac_f32 v19, v94, v11
  v_fmac_f32 v20, v95, v11
  v_fmac_f32 v21, v96, v11
  v_fmac_f32 v22, v97, v11
  v_fmac_f32 v23, v98, v11
  v_fmac_f32 v19, v93, v12
  v_fmac_f32 v20, v94, v12
  v_fmac_f32 v21, v95, v12
  v_fmac_f32 v22, v96, v12
  v_fmac_f32 v23, v97, v12
  v_fmac_f32 v19, v92, v13
  v_fmac_f32 v20, v93, v13
  v_fmac_f32 v21, v94, v13
  v_fmac_f32 v22, v95, v13
  v_fmac_f32 v23, v96, v13
  s_waitcnt lgkmcnt(2)
  v_cndmask_b32 v24, v24, v108, s[42:43]
  s_waitcnt lgkmcnt(1)
  v_cndmask_b32 v25, v25, v109, s[42:43]
  s_waitcnt lgkmcnt(0)
  v_cndmask_b32 v26, v26, v110, s[42:43]
  v_mul_f32 v16, v92, v10
  v_mul_f32 v17, v93, v10
  v_mul_f32 v18, v94, v10
  v_fmac_f32 v16, v26, v11
  v_fmac_f32 v17, v92, v11
  v_fmac_f32 v18, v93, v11
  v_fmac_f32 v16, v25, v12
  v_fmac_f32 v17, v26, v12
  v_fmac_f32 v18, v92, v12
  v_fmac_f32 v16, v24, v13
  v_fmac_f32 v17, v25, v13
  v_fmac_f32 v18, v26, v13
  s_waitcnt vmcnt(7)
  v_mul_f32 v16, v16, v100
  s_waitcnt vmcnt(6)
  v_mul_f32 v17, v17, v101
  s_waitcnt vmcnt(5)
  v_mul_f32 v18, v18, v102
  s_waitcnt vmcnt(4)
  v_mul_f32 v19, v19, v103
  s_waitcnt vmcnt(3)
  v_mul_f32 v20, v20, v104
  s_waitcnt vmcnt(2)
  v_mul_f32 v21, v21, v105
  s_waitcnt vmcnt(1)
  v_mul_f32 v22, v22, v106
  s_waitcnt vmcnt(0)
  v_mul_f32 v23, v23, v107
  v_cvt_pk_bf16_f32 v24, v20, v16
  ds_write_b32 v3, v24 offset:512
  v_cvt_pk_bf16_f32 v25, v21, v17
  ds_write_b32 v3, v25 offset:1664
  v_cvt_pk_bf16_f32 v26, v22, v18
  ds_write_b32 v3, v26 offset:2816
  v_cvt_pk_bf16_f32 v27, v23, v19
  ds_write_b32 v3, v27 offset:3968
  s_waitcnt lgkmcnt(0)
  s_barrier
  s_cmp_eq_u32 s29, 0
  s_cbranch_scc0 L_ldsK
  s_mov_b32 s39, 200000
  v_mov_b32 v14, 0
L_nonce:
  global_load_dword v15, v14, s[92:93] offset:252 sc1
  s_waitcnt vmcnt(0)
  v_readfirstlane_b32 s59, v15
  s_sub_u32 s39, s39, 1
  s_cmp_eq_u32 s39, 0
  s_cbranch_scc1 L_nonced
  s_nop 0
  s_cmp_lg_u32 s59, 0
  s_cbranch_scc1 L_nonced
  s_sleep 8
  s_branch L_nonce
L_nonced:
  s_mov_b32 s39, 400000
  s_lshl_b32 s5, s28, 7
  s_add_u32 s5, s5, 6291456
  v_mov_b32 v14, s5
L_pollK:
  global_load_dwordx4 v[16:19], v14, s[94:95] sc1
  global_load_dwordx4 v[20:23], v14, s[94:95] offset:16 sc1
  s_waitcnt vmcnt(0)
  s_sub_u32 s39, s39, 1
  s_cmp_eq_u32 s39, 0
  s_cbranch_scc1 L_polledK
  v_readfirstlane_b32 s5, v16
  s_nop 3
  s_cmp_eq_u32 s5, s59
  s_cbranch_scc0 L_againK
  v_readfirstlane_b32 s5, v17
  s_nop 3
  s_cmp_eq_u32 s5, s59
  s_cbranch_scc0 L_againK
  v_readfirstlane_b32 s5, v18
  s_nop 3
  s_cmp_eq_u32 s5, s59
  s_cbranch_scc0 L_againK
  v_readfirstlane_b32 s5, v19
  s_nop 3
  s_cmp_eq_u32 s5, s59
  s_cbranch_scc0 L_againK
  v_readfirstlane_b32 s5, v20
  s_nop 3
  s_cmp_eq_u32 s5, s59
  s_cbranch_scc0 L_againK
  v_readfirstlane_b32 s5, v21
  s_nop 3
  s_cmp_eq_u32 s5, s59
  s_cbranch_scc0 L_againK
  s_branch L_polledK
L_againK:
  s_sleep 2
  s_branch L_pollK
L_polledK:
  v_mov_b32 v14, 150400
  v_mov_b32 v15, 1
  ds_write_b32 v14, v15
  s_branch L_goK
L_ldsK:
  s_mov_b32 s39, 4000000
  v_mov_b32 v14, 150400
L_ldswK:
  ds_read_b32 v15, v14
  s_waitcnt lgkmcnt(0)
  v_readfirstlane_b32 s5, v15
  s_sub_u32 s39, s39, 1
  s_cmp_eq_u32 s39, 0
  s_cbranch_scc1 L_goK
  s_nop 0
  s_cmp_eq_u32 s5, 1
  s_cbranch_scc1 L_goK
  s_sleep 1
  s_branch L_ldswK
L_goK:
  s_waitcnt vmcnt(0) lgkmcnt(0)
  v_mov_b32 v6, v165
  buffer_load_dwordx4 v[32:35], v6, s[52:55], 0 offen offset:0 sc1
  buffer_load_dwordx4 v[36:39], v6, s[52:55], 0 offen offset:128 sc1
  buffer_load_dwordx4 v[40:43], v6, s[52:55], 0 offen offset:1024 sc1
  buffer_load_dwordx4 v[44:47], v6, s[52:55], 0 offen offset:1152 sc1
  buffer_load_dwordx4 v[112:115], v9, s[16:19], 0 offen offset:0 sc1
  buffer_load_dwordx4 v[116:119], v9, s[16:19], 0 offen offset:128 sc1
  buffer_load_dwordx4 v[120:123], v9, s[16:19], 0 offen offset:1024 sc1
  buffer_load_dwordx4 v[124:127], v9, s[16:19], 0 offen offset:1152 sc1
  s_waitcnt vmcnt(7)
  v_perm_b32 v16, v32, v34, s48
  v_perm_b32 v17, v32, v34, s49
  v_perm_b32 v18, v33, v35, s48
  v_perm_b32 v19, v33, v35, s49
  ds_write_b32 v3, v16 offset:288
  ds_write_b32 v3, v17 offset:1440
  ds_write_b32 v3, v18 offset:2592
  ds_write_b32 v3, v19 offset:3744
  s_waitcnt vmcnt(6)
  v_perm_b32 v20, v36, v38, s48
  v_perm_b32 v21, v36, v38, s49
  v_perm_b32 v22, v37, v39, s48
  v_perm_b32 v23, v37, v39, s49
  ds_write_b32 v3, v20 offset:256
  ds_write_b32 v3, v21 offset:1408
  ds_write_b32 v3, v22 offset:2560
  ds_write_b32 v3, v23 offset:3712
  s_waitcnt vmcnt(5)
  v_perm_b32 v16, v40, v42, s48
  v_perm_b32 v17, v40, v42, s49
  v_perm_b32 v18, v41, v43, s48
  v_perm_b32 v19, v41, v43, s49
  ds_write_b32 v3, v16 offset:32
  ds_write_b32 v3, v17 offset:1184
  ds_write_b32 v3, v18 offset:2336
  ds_write_b32 v3, v19 offset:3488
  s_waitcnt vmcnt(4)
  v_perm_b32 v20, v44, v46, s48
  v_perm_b32 v21, v44, v46, s49
  v_perm_b32 v22, v45, v47, s48
  v_perm_b32 v23, v45, v47, s49
  ds_write_b32 v3, v20 offset:0
  ds_write_b32 v3, v21 offset:1152
  ds_write_b32 v3, v22 offset:2304
  ds_write_b32 v3, v23 offset:3456
  s_waitcnt lgkmcnt(0)
  s_barrier
  ds_read_b128 v[144:147], v4 offset:0
  ds_read_b128 v[148:151], v4 offset:144
  s_waitcnt lgkmcnt(1)
  v_lshlrev_b32 v152, 16, v144
  v_and_b32 v153, s44, v144
  s_waitcnt vmcnt(3)
  v_lshlrev_b32 v156, 16, v112
  v_and_b32 v157, s44, v112
  v_lshlrev_b32 v154, 16, v145
  v_and_b32 v155, s44, v145
  v_lshlrev_b32 v158, 16, v113
  v_and_b32 v159, s44, v113
  v_mul_f32 v152, v152, v156
  v_mul_f32 v153, v153, v157
  v_mul_f32 v154, v154, v158
  v_mul_f32 v155, v155, v159
  v_cvt_pk_bf16_f32 v160, v152, v153
  v_cvt_pk_bf16_f32 v161, v154, v155
  v_lshlrev_b32 v152, 16, v146
  v_and_b32 v153, s44, v146
  v_lshlrev_b32 v156, 16, v114
  v_and_b32 v157, s44, v114
  v_lshlrev_b32 v154, 16, v147
  v_and_b32 v155, s44, v147
  v_lshlrev_b32 v158, 16, v115
  v_and_b32 v159, s44, v115
  v_mul_f32 v152, v152, v156
  v_mul_f32 v153, v153, v157
  v_mul_f32 v154, v154, v158
  v_mul_f32 v155, v155, v159
  v_cvt_pk_bf16_f32 v162, v152, v153
  v_cvt_pk_bf16_f32 v163, v154, v155
  s_mov_b32 s46, 0
  buffer_store_short v160, v5, s[24:27], s46 offen nt
  buffer_store_short_d16_hi v160, v5, s[24:27], s46 offen offset:2560 nt
  s_mov_b32 s46, 5120
  buffer_store_short v161, v5, s[24:27], s46 offen nt
  buffer_store_short_d16_hi v161, v5, s[24:27], s46 offen offset:2560 nt
  s_mov_b32 s46, 10240
  buffer_store_short v162, v5, s[24:27], s46 offen nt
  buffer_store_short_d16_hi v162, v5, s[24:27], s46 offen offset:2560 nt
  s_mov_b32 s46, 15360
  buffer_store_short v163, v5, s[24:27], s46 offen nt
  buffer_store_short_d16_hi v163, v5, s[24:27], s46 offen offset:2560 nt
  s_waitcnt lgkmcnt(0)
  v_lshlrev_b32 v152, 16, v148
  v_and_b32 v153, s44, v148
  s_waitcnt vmcnt(10)
  v_lshlrev_b32 v156, 16, v116
  v_and_b32 v157, s44, v116
  v_lshlrev_b32 v154, 16, v149
  v_and_b32 v155, s44, v149
  v_lshlrev_b32 v158, 16, v117
  v_and_b32 v159, s44, v117
  v_mul_f32 v152, v152, v156
  v_mul_f32 v153, v153, v157
  v_mul_f32 v154, v154, v158
  v_mul_f32 v155, v155, v159
  v_cvt_pk_bf16_f32 v160, v152, v153
  v_cvt_pk_bf16_f32 v161, v154, v155
  v_lshlrev_b32 v152, 16, v150
  v_and_b32 v153, s44, v150
  v_lshlrev_b32 v156, 16, v118
  v_and_b32 v157, s44, v118
  v_lshlrev_b32 v154, 16, v151
  v_and_b32 v155, s44, v151
  v_lshlrev_b32 v158, 16, v119
  v_and_b32 v159, s44, v119
  v_mul_f32 v152, v152, v156
  v_mul_f32 v153, v153, v157
  v_mul_f32 v154, v154, v158
  v_mul_f32 v155, v155, v159
  v_cvt_pk_bf16_f32 v162, v152, v153
  v_cvt_pk_bf16_f32 v163, v154, v155
  s_mov_b32 s46, 163840
  buffer_store_short v160, v5, s[24:27], s46 offen nt
  buffer_store_short_d16_hi v160, v5, s[24:27], s46 offen offset:2560 nt
  s_mov_b32 s46, 168960
  buffer_store_short v161, v5, s[24:27], s46 offen nt
  buffer_store_short_d16_hi v161, v5, s[24:27], s46 offen offset:2560 nt
  s_mov_b32 s46, 174080
  buffer_store_short v162, v5, s[24:27], s46 offen nt
  buffer_store_short_d16_hi v162, v5, s[24:27], s46 offen offset:2560 nt
  s_mov_b32 s46, 179200
  buffer_store_short v163, v5, s[24:27], s46 offen nt
  buffer_store_short_d16_hi v163, v5, s[24:27], s46 offen offset:2560 nt
  s_cmp_eq_u32 s29, 0
  s_cbranch_scc0 L_ldsQ1
  s_mov_b32 s39, 400000
  s_lshl_b32 s5, s28, 7
  s_add_u32 s5, s5, 6291456
  v_mov_b32 v14, s5
L_pollQ1:
  global_load_dwordx4 v[16:19], v14, s[94:95] sc1
  global_load_dwordx4 v[20:23], v14, s[94:95] offset:16 sc1
  s_waitcnt vmcnt(0)
  s_sub_u32 s39, s39, 1
  s_cmp_eq_u32 s39, 0
  s_cbranch_scc1 L_polledQ1
  v_readfirstlane_b32 s5, v22
  s_nop 3
  s_cmp_eq_u32 s5, s59
  s_cbranch_scc0 L_againQ1
  v_readfirstlane_b32 s5, v23
  s_nop 3
  s_cmp_eq_u32 s5, s59
  s_cbranch_scc0 L_againQ1
  s_branch L_polledQ1
L_againQ1:
  s_sleep 2
  s_branch L_pollQ1
L_polledQ1:
  v_mov_b32 v14, 150404
  v_mov_b32 v15, 1
  ds_write_b32 v14, v15
  s_branch L_goQ1
L_ldsQ1:
  s_mov_b32 s39, 4000000
  v_mov_b32 v14, 150404
L_ldswQ1:
  ds_read_b32 v15, v14
  s_waitcnt lgkmcnt(0)
  v_readfirstlane_b32 s5, v15
  s_sub_u32 s39, s39, 1
  s_cmp_eq_u32 s39, 0
  s_cbranch_scc1 L_goQ1
  s_nop 0
  s_cmp_eq_u32 s5, 1
  s_cbranch_scc1 L_goQ1
  s_sleep 1
  s_branch L_ldswQ1
L_goQ1:
  s_waitcnt vmcnt(0) lgkmcnt(0)
  buffer_load_dwordx4 v[128:131], v9, s[16:19], 0 offen offset:2048 sc1
  buffer_load_dwordx4 v[132:135], v9, s[16:19], 0 offen offset:2176 sc1
  buffer_load_dwordx4 v[136:139], v9, s[16:19], 0 offen offset:3072 sc1
  buffer_load_dwordx4 v[140:143], v9, s[16:19], 0 offen offset:3200 sc1
  ds_read_b128 v[144:147], v4 offset:1152
  ds_read_b128 v[148:151], v4 offset:1296
  s_waitcnt lgkmcnt(1)
  v_lshlrev_b32 v152, 16, v144
  v_and_b32 v153, s44, v144
  v_lshlrev_b32 v156, 16, v120
  v_and_b32 v157, s44, v120
  v_lshlrev_b32 v154, 16, v145
  v_and_b32 v155, s44, v145
  v_lshlrev_b32 v158, 16, v121
  v_and_b32 v159, s44, v121
  v_mul_f32 v152, v152, v156
  v_mul_f32 v153, v153, v157
  v_mul_f32 v154, v154, v158
  v_mul_f32 v155, v155, v159
  v_cvt_pk_bf16_f32 v160, v152, v153
  v_cvt_pk_bf16_f32 v161, v154, v155
  v_lshlrev_b32 v152, 16, v146
  v_and_b32 v153, s44, v146
  v_lshlrev_b32 v156, 16, v122
  v_and_b32 v157, s44, v122
  v_lshlrev_b32 v154, 16, v147
  v_and_b32 v155, s44, v147
  v_lshlrev_b32 v158, 16, v123
  v_and_b32 v159, s44, v123
  v_mul_f32 v152, v152, v156
  v_mul_f32 v153, v153, v157
  v_mul_f32 v154, v154, v158
  v_mul_f32 v155, v155, v159
  v_cvt_pk_bf16_f32 v162, v152, v153
  v_cvt_pk_bf16_f32 v163, v154, v155
  s_mov_b32 s46, 1310720
  buffer_store_short v160, v5, s[24:27], s46 offen nt
  buffer_store_short_d16_hi v160, v5, s[24:27], s46 offen offset:2560 nt
  s_mov_b32 s46, 1315840
  buffer_store_short v161, v5, s[24:27], s46 offen nt
  buffer_store_short_d16_hi v161, v5, s[24:27], s46 offen offset:2560 nt
  s_mov_b32 s46, 1320960
  buffer_store_short v162, v5, s[24:27], s46 offen nt
  buffer_store_short_d16_hi v162, v5, s[24:27], s46 offen offset:2560 nt
  s_mov_b32 s46, 1326080
  buffer_store_short v163, v5, s[24:27], s46 offen nt
  buffer_store_short_d16_hi v163, v5, s[24:27], s46 offen offset:2560 nt
  s_waitcnt lgkmcnt(0)
  v_lshlrev_b32 v152, 16, v148
  v_and_b32 v153, s44, v148
  v_lshlrev_b32 v156, 16, v124
  v_and_b32 v157, s44, v124
  v_lshlrev_b32 v154, 16, v149
  v_and_b32 v155, s44, v149
  v_lshlrev_b32 v158, 16, v125
  v_and_b32 v159, s44, v125
  v_mul_f32 v152, v152, v156
  v_mul_f32 v153, v153, v157
  v_mul_f32 v154, v154, v158
  v_mul_f32 v155, v155, v159
  v_cvt_pk_bf16_f32 v160, v152, v153
  v_cvt_pk_bf16_f32 v161, v154, v155
  v_lshlrev_b32 v152, 16, v150
  v_and_b32 v153, s44, v150
  v_lshlrev_b32 v156, 16, v126
  v_and_b32 v157, s44, v126
  v_lshlrev_b32 v154, 16, v151
  v_and_b32 v155, s44, v151
  v_lshlrev_b32 v158, 16, v127
  v_and_b32 v159, s44, v127
  v_mul_f32 v152, v152, v156
  v_mul_f32 v153, v153, v157
  v_mul_f32 v154, v154, v158
  v_mul_f32 v155, v155, v159
  v_cvt_pk_bf16_f32 v162, v152, v153
  v_cvt_pk_bf16_f32 v163, v154, v155
  s_mov_b32 s46, 1474560
  buffer_store_short v160, v5, s[24:27], s46 offen nt
  buffer_store_short_d16_hi v160, v5, s[24:27], s46 offen offset:2560 nt
  s_mov_b32 s46, 1479680
  buffer_store_short v161, v5, s[24:27], s46 offen nt
  buffer_store_short_d16_hi v161, v5, s[24:27], s46 offen offset:2560 nt
  s_mov_b32 s46, 1484800
  buffer_store_short v162, v5, s[24:27], s46 offen nt
  buffer_store_short_d16_hi v162, v5, s[24:27], s46 offen offset:2560 nt
  s_mov_b32 s46, 1489920
  buffer_store_short v163, v5, s[24:27], s46 offen nt
  buffer_store_short_d16_hi v163, v5, s[24:27], s46 offen offset:2560 nt
  s_waitcnt lgkmcnt(0)
  s_barrier
  ds_read_b128 v[144:147], v4 offset:2304
  ds_read_b128 v[148:151], v4 offset:2448
  s_waitcnt lgkmcnt(1)
  v_lshlrev_b32 v152, 16, v144
  v_and_b32 v153, s44, v144
  s_waitcnt vmcnt(19)
  v_lshlrev_b32 v156, 16, v128
  v_and_b32 v157, s44, v128
  v_lshlrev_b32 v154, 16, v145
  v_and_b32 v155, s44, v145
  v_lshlrev_b32 v158, 16, v129
  v_and_b32 v159, s44, v129
  v_mul_f32 v152, v152, v156
  v_mul_f32 v153, v153, v157
  v_mul_f32 v154, v154, v158
  v_mul_f32 v155, v155, v159
  v_cvt_pk_bf16_f32 v160, v152, v153
  v_cvt_pk_bf16_f32 v161, v154, v155
  v_lshlrev_b32 v152, 16, v146
  v_and_b32 v153, s44, v146
  v_lshlrev_b32 v156, 16, v130
  v_and_b32 v157, s44, v130
  v_lshlrev_b32 v154, 16, v147
  v_and_b32 v155, s44, v147
  v_lshlrev_b32 v158, 16, v131
  v_and_b32 v159, s44, v131
  v_mul_f32 v152, v152, v156
  v_mul_f32 v153, v153, v157
  v_mul_f32 v154, v154, v158
  v_mul_f32 v155, v155, v159
  v_cvt_pk_bf16_f32 v162, v152, v153
  v_cvt_pk_bf16_f32 v163, v154, v155
  s_mov_b32 s46, 2621440
  buffer_store_short v160, v5, s[24:27], s46 offen nt
  buffer_store_short_d16_hi v160, v5, s[24:27], s46 offen offset:2560 nt
  s_mov_b32 s46, 2626560
  buffer_store_short v161, v5, s[24:27], s46 offen nt
  buffer_store_short_d16_hi v161, v5, s[24:27], s46 offen offset:2560 nt
  s_mov_b32 s46, 2631680
  buffer_store_short v162, v5, s[24:27], s46 offen nt
  buffer_store_short_d16_hi v162, v5, s[24:27], s46 offen offset:2560 nt
  s_mov_b32 s46, 2636800
  buffer_store_short v163, v5, s[24:27], s46 offen nt
  buffer_store_short_d16_hi v163, v5, s[24:27], s46 offen offset:2560 nt
  s_waitcnt lgkmcnt(0)
  v_lshlrev_b32 v152, 16, v148
  v_and_b32 v153, s44, v148
  s_waitcnt vmcnt(26)
  v_lshlrev_b32 v156, 16, v132
  v_and_b32 v157, s44, v132
  v_lshlrev_b32 v154, 16, v149
  v_and_b32 v155, s44, v149
  v_lshlrev_b32 v158, 16, v133
  v_and_b32 v159, s44, v133
  v_mul_f32 v152, v152, v156
  v_mul_f32 v153, v153, v157
  v_mul_f32 v154, v154, v158
  v_mul_f32 v155, v155, v159
  v_cvt_pk_bf16_f32 v160, v152, v153
  v_cvt_pk_bf16_f32 v161, v154, v155
  v_lshlrev_b32 v152, 16, v150
  v_and_b32 v153, s44, v150
  v_lshlrev_b32 v156, 16, v134
  v_and_b32 v157, s44, v134
  v_lshlrev_b32 v154, 16, v151
  v_and_b32 v155, s44, v151
  v_lshlrev_b32 v158, 16, v135
  v_and_b32 v159, s44, v135
  v_mul_f32 v152, v152, v156
  v_mul_f32 v153, v153, v157
  v_mul_f32 v154, v154, v158
  v_mul_f32 v155, v155, v159
  v_cvt_pk_bf16_f32 v162, v152, v153
  v_cvt_pk_bf16_f32 v163, v154, v155
  s_mov_b32 s46, 2785280
  buffer_store_short v160, v5, s[24:27], s46 offen nt
  buffer_store_short_d16_hi v160, v5, s[24:27], s46 offen offset:2560 nt
  s_mov_b32 s46, 2790400
  buffer_store_short v161, v5, s[24:27], s46 offen nt
  buffer_store_short_d16_hi v161, v5, s[24:27], s46 offen offset:2560 nt
  s_mov_b32 s46, 2795520
  buffer_store_short v162, v5, s[24:27], s46 offen nt
  buffer_store_short_d16_hi v162, v5, s[24:27], s46 offen offset:2560 nt
  s_mov_b32 s46, 2800640
  buffer_store_short v163, v5, s[24:27], s46 offen nt
  buffer_store_short_d16_hi v163, v5, s[24:27], s46 offen offset:2560 nt
  s_waitcnt lgkmcnt(0)
  s_barrier
  ds_read_b128 v[144:147], v4 offset:3456
  ds_read_b128 v[148:151], v4 offset:3600
  s_waitcnt lgkmcnt(1)
  v_lshlrev_b32 v152, 16, v144
  v_and_b32 v153, s44, v144
  s_waitcnt vmcnt(33)
  v_lshlrev_b32 v156, 16, v136
  v_and_b32 v157, s44, v136
  v_lshlrev_b32 v154, 16, v145
  v_and_b32 v155, s44, v145
  v_lshlrev_b32 v158, 16, v137
  v_and_b32 v159, s44, v137
  v_mul_f32 v152, v152, v156
  v_mul_f32 v153, v153, v157
  v_mul_f32 v154, v154, v158
  v_mul_f32 v155, v155, v159
  v_cvt_pk_bf16_f32 v160, v152, v153
  v_cvt_pk_bf16_f32 v161, v154, v155
  v_lshlrev_b32 v152, 16, v146
  v_and_b32 v153, s44, v146
  v_lshlrev_b32 v156, 16, v138
  v_and_b32 v157, s44, v138
  v_lshlrev_b32 v154, 16, v147
  v_and_b32 v155, s44, v147
  v_lshlrev_b32 v158, 16, v139
  v_and_b32 v159, s44, v139
  v_mul_f32 v152, v152, v156
  v_mul_f32 v153, v153, v157
  v_mul_f32 v154, v154, v158
  v_mul_f32 v155, v155, v159
  v_cvt_pk_bf16_f32 v162, v152, v153
  v_cvt_pk_bf16_f32 v163, v154, v155
  s_mov_b32 s46, 3932160
  buffer_store_short v160, v5, s[24:27], s46 offen nt
  buffer_store_short_d16_hi v160, v5, s[24:27], s46 offen offset:2560 nt
  s_mov_b32 s46, 3937280
  buffer_store_short v161, v5, s[24:27], s46 offen nt
  buffer_store_short_d16_hi v161, v5, s[24:27], s46 offen offset:2560 nt
  s_mov_b32 s46, 3942400
  buffer_store_short v162, v5, s[24:27], s46 offen nt
  buffer_store_short_d16_hi v162, v5, s[24:27], s46 offen offset:2560 nt
  s_mov_b32 s46, 3947520
  buffer_store_short v163, v5, s[24:27], s46 offen nt
  buffer_store_short_d16_hi v163, v5, s[24:27], s46 offen offset:2560 nt
  s_waitcnt lgkmcnt(0)
  v_lshlrev_b32 v152, 16, v148
  v_and_b32 v153, s44, v148
  s_waitcnt vmcnt(40)
  v_lshlrev_b32 v156, 16, v140
  v_and_b32 v157, s44, v140
  v_lshlrev_b32 v154, 16, v149
  v_and_b32 v155, s44, v149
  v_lshlrev_b32 v158, 16, v141
  v_and_b32 v159, s44, v141
  v_mul_f32 v152, v152, v156
  v_mul_f32 v153, v153, v157
  v_mul_f32 v154, v154, v158
  v_mul_f32 v155, v155, v159
  v_cvt_pk_bf16_f32 v160, v152, v153
  v_cvt_pk_bf16_f32 v161, v154, v155
  v_lshlrev_b32 v152, 16, v150
  v_and_b32 v153, s44, v150
  v_lshlrev_b32 v156, 16, v142
  v_and_b32 v157, s44, v142
  v_lshlrev_b32 v154, 16, v151
  v_and_b32 v155, s44, v151
  v_lshlrev_b32 v158, 16, v143
  v_and_b32 v159, s44, v143
  v_mul_f32 v152, v152, v156
  v_mul_f32 v153, v153, v157
  v_mul_f32 v154, v154, v158
  v_mul_f32 v155, v155, v159
  v_cvt_pk_bf16_f32 v162, v152, v153
  v_cvt_pk_bf16_f32 v163, v154, v155
  s_mov_b32 s46, 4096000
  buffer_store_short v160, v5, s[24:27], s46 offen nt
  buffer_store_short_d16_hi v160, v5, s[24:27], s46 offen offset:2560 nt
  s_mov_b32 s46, 4101120
  buffer_store_short v161, v5, s[24:27], s46 offen nt
  buffer_store_short_d16_hi v161, v5, s[24:27], s46 offen offset:2560 nt
  s_mov_b32 s46, 4106240
  buffer_store_short v162, v5, s[24:27], s46 offen nt
  buffer_store_short_d16_hi v162, v5, s[24:27], s46 offen offset:2560 nt
  s_mov_b32 s46, 4111360
  buffer_store_short v163, v5, s[24:27], s46 offen nt
  buffer_store_short_d16_hi v163, v5, s[24:27], s46 offen offset:2560 nt
  s_endpgm
L_H:
  s_cmp_ge_u32 s4, 9
  s_cbranch_scc1 L_exit
  s_cmp_eq_u32 s4, 8
  s_cbranch_scc1 L_HN
  s_lshl_b32 s7, s5, 3
  s_mul_i32 s34, s5, 12
  s_sub_u32 s34, s34, 16
  s_cmp_lt_u32 s5, 4
  s_cselect_b32 s7, s7, s34
  s_add_u32 s7, s7, s6
  s_cmp_ge_u32 s7, 20
  s_cselect_b32 s35, 20, 0
  s_cmp_ge_u32 s7, 60
  s_cselect_b32 s35, 40, s35
  s_sub_u32 s34, s7, s35
  s_mul_hi_u32 s38, s34, 0x1999999a
  s_mul_i32 s35, s38, 10
  s_sub_u32 s28, s34, s35
  s_waitcnt lgkmcnt(0)
  s_cmp_lt_u32 s7, 20
  s_cbranch_scc1 L_HQ
  s_cmp_ge_u32 s7, 60
  s_cbranch_scc1 L_HQ
  s_mov_b32 s8, s80
  s_and_b32 s9, s81, 0xffff
  s_mov_b32 s10, 2621440
  s_mov_b32 s11, 0x20000
  s_mov_b32 s12, s82
  s_and_b32 s13, s83, 0xffff
  s_mov_b32 s14, 2621440
  s_mov_b32 s15, 0x20000
  v_lshrrev_b32 v2, 3, v1
  v_and_b32 v3, 7, v1
  v_and_b32 v4, 15, v1
  v_lshrrev_b32 v5, 4, v1
  v_lshrrev_b32 v6, 2, v4
  v_and_b32 v7, 3, v4
  s_lshl_b32 s5, s28, 9
  s_and_b32 s6, s4, 1
  s_lshl_b32 s6, s6, 8
  s_add_u32 s5, s5, s6
  v_lshl_add_u32 v12, v4, 3, s5
  global_load_dwordx2 v[52:53], v12, s[84:85] offset:0
  global_load_dwordx2 v[54:55], v12, s[84:85] offset:128
  s_mul_i32 s5, s4, 40960
  s_lshl_b32 s6, s28, 7
  s_add_u32 s5, s5, s6
  v_mul_u32_u24 v8, 1280, v2
  v_lshl_add_u32 v8, v3, 4, v8
  v_add_u32 v8, s5, v8
  s_mul_i32 s46, s38, 327680
  s_add_u32 s45, s46, 1300480
  buffer_load_dwordx4 v[16:19], v8, s[8:11], s45 offen
  s_add_u32 s45, s45, 10240
  buffer_load_dwordx4 v[20:23], v8, s[8:11], s45 offen
  s_add_u32 s45, s45, 10240
  buffer_load_dwordx4 v[24:27], v8, s[8:11], s45 offen
  s_add_u32 s45, s45, 10240
  buffer_load_dwordx4 v[28:31], v8, s[8:11], s45 offen
  s_add_u32 s45, s45, 10240
  s_add_u32 s45, s46, 1628160
  buffer_load_dwordx4 v[32:35], v8, s[8:11], s45 offen
  s_add_u32 s45, s46, 1310720
  buffer_load_dwordx4 v[36:39], v8, s[12:15], s45 offen
  s_add_u32 s45, s45, 10240
  buffer_load_dwordx4 v[40:43], v8, s[12:15], s45 offen
  s_add_u32 s45, s45, 10240
  buffer_load_dwordx4 v[44:47], v8, s[12:15], s45 offen
  s_add_u32 s45, s45, 10240
  buffer_load_dwordx4 v[48:51], v8, s[12:15], s45 offen
  s_add_u32 s52, s94, 4194304
  s_addc_u32 s53, s95, 0
  s_and_b32 s53, s53, 0xffff
  s_mov_b32 s54, 1310720
  s_mov_b32 s55, 0x20000
  s_mov_b32 s44, 0xffff0000
  s_mul_i32 s5, s4, 4608
  v_mul_u32_u24 v9, 144, v2
  v_lshl_add_u32 v9, v3, 4, v9
  v_add_u32 v9, s5, v9
  s_lshr_b32 s5, s4, 1
  s_and_b32 s6, s4, 1
  s_mul_i32 s7, s5, 9216
  s_lshl_b32 s29, s6, 6
  s_add_u32 s7, s7, s29
  v_lshl_add_u32 v10, v5, 3, v6
  v_mul_u32_u24 v10, 144, v10
  v_lshl_add_u32 v10, v7, 3, v10
  v_add_u32 v10, s7, v10
  s_lshl_b32 s7, s28, 17
  s_lshl_b32 s29, s6, 16
  s_add_u32 s7, s7, s29
  s_lshl_b32 s29, s38, 9
  s_add_u32 s7, s7, s29
  s_lshl_b32 s29, s5, 7
  s_add_u32 s7, s7, s29
  v_lshlrev_b32 v11, 11, v2
  v_lshl_add_u32 v11, v3, 4, v11
  v_add_u32 v11, s7, v11
  s_mul_i32 s7, s4, 4608
  s_add_u32 s7, s7, 76032
  v_mul_u32_u24 v14, 144, v4
  v_lshl_add_u32 v14, v5, 4, v14
  v_add_u32 v14, s7, v14
  v_mul_u32_u24 v15, 144, v2
  v_lshl_add_u32 v15, v3, 4, v15
  v_add_u32 v15, s7, v15
  s_waitcnt vmcnt(8)
  ds_write_b128 v9, v[16:19] offset:0
  s_waitcnt vmcnt(7)
  ds_write_b128 v9, v[20:23] offset:1152
  s_waitcnt vmcnt(6)
  ds_write_b128 v9, v[24:27] offset:2304
  s_waitcnt vmcnt(5)
  ds_write_b128 v9, v[28:31] offset:3456
  s_cmp_eq_u32 s4, 0
  s_mov_b32 s6, 74880
  s_cselect_b32 s5, 36864, s6
  v_mul_u32_u24 v13, 144, v2
  v_lshl_add_u32 v13, v3, 4, v13
  v_add_u32 v13, s5, v13
  s_waitcnt vmcnt(4)
  ds_write_b128 v13, v[32:35]
  s_waitcnt vmcnt(3)
  ds_write_b128 v9, v[36:39] offset:38016
  s_waitcnt vmcnt(2)
  ds_write_b128 v9, v[40:43] offset:39168
  s_waitcnt vmcnt(1)
  ds_write_b128 v9, v[44:47] offset:40320
  s_waitcnt vmcnt(0)
  ds_write_b128 v9, v[48:51] offset:41472
  s_waitcnt lgkmcnt(0)
  s_barrier
  ds_read_b64_tr_b16 v[60:61], v10 offset:576
  ds_read_b64_tr_b16 v[62:63], v10 offset:1152
  ds_read_b64_tr_b16 v[64:65], v10 offset:1728
  ds_read_b64_tr_b16 v[66:67], v10 offset:38016
  ds_read_b64_tr_b16 v[68:69], v10 offset:38592
  ds_read_b64_tr_b16 v[70:71], v10 offset:5184
  ds_read_b64_tr_b16 v[72:73], v10 offset:5760
  ds_read_b64_tr_b16 v[74:75], v10 offset:6336
  ds_read_b64_tr_b16 v[76:77], v10 offset:42624
  ds_read_b64_tr_b16 v[78:79], v10 offset:43200
  v_lshlrev_b32 v80, 16, v52
  v_and_b32 v81, s44, v52
  v_lshlrev_b32 v82, 16, v53
  v_and_b32 v83, s44, v53
  s_waitcnt lgkmcnt(9)
  v_and_b32 v84, s44, v60
  v_lshlrev_b32 v85, 16, v61
  v_and_b32 v86, s44, v61
  s_waitcnt lgkmcnt(8)
  v_lshlrev_b32 v87, 16, v62
  v_and_b32 v88, s44, v62
  v_lshlrev_b32 v89, 16, v63
  v_and_b32 v90, s44, v63
  s_waitcnt lgkmcnt(7)
  v_lshlrev_b32 v91, 16, v64
  v_and_b32 v92, s44, v64
  v_lshlrev_b32 v93, 16, v65
  v_and_b32 v94, s44, v65
  s_waitcnt lgkmcnt(6)
  v_lshlrev_b32 v96, 16, v66
  v_and_b32 v97, s44, v66
  v_lshlrev_b32 v98, 16, v67
  v_and_b32 v99, s44, v67
  s_waitcnt lgkmcnt(5)
  v_lshlrev_b32 v100, 16, v68
  v_and_b32 v101, s44, v68
  v_lshlrev_b32 v102, 16, v69
  v_and_b32 v103, s44, v69
  v_mul_f32 v104, v87, v80
  v_mul_f32 v105, v88, v80
  v_mul_f32 v106, v89, v80
  v_mul_f32 v107, v90, v80
  v_mul_f32 v108, v91, v80
  v_mul_f32 v109, v92, v80
  v_mul_f32 v110, v93, v80
  v_mul_f32 v111, v94, v80
  v_fmac_f32 v104, v86, v81
  v_fmac_f32 v105, v87, v81
  v_fmac_f32 v106, v88, v81
  v_fmac_f32 v107, v89, v81
  v_fmac_f32 v108, v90, v81
  v_fmac_f32 v109, v91, v81
  v_fmac_f32 v110, v92, v81
  v_fmac_f32 v111, v93, v81
  v_fmac_f32 v104, v85, v82
  v_fmac_f32 v105, v86, v82
  v_fmac_f32 v106, v87, v82
  v_fmac_f32 v107, v88, v82
  v_fmac_f32 v108, v89, v82
  v_fmac_f32 v109, v90, v82
  v_fmac_f32 v110, v91, v82
  v_fmac_f32 v111, v92, v82
  v_fmac_f32 v104, v84, v83
  v_fmac_f32 v105, v85, v83
  v_fmac_f32 v106, v86, v83
  v_fmac_f32 v107, v87, v83
  v_fmac_f32 v108, v88, v83
  v_fmac_f32 v109, v89, v83
  v_fmac_f32 v110, v90, v83
  v_fmac_f32 v111, v91, v83
  v_mul_f32 v104, v104, v96
  v_mul_f32 v105, v105, v97
  v_mul_f32 v106, v106, v98
  v_mul_f32 v107, v107, v99
  v_mul_f32 v108, v108, v100
  v_mul_f32 v109, v109, v101
  v_mul_f32 v110, v110, v102
  v_mul_f32 v111, v111, v103
  v_cvt_pk_bf16_f32 v112, v104, v105
  v_cvt_pk_bf16_f32 v113, v106, v107
  v_cvt_pk_bf16_f32 v114, v108, v109
  v_cvt_pk_bf16_f32 v115, v110, v111
  ds_write_b128 v14, v[112:115] offset:0
  ds_read_b64_tr_b16 v[60:61], v10 offset:608
  ds_read_b64_tr_b16 v[62:63], v10 offset:1184
  ds_read_b64_tr_b16 v[64:65], v10 offset:1760
  ds_read_b64_tr_b16 v[66:67], v10 offset:38048
  ds_read_b64_tr_b16 v[68:69], v10 offset:38624
  s_waitcnt lgkmcnt(10)
  v_and_b32 v84, s44, v70
  v_lshlrev_b32 v85, 16, v71
  v_and_b32 v86, s44, v71
  s_waitcnt lgkmcnt(9)
  v_lshlrev_b32 v87, 16, v72
  v_and_b32 v88, s44, v72
  v_lshlrev_b32 v89, 16, v73
  v_and_b32 v90, s44, v73
  s_waitcnt lgkmcnt(8)
  v_lshlrev_b32 v91, 16, v74
  v_and_b32 v92, s44, v74
  v_lshlrev_b32 v93, 16, v75
  v_and_b32 v94, s44, v75
  s_waitcnt lgkmcnt(7)
  v_lshlrev_b32 v96, 16, v76
  v_and_b32 v97, s44, v76
  v_lshlrev_b32 v98, 16, v77
  v_and_b32 v99, s44, v77
  s_waitcnt lgkmcnt(6)
  v_lshlrev_b32 v100, 16, v78
  v_and_b32 v101, s44, v78
  v_lshlrev_b32 v102, 16, v79
  v_and_b32 v103, s44, v79
  v_mul_f32 v104, v87, v80
  v_mul_f32 v105, v88, v80
  v_mul_f32 v106, v89, v80
  v_mul_f32 v107, v90, v80
  v_mul_f32 v108, v91, v80
  v_mul_f32 v109, v92, v80
  v_mul_f32 v110, v93, v80
  v_mul_f32 v111, v94, v80
  v_fmac_f32 v104, v86, v81
  v_fmac_f32 v105, v87, v81
  v_fmac_f32 v106, v88, v81
  v_fmac_f32 v107, v89, v81
  v_fmac_f32 v108, v90, v81
  v_fmac_f32 v109, v91, v81
  v_fmac_f32 v110, v92, v81
  v_fmac_f32 v111, v93, v81
  v_fmac_f32 v104, v85, v82
  v_fmac_f32 v105, v86, v82
  v_fmac_f32 v106, v87, v82
  v_fmac_f32 v107, v88, v82
  v_fmac_f32 v108, v89, v82
  v_fmac_f32 v109, v90, v82
  v_fmac_f32 v110, v91, v82
  v_fmac_f32 v111, v92, v82
  v_fmac_f32 v104, v84, v83
  v_fmac_f32 v105, v85, v83
  v_fmac_f32 v106, v86, v83
  v_fmac_f32 v107, v87, v83
  v_fmac_f32 v108, v88, v83
  v_fmac_f32 v109, v89, v83
  v_fmac_f32 v110, v90, v83
  v_fmac_f32 v111, v91, v83
  v_mul_f32 v104, v104, v96
  v_mul_f32 v105, v105, v97
  v_mul_f32 v106, v106, v98
  v_mul_f32 v107, v107, v99
  v_mul_f32 v108, v108, v100
  v_mul_f32 v109, v109, v101
  v_mul_f32 v110, v110, v102
  v_mul_f32 v111, v111, v103
  v_cvt_pk_bf16_f32 v116, v104, v105
  v_cvt_pk_bf16_f32 v117, v106, v107
  v_cvt_pk_bf16_f32 v118, v108, v109
  v_cvt_pk_bf16_f32 v119, v110, v111
  ds_write_b128 v14, v[116:119] offset:64
  ds_read_b64_tr_b16 v[70:71], v10 offset:5216
  ds_read_b64_tr_b16 v[72:73], v10 offset:5792
  ds_read_b64_tr_b16 v[74:75], v10 offset:6368
  ds_read_b64_tr_b16 v[76:77], v10 offset:42656
  ds_read_b64_tr_b16 v[78:79], v10 offset:43232
  v_lshlrev_b32 v80, 16, v54
  v_and_b32 v81, s44, v54
  v_lshlrev_b32 v82, 16, v55
  v_and_b32 v83, s44, v55
  s_waitcnt lgkmcnt(10)
  v_and_b32 v84, s44, v60
  v_lshlrev_b32 v85, 16, v61
  v_and_b32 v86, s44, v61
  s_waitcnt lgkmcnt(9)
  v_lshlrev_b32 v87, 16, v62
  v_and_b32 v88, s44, v62
  v_lshlrev_b32 v89, 16, v63
  v_and_b32 v90, s44, v63
  s_waitcnt lgkmcnt(8)
  v_lshlrev_b32 v91, 16, v64
  v_and_b32 v92, s44, v64
  v_lshlrev_b32 v93, 16, v65
  v_and_b32 v94, s44, v65
  s_waitcnt lgkmcnt(7)
  v_lshlrev_b32 v96, 16, v66
  v_and_b32 v97, s44, v66
  v_lshlrev_b32 v98, 16, v67
  v_and_b32 v99, s44, v67
  s_waitcnt lgkmcnt(6)
  v_lshlrev_b32 v100, 16, v68
  v_and_b32 v101, s44, v68
  v_lshlrev_b32 v102, 16, v69
  v_and_b32 v103, s44, v69
  v_mul_f32 v104, v87, v80
  v_mul_f32 v105, v88, v80
  v_mul_f32 v106, v89, v80
  v_mul_f32 v107, v90, v80
  v_mul_f32 v108, v91, v80
  v_mul_f32 v109, v92, v80
  v_mul_f32 v110, v93, v80
  v_mul_f32 v111, v94, v80
  v_fmac_f32 v104, v86, v81
  v_fmac_f32 v105, v87, v81
  v_fmac_f32 v106, v88, v81
  v_fmac_f32 v107, v89, v81
  v_fmac_f32 v108, v90, v81
  v_fmac_f32 v109, v91, v81
  v_fmac_f32 v110, v92, v81
  v_fmac_f32 v111, v93, v81
  v_fmac_f32 v104, v85, v82
  v_fmac_f32 v105, v86, v82
  v_fmac_f32 v106, v87, v82
  v_fmac_f32 v107, v88, v82
  v_fmac_f32 v108, v89, v82
  v_fmac_f32 v109, v90, v82
  v_fmac_f32 v110, v91, v82
  v_fmac_f32 v111, v92, v82
  v_fmac_f32 v104, v84, v83
  v_fmac_f32 v105, v85, v83
  v_fmac_f32 v106, v86, v83
  v_fmac_f32 v107, v87, v83
  v_fmac_f32 v108, v88, v83
  v_fmac_f32 v109, v89, v83
  v_fmac_f32 v110, v90, v83
  v_fmac_f32 v111, v91, v83
  v_mul_f32 v104, v104, v96
  v_mul_f32 v105, v105, v97
  v_mul_f32 v106, v106, v98
  v_mul_f32 v107, v107, v99
  v_mul_f32 v108, v108, v100
  v_mul_f32 v109, v109, v101
  v_mul_f32 v110, v110, v102
  v_mul_f32 v111, v111, v103
  v_cvt_pk_bf16_f32 v112, v104, v105
  v_cvt_pk_bf16_f32 v113, v106, v107
  v_cvt_pk_bf16_f32 v114, v108, v109
  v_cvt_pk_bf16_f32 v115, v110, v111
  ds_write_b128 v14, v[112:115] offset:2304
  s_waitcnt lgkmcnt(5)
  v_and_b32 v84, s44, v70
  v_lshlrev_b32 v85, 16, v71
  v_and_b32 v86, s44, v71
  s_waitcnt lgkmcnt(4)
  v_lshlrev_b32 v87, 16, v72
  v_and_b32 v88, s44, v72
  v_lshlrev_b32 v89, 16, v73
  v_and_b32 v90, s44, v73
  s_waitcnt lgkmcnt(3)
  v_lshlrev_b32 v91, 16, v74
  v_and_b32 v92, s44, v74
  v_lshlrev_b32 v93, 16, v75
  v_and_b32 v94, s44, v75
  s_waitcnt lgkmcnt(2)
  v_lshlrev_b32 v96, 16, v76
  v_and_b32 v97, s44, v76
  v_lshlrev_b32 v98, 16, v77
  v_and_b32 v99, s44, v77
  s_waitcnt lgkmcnt(1)
  v_lshlrev_b32 v100, 16, v78
  v_and_b32 v101, s44, v78
  v_lshlrev_b32 v102, 16, v79
  v_and_b32 v103, s44, v79
  v_mul_f32 v104, v87, v80
  v_mul_f32 v105, v88, v80
  v_mul_f32 v106, v89, v80
  v_mul_f32 v107, v90, v80
  v_mul_f32 v108, v91, v80
  v_mul_f32 v109, v92, v80
  v_mul_f32 v110, v93, v80
  v_mul_f32 v111, v94, v80
  v_fmac_f32 v104, v86, v81
  v_fmac_f32 v105, v87, v81
  v_fmac_f32 v106, v88, v81
  v_fmac_f32 v107, v89, v81
  v_fmac_f32 v108, v90, v81
  v_fmac_f32 v109, v91, v81
  v_fmac_f32 v110, v92, v81
  v_fmac_f32 v111, v93, v81
  v_fmac_f32 v104, v85, v82
  v_fmac_f32 v105, v86, v82
  v_fmac_f32 v106, v87, v82
  v_fmac_f32 v107, v88, v82
  v_fmac_f32 v108, v89, v82
  v_fmac_f32 v109, v90, v82
  v_fmac_f32 v110, v91, v82
  v_fmac_f32 v111, v92, v82
  v_fmac_f32 v104, v84, v83
  v_fmac_f32 v105, v85, v83
  v_fmac_f32 v106, v86, v83
  v_fmac_f32 v107, v87, v83
  v_fmac_f32 v108, v88, v83
  v_fmac_f32 v109, v89, v83
  v_fmac_f32 v110, v90, v83
  v_fmac_f32 v111, v91, v83
  v_mul_f32 v104, v104, v96
  v_mul_f32 v105, v105, v97
  v_mul_f32 v106, v106, v98
  v_mul_f32 v107, v107, v99
  v_mul_f32 v108, v108, v100
  v_mul_f32 v109, v109, v101
  v_mul_f32 v110, v110, v102
  v_mul_f32 v111, v111, v103
  v_cvt_pk_bf16_f32 v116, v104, v105
  v_cvt_pk_bf16_f32 v117, v106, v107
  v_cvt_pk_bf16_f32 v118, v108, v109
  v_cvt_pk_bf16_f32 v119, v110, v111
  ds_write_b128 v14, v[116:119] offset:2368
  ds_read_b128 v[16:19], v15 offset:0
  ds_read_b128 v[20:23], v15 offset:1152
  ds_read_b128 v[24:27], v15 offset:2304
  ds_read_b128 v[28:31], v15 offset:3456
  s_mov_b32 s45, 0
  s_waitcnt lgkmcnt(3)
  buffer_store_dwordx4 v[16:19], v11, s[52:55], s45 offen sc1
  s_mov_b32 s45, 16384
  s_waitcnt lgkmcnt(2)
  buffer_store_dwordx4 v[20:23], v11, s[52:55], s45 offen sc1
  s_mov_b32 s45, 32768
  s_waitcnt lgkmcnt(1)
  buffer_store_dwordx4 v[24:27], v11, s[52:55], s45 offen sc1
  s_mov_b32 s45, 49152
  s_waitcnt lgkmcnt(0)
  buffer_store_dwordx4 v[28:31], v11, s[52:55], s45 offen sc1
  s_waitcnt vmcnt(0)
  s_barrier
  s_cmp_eq_u32 s4, 0
  s_cbranch_scc0 L_hdone140574130345360
  v_mov_b32 v2, 148480
  ds_read_b32 v126, v2
  s_waitcnt lgkmcnt(0)
  s_mov_b64 exec, 1
  s_lshl_b32 s5, s28, 7
  s_lshl_b32 s6, s38, 2
  s_add_u32 s5, s5, s6
  s_add_u32 s5, s5, 6291456
  v_mov_b32 v2, s5
  global_store_dword v2, v126, s[94:95] sc1
  s_mov_b64 exec, -1
  s_waitcnt vmcnt(0)
L_hdone140574130345360:
  s_endpgm
L_HQ:
  s_mov_b32 s16, s78
  s_and_b32 s17, s79, 0xffff
  s_mov_b32 s18, 2621440
  s_mov_b32 s19, 0x20000
  v_lshrrev_b32 v2, 3, v1
  v_and_b32 v3, 7, v1
  v_and_b32 v4, 15, v1
  v_lshrrev_b32 v5, 4, v1
  v_lshrrev_b32 v6, 2, v4
  v_and_b32 v7, 3, v4
  s_mul_i32 s5, s4, 81920
  s_lshl_b32 s6, s28, 7
  s_add_u32 s5, s5, s6
  v_mul_u32_u24 v8, 1280, v2
  v_lshl_add_u32 v8, v3, 4, v8
  v_add_u32 v8, s5, v8
  s_mul_i32 s45, s38, 655360
  buffer_load_dwordx4 v[16:19], v8, s[16:19], s45 offen
  s_add_u32 s45, s45, 10240
  buffer_load_dwordx4 v[20:23], v8, s[16:19], s45 offen
  s_add_u32 s45, s45, 10240
  buffer_load_dwordx4 v[24:27], v8, s[16:19], s45 offen
  s_add_u32 s45, s45, 10240
  buffer_load_dwordx4 v[28:31], v8, s[16:19], s45 offen
  s_add_u32 s45, s45, 10240
  buffer_load_dwordx4 v[32:35], v8, s[16:19], s45 offen
  s_add_u32 s45, s45, 10240
  buffer_load_dwordx4 v[36:39], v8, s[16:19], s45 offen
  s_add_u32 s45, s45, 10240
  buffer_load_dwordx4 v[40:43], v8, s[16:19], s45 offen
  s_add_u32 s45, s45, 10240
  buffer_load_dwordx4 v[44:47], v8, s[16:19], s45 offen
  s_mov_b32 s52, s94
  s_and_b32 s53, s95, 0xffff
  s_mov_b32 s54, 2621440
  s_mov_b32 s55, 0x20000
  s_mul_i32 s5, s4, 9216
  v_mul_u32_u24 v9, 144, v2
  v_lshl_add_u32 v9, v3, 4, v9
  v_add_u32 v9, s5, v9
  v_lshl_add_u32 v10, v5, 3, v6
  v_mul_u32_u24 v10, 144, v10
  v_lshl_add_u32 v10, v7, 3, v10
  v_add_u32 v10, s5, v10
  s_mul_i32 s7, s4, 9216
  s_add_u32 s7, s7, 73728
  v_mul_u32_u24 v12, 144, v4
  v_lshl_add_u32 v12, v5, 4, v12
  v_add_u32 v12, s7, v12
  v_mul_u32_u24 v13, 144, v2
  v_lshl_add_u32 v13, v3, 4, v13
  v_add_u32 v13, s7, v13
  s_lshl_b32 s5, s28, 18
  s_lshl_b32 s6, s38, 10
  s_add_u32 s5, s5, s6
  s_lshl_b32 s6, s4, 7
  s_add_u32 s5, s5, s6
  v_lshlrev_b32 v11, 12, v2
  v_lshl_add_u32 v11, v3, 4, v11
  v_add_u32 v11, s5, v11
  s_waitcnt vmcnt(7)
  ds_write_b128 v9, v[16:19] offset:0
  s_waitcnt vmcnt(6)
  ds_write_b128 v9, v[20:23] offset:1152
  s_waitcnt vmcnt(5)
  ds_write_b128 v9, v[24:27] offset:2304
  s_waitcnt vmcnt(4)
  ds_write_b128 v9, v[28:31] offset:3456
  s_waitcnt vmcnt(3)
  ds_write_b128 v9, v[32:35] offset:4608
  s_waitcnt vmcnt(2)
  ds_write_b128 v9, v[36:39] offset:5760
  s_waitcnt vmcnt(1)
  ds_write_b128 v9, v[40:43] offset:6912
  s_waitcnt vmcnt(0)
  ds_write_b128 v9, v[44:47] offset:8064
  s_waitcnt lgkmcnt(0)
  s_barrier
  ds_read_b64_tr_b16 v[48:49], v10 offset:0
  ds_read_b64_tr_b16 v[50:51], v10 offset:576
  ds_read_b64_tr_b16 v[52:53], v10 offset:32
  ds_read_b64_tr_b16 v[54:55], v10 offset:608
  ds_read_b64_tr_b16 v[56:57], v10 offset:64
  ds_read_b64_tr_b16 v[58:59], v10 offset:640
  ds_read_b64_tr_b16 v[60:61], v10 offset:96
  ds_read_b64_tr_b16 v[62:63], v10 offset:672
  ds_read_b64_tr_b16 v[64:65], v10 offset:4608
  ds_read_b64_tr_b16 v[66:67], v10 offset:5184
  ds_read_b64_tr_b16 v[68:69], v10 offset:4640
  ds_read_b64_tr_b16 v[70:71], v10 offset:5216
  ds_read_b64_tr_b16 v[72:73], v10 offset:4672
  ds_read_b64_tr_b16 v[74:75], v10 offset:5248
  ds_read_b64_tr_b16 v[76:77], v10 offset:4704
  ds_read_b64_tr_b16 v[78:79], v10 offset:5280
  s_waitcnt lgkmcnt(14)
  ds_write_b128 v12, v[48:51] offset:0
  s_waitcnt lgkmcnt(13)
  ds_write_b128 v12, v[52:55] offset:2304
  s_waitcnt lgkmcnt(12)
  ds_write_b128 v12, v[56:59] offset:4608
  s_waitcnt lgkmcnt(11)
  ds_write_b128 v12, v[60:63] offset:6912
  s_waitcnt lgkmcnt(10)
  ds_write_b128 v12, v[64:67] offset:64
  s_waitcnt lgkmcnt(9)
  ds_write_b128 v12, v[68:71] offset:2368
  s_waitcnt lgkmcnt(8)
  ds_write_b128 v12, v[72:75] offset:4672
  s_waitcnt lgkmcnt(7)
  ds_write_b128 v12, v[76:79] offset:6976
  ds_read_b128 v[16:19], v13 offset:0
  ds_read_b128 v[20:23], v13 offset:1152
  ds_read_b128 v[24:27], v13 offset:2304
  ds_read_b128 v[28:31], v13 offset:3456
  ds_read_b128 v[32:35], v13 offset:4608
  ds_read_b128 v[36:39], v13 offset:5760
  ds_read_b128 v[40:43], v13 offset:6912
  ds_read_b128 v[44:47], v13 offset:8064
  s_mov_b32 s45, 0
  s_waitcnt lgkmcnt(7)
  buffer_store_dwordx4 v[16:19], v11, s[52:55], s45 offen sc1
  s_mov_b32 s45, 32768
  s_waitcnt lgkmcnt(6)
  buffer_store_dwordx4 v[20:23], v11, s[52:55], s45 offen sc1
  s_mov_b32 s45, 65536
  s_waitcnt lgkmcnt(5)
  buffer_store_dwordx4 v[24:27], v11, s[52:55], s45 offen sc1
  s_mov_b32 s45, 98304
  s_waitcnt lgkmcnt(4)
  buffer_store_dwordx4 v[28:31], v11, s[52:55], s45 offen sc1
  s_mov_b32 s45, 131072
  s_waitcnt lgkmcnt(3)
  buffer_store_dwordx4 v[32:35], v11, s[52:55], s45 offen sc1
  s_mov_b32 s45, 163840
  s_waitcnt lgkmcnt(2)
  buffer_store_dwordx4 v[36:39], v11, s[52:55], s45 offen sc1
  s_mov_b32 s45, 196608
  s_waitcnt lgkmcnt(1)
  buffer_store_dwordx4 v[40:43], v11, s[52:55], s45 offen sc1
  s_mov_b32 s45, 229376
  s_waitcnt lgkmcnt(0)
  buffer_store_dwordx4 v[44:47], v11, s[52:55], s45 offen sc1
  s_add_u32 s36, s38, 4
  s_waitcnt vmcnt(0)
  s_barrier
  s_cmp_eq_u32 s4, 0
  s_cbranch_scc0 L_hdone140574129620528
  v_mov_b32 v2, 148480
  ds_read_b32 v126, v2
  s_waitcnt lgkmcnt(0)
  s_mov_b64 exec, 1
  s_lshl_b32 s5, s28, 7
  s_lshl_b32 s6, s36, 2
  s_add_u32 s5, s5, s6
  s_add_u32 s5, s5, 6291456
  v_mov_b32 v2, s5
  global_store_dword v2, v126, s[94:95] sc1
  s_mov_b64 exec, -1
  s_waitcnt vmcnt(0)
L_hdone140574129620528:
  s_endpgm
L_HN:
  s_waitcnt lgkmcnt(0)
  s_memrealtime s[56:57]
  s_waitcnt lgkmcnt(0)
  s_or_b32 s56, s56, 1
  v_mov_b32 v4, s56
  v_mov_b32 v5, 0
  v_mov_b32 v3, 0
  s_mov_b64 exec, 1
  global_atomic_cmpswap v6, v3, v[4:5], s[92:93] offset:252 sc0 sc1
  s_waitcnt vmcnt(0)
  v_cmp_eq_u32 vcc, 0, v6
  s_nop 1
  v_cndmask_b32 v6, v6, v4, vcc
  v_mov_b32 v3, 148480
  ds_write_b32 v3, v6
  s_mov_b64 exec, -1
  s_waitcnt lgkmcnt(0)
  s_barrier
  s_barrier
L_exit:
  s_endpgm
.section .rodata,"a"
.p2align 6
.amdhsa_kernel concat_heads__ssm_conv_s4d__ssm_conv_h3__prompt_kernel
  .amdhsa_next_free_vgpr 168
  .amdhsa_next_free_sgpr 100
  .amdhsa_accum_offset 168
  .amdhsa_group_segment_fixed_size 0
  .amdhsa_kernarg_size 128
  .amdhsa_user_sgpr_count 2
  .amdhsa_user_sgpr_kernarg_segment_ptr 1
  .amdhsa_system_sgpr_workgroup_id_x 1
.end_amdhsa_kernel
```
